```python
import torch

def _softmax(x, axis=-1):
    return torch.softmax(x, dim=axis)
def _gelu(x):
    return torch.nn.functional.gelu(x, approximate="tanh")
def _silu(x):
    return torch.nn.functional.silu(x)
def _sigmoid(x):
    return torch.sigmoid(x)
def _layernorm(x, axis=-1, eps=1e-5):
    m = x.mean(dim=axis, keepdim=True)
    v = x.var(dim=axis, keepdim=True, unbiased=False)
    return (x - m) / torch.sqrt(v + eps)
def _scatter_add(tgt, idx, src, axis=0):
    return tgt.clone().index_add_(axis, idx, src)
def _segment_sum(src, seg, n):
    out = torch.zeros((n,) + src.shape[1:], dtype=src.dtype)
    return out.index_add_(0, seg, src)
def _pad(x, pw):
    flat = tuple(v for pair in reversed(pw) for v in pair)
    return torch.nn.functional.pad(x, flat)

kernel_name = 'standalone__mha_block_cached__near_ridge'

def setup_inputs():

    _w = (lambda a: (lambda t: t.to(torch.bfloat16) if t.is_floating_point() else t)(torch.as_tensor(a)))
    B, Sq, D = 16, 192, 1024
    H, Sk, Dh = 32, 1024, 128
    return {
        "x": _w((lambda *s: torch.randn(*s, dtype=torch.bfloat16) * 0.8)(B, Sq, D)),
        "k_cache": _w((lambda *s: torch.randn(*s, dtype=torch.bfloat16) * 0.8)(B, H, Sk, Dh)),
        "v_cache": _w((lambda *s: torch.randn(*s, dtype=torch.bfloat16) * 0.05)(B, H, Sk, Dh)),
        "wq": _w((lambda *s: torch.randn(*s, dtype=torch.bfloat16) * 0.8)(D, H * Dh) * (D ** -0.5)),
        "wo": _w((lambda *s: torch.randn(*s, dtype=torch.bfloat16) * 0.05)(H * Dh, D) * ((H * Dh) ** -0.5)),
    }

def reference(x, k_cache, v_cache, wq, wo):
    B, Sq, D = x.shape
    H, Dh = 32, 128
    q = (lambda x, *d: x.permute(*d))((x @ wq).reshape(B, Sq, H, Dh), 0, 2, 1, 3)
    scores = torch.einsum("bhqd,bhkd->bhqk", q, k_cache) * (Dh ** -0.5)
    p = _softmax(scores, axis=-1)
    o = torch.einsum("bhqk,bhkd->bhqd", p, v_cache)
    return (lambda x, *d: x.permute(*d))(o, 0, 2, 1, 3).reshape(B, Sq, H * Dh) @ wo
```

```asm
; @launch kernel=standalone__mha_block_cached__near_ridge_kernel grid=(512,1,1) block=(256,1,1) lds=81920
.amdgcn_target "amdgcn-amd-amdhsa--gfx950"
.text
.globl standalone__mha_block_cached__near_ridge_kernel
.p2align 8
.type standalone__mha_block_cached__near_ridge_kernel,@function
standalone__mha_block_cached__near_ridge_kernel:
    s_cmp_ge_u32 s2, 512
    s_cbranch_scc1 L_end
    s_load_dwordx16 s[48:63], s[0:1], 0
    v_and_b32 v13, 63, v0
    v_lshrrev_b32 v7, 6, v0
    s_nop 0
    v_readfirstlane_b32 s24, v7
    s_lshr_b32 s71, s2, 8
    s_xor_b32 s71, s71, 1
    s_mov_b32 s69, 0
    s_setprio 1
    s_cmp_lt_u32 s2, 256
    s_cbranch_scc1 L_pr0
    s_setprio 2
L_pr0:
    s_cmp_lg_u32 s24, 3
    s_cbranch_scc1 L_nocpf
    s_lshr_b32 s37, s2, 3
    s_cmp_lg_u32 s37, 1
    s_cbranch_scc1 L_nocpf
    s_getpc_b64 s[96:97]
    s_and_b32 s96, s96, 0xffffff00
    s_and_b32 s97, s97, 0xffff
    s_mov_b32 s98, 40000
    s_mov_b32 s99, 0x00020000
    v_lshlrev_b32 v14, 7, v13
    s_mov_b32 s37, 0
    buffer_load_dword v15, v14, s[96:99], s37 offen
    s_mov_b32 s37, 8192
    buffer_load_dword v15, v14, s[96:99], s37 offen
    s_mov_b32 s37, 16384
    buffer_load_dword v15, v14, s[96:99], s37 offen
    s_mov_b32 s37, 24576
    buffer_load_dword v15, v14, s[96:99], s37 offen
    s_mov_b32 s37, 32768
    buffer_load_dword v15, v14, s[96:99], s37 offen
    s_mov_b32 s37, 40960
    buffer_load_dword v15, v14, s[96:99], s37 offen
L_nocpf:
    s_memrealtime s[42:43]
    s_waitcnt lgkmcnt(0)
    s_or_b32 s37, s2, s24
    s_cmp_lg_u32 s37, 0
    s_cbranch_scc1 L_start
    s_mov_b32 s20, s60
    s_and_b32 s21, s61, 0xffff
    s_mov_b32 s22, 256
    s_mov_b32 s23, 0x00020000
    s_or_b32 s42, s42, 1
    v_mov_b32 v62, 0
    v_mov_b32 v63, s42
    s_mov_b64 exec, 1
    s_nop 0
    buffer_store_dword v63, v62, s[20:23], 0 offen sc1
    s_mov_b64 exec, -1
    s_nop 1
L_start:
    s_and_b32 s46, s2, 7
    s_lshr_b32 s47, s2, 3
    s_and_b32 s47, s47, 31
    s_and_b32 s37, s46, 3
    s_lshl_b32 s37, s37, 2
    s_and_b32 s25, s47, 3
    s_add_u32 s25, s25, s37
    s_lshr_b32 s37, s46, 2
    s_lshl_b32 s37, s37, 3
    s_lshr_b32 s26, s47, 2
    s_add_u32 s26, s26, s37
    s_lshl_b32 s37, s71, 4
    s_add_u32 s26, s26, s37
    s_mov_b32 s4, s48
    s_and_b32 s5, s49, 0xffff
    s_mov_b32 s6, 6291456
    s_mov_b32 s7, 0x00020000
    s_mov_b32 s8, s54
    s_and_b32 s9, s55, 0xffff
    s_mov_b32 s10, 8388608
    s_mov_b32 s11, 0x00020000
    s_lshl_b32 s37, s25, 5
    s_add_u32 s37, s37, s26
    s_lshl_b32 s37, s37, 18
    s_add_u32 s12, s50, s37
    s_addc_u32 s13, s51, 0
    s_add_u32 s16, s52, s37
    s_addc_u32 s17, s53, 0
    s_and_b32 s13, s13, 0xffff
    s_mov_b32 s14, 262144
    s_mov_b32 s15, 0x00020000
    s_and_b32 s17, s17, 0xffff
    s_mov_b32 s18, 262144
    s_mov_b32 s19, 0x00020000
    s_cmp_eq_u32 s71, 1
    s_cselect_b32 s14, 0, s14
    s_mov_b32 s18, s14
    s_mov_b32 s20, s62
    s_and_b32 s21, s63, 0xffff
    s_mov_b32 s22, 46309376
    s_mov_b32 s23, 0x00020000
    s_mov_b32 s96, s60
    s_and_b32 s97, s61, 0xffff
    s_mov_b32 s98, 256
    s_mov_b32 s99, 0x00020000
    s_mul_i32 s33, s24, 2176
    s_mul_i32 s34, s24, 2112
    s_mov_b32 s35, 1149239296
    s_mov_b32 s36, 1040356334
    s_lshl_b32 s70, s47, 13
    s_mov_b32 s30, s70
    s_mov_b32 s31, s70
    s_mov_b32 s28, 0
    s_mul_i32 s67, s24, 6144
    s_lshl_b32 s68, s24, 11
    s_mul_i32 s27, s25, 192
    s_mul_i32 s37, s24, 48
    s_add_u32 s27, s27, s37
    s_lshl_b32 s64, s27, 11
    s_add_u32 s65, s64, 0x8000
    s_add_u32 s66, s64, 0x10000
    v_and_b32 v2, 15, v13
    v_lshrrev_b32 v3, 4, v13
    v_xor_b32 v4, v3, v13
    v_and_b32 v4, 7, v4
    v_lshrrev_b32 v5, 3, v13
    v_lshlrev_b32 v5, 11, v5
    v_lshl_add_u32 v18, v4, 4, v5
    v_xor_b32 v19, 64, v18
    v_add_u32 v19, 0x4000, v19
    v_and_b32 v4, 1, v3
    v_lshlrev_b32 v4, 2, v4
    v_lshrrev_b32 v5, 1, v3
    v_lshl_add_u32 v4, v5, 4, v4
    s_lshl_b32 s37, s24, 1
    s_and_b32 s37, s37, 3
    s_lshr_b32 s38, s24, 1
    s_lshl_b32 s38, s38, 3
    s_add_u32 s37, s37, s38
    v_add_u32 v4, s37, v4
    v_lshlrev_b32 v4, 13, v4
    s_lshl_b32 s37, s24, 2
    v_xor_b32 v5, s37, v2
    v_lshl_add_u32 v4, v5, 4, v4
    s_lshl_b32 s37, s26, 8
    v_add_u32 v16, s37, v4
    v_xor_b32 v17, 32, v16
    v_add_u32 v17, 0x2000, v17
    s_add_u32 m0, s67, 32768
    s_nop 0
    buffer_load_dwordx4 v18, s[4:7], s64 offen lds
    s_add_u32 m0, s67, 33792
    s_nop 0
    buffer_load_dwordx4 v19, s[4:7], s64 offen lds
    s_add_u32 m0, s67, 34816
    s_nop 0
    buffer_load_dwordx4 v18, s[4:7], s65 offen lds
    s_add_u32 m0, s67, 35840
    s_nop 0
    buffer_load_dwordx4 v19, s[4:7], s65 offen lds
    s_add_u32 m0, s67, 36864
    s_nop 0
    buffer_load_dwordx4 v18, s[4:7], s66 offen lds
    s_add_u32 m0, s67, 37888
    s_nop 0
    buffer_load_dwordx4 v19, s[4:7], s66 offen lds
    s_add_u32 m0, s68, 0
    s_nop 0
    buffer_load_dwordx4 v16, s[8:11], s28 offen lds
    s_add_u32 m0, s68, 1024
    s_nop 0
    buffer_load_dwordx4 v17, s[8:11], s28 offen lds
    s_add_u32 s28, s28, 0x40000
    s_add_u32 m0, s68, 8192
    s_nop 0
    buffer_load_dwordx4 v16, s[8:11], s28 offen lds
    s_add_u32 m0, s68, 9216
    s_nop 0
    buffer_load_dwordx4 v17, s[8:11], s28 offen lds
    s_add_u32 s28, s28, 0x40000
    s_add_u32 m0, s67, 57216
    s_nop 0
    buffer_load_dwordx4 v18, s[4:7], s64 offen offset:128 lds
    s_add_u32 m0, s67, 58240
    s_nop 0
    buffer_load_dwordx4 v19, s[4:7], s64 offen offset:128 lds
    s_add_u32 m0, s67, 59264
    s_nop 0
    buffer_load_dwordx4 v18, s[4:7], s65 offen offset:128 lds
    s_add_u32 m0, s67, 60288
    s_nop 0
    buffer_load_dwordx4 v19, s[4:7], s65 offen offset:128 lds
    s_add_u32 m0, s67, 61312
    s_nop 0
    buffer_load_dwordx4 v18, s[4:7], s66 offen offset:128 lds
    s_add_u32 m0, s67, 62336
    s_nop 0
    buffer_load_dwordx4 v19, s[4:7], s66 offen offset:128 lds
    s_add_u32 m0, s68, 16384
    s_nop 0
    buffer_load_dwordx4 v16, s[8:11], s28 offen lds
    s_add_u32 m0, s68, 17408
    s_nop 0
    buffer_load_dwordx4 v17, s[8:11], s28 offen lds
    s_add_u32 s28, s28, 0x40000
    s_add_u32 m0, s68, 24576
    s_nop 0
    buffer_load_dwordx4 v16, s[8:11], s28 offen lds
    s_add_u32 m0, s68, 25600
    s_nop 0
    buffer_load_dwordx4 v17, s[8:11], s28 offen lds
    s_add_u32 s28, s28, 0x40000
    v_lshrrev_b32 v4, 1, v2
    v_xor_b32 v4, v4, v3
    v_lshlrev_b32 v4, 4, v4
    v_lshl_add_u32 v4, v2, 7, v4
    s_add_u32 s37, s67, 32768
    v_add_u32 v60, s37, v4
    v_xor_b32 v61, 64, v60
    v_and_b32 v4, 1, v3
    v_lshlrev_b32 v4, 2, v4
    v_lshrrev_b32 v5, 2, v2
    v_add_u32 v4, v4, v5
    v_lshlrev_b32 v20, 10, v4
    v_lshrrev_b32 v5, 1, v3
    v_lshl_add_u32 v20, v5, 9, v20
    v_lshlrev_b32 v4, 1, v4
    v_and_b32 v5, 3, v2
    v_xor_b32 v4, v4, v5
    v_lshl_add_u32 v20, v4, 4, v20
    v_lshrrev_b32 v5, 1, v5
    v_lshl_add_u32 v20, v5, 3, v20
    v_xor_b32 v21, 64, v20
    v_xor_b32 v22, 128, v20
    v_xor_b32 v23, 192, v20
    v_xor_b32 v24, 8, v20
    v_xor_b32 v25, 72, v20
    v_xor_b32 v26, 136, v20
    v_xor_b32 v27, 200, v20
    v_lshrrev_b32 v4, 2, v2
    v_mul_u32_u24 v9, 1088, v4
    v_and_b32 v4, 3, v2
    v_lshl_add_u32 v9, v4, 8, v9
    v_xor_b32 v4, v4, v3
    v_lshl_add_u32 v9, v4, 4, v9
    v_add_u32 v9, 8704, v9
    v_and_b32 v4, 1, v3
    v_lshlrev_b32 v4, 2, v4
    v_lshrrev_b32 v5, 2, v2
    v_add_u32 v4, v4, v5
    v_mul_u32_u24 v4, 1056, v4
    v_lshrrev_b32 v5, 1, v3
    v_lshl_add_u32 v10, v5, 8, v4
    v_and_b32 v5, 3, v2
    v_lshl_add_u32 v10, v5, 3, v10
    v_and_b32 v4, 3, v2
    v_xor_b32 v4, v4, v3
    v_and_b32 v5, 12, v2
    v_or_b32 v4, v4, v5
    v_lshlrev_b32 v4, 4, v4
    v_lshl_add_u32 v4, v3, 8, v4
    s_lshl_b32 s37, s24, 11
    v_add_u32 v11, s37, v4
    v_lshlrev_b32 v4, 4, v2
    v_lshl_add_u32 v4, v3, 11, v4
    s_lshl_b32 s37, s24, 9
    v_add_u32 v12, s37, v4
    s_waitcnt vmcnt(14)
    ds_read_b128 v[64:67], v60 offset:0
    ds_read_b128 v[68:71], v60 offset:2048
    ds_read_b128 v[72:75], v60 offset:4096
    ds_read_b128 v[76:79], v61 offset:0
    ds_read_b128 v[80:83], v61 offset:2048
    ds_read_b128 v[84:87], v61 offset:4096
    s_waitcnt vmcnt(12) lgkmcnt(0)
    s_cmp_lg_u32 s71, 1
    s_cbranch_scc1 L_bwd
    s_cmp_lg_u32 s24, 0
    s_cbranch_scc1 L_bwd
    v_mov_b32 v62, 0
    s_mov_b32 s32, 0
    s_and_b32 s39, s2, 255
    s_lshl_b32 s39, s39, 7
    s_add_u32 s39, s39, 46211072
L_bwl:
    s_sleep 8
    buffer_load_dword v63, v62, s[96:99], 0 offen sc1
    buffer_load_dword v7, v62, s[20:23], s39 offen sc1
    s_waitcnt vmcnt(0)
    v_readfirstlane_b32 s37, v63
    v_readfirstlane_b32 s38, v7
    s_add_u32 s32, s32, 1
    s_cmp_ge_u32 s32, 32
    s_cbranch_scc1 L_bwd
    s_nop 1
    s_cmp_eq_u32 s37, 0
    s_cbranch_scc1 L_bwl
    s_cmp_lg_u32 s37, s38
    s_cbranch_scc1 L_bwl
L_bwd:
    s_barrier
    s_add_u32 m0, s67, 32512
    ds_read_b64_tr_b16 v[28:29], v20 offset:0
    ds_read_b64_tr_b16 v[30:31], v20 offset:256
    ds_read_b64_tr_b16 v[32:33], v24 offset:0
    ds_read_b64_tr_b16 v[34:35], v24 offset:256
    ds_read_b64_tr_b16 v[36:37], v21 offset:0
    ds_read_b64_tr_b16 v[38:39], v21 offset:256
    ds_read_b64_tr_b16 v[40:41], v25 offset:0
    ds_read_b64_tr_b16 v[42:43], v25 offset:256
    ds_read_b64_tr_b16 v[44:45], v22 offset:0
    ds_read_b64_tr_b16 v[46:47], v22 offset:256
    ds_read_b64_tr_b16 v[48:49], v26 offset:0
    ds_read_b64_tr_b16 v[50:51], v26 offset:256
    ds_read_b64_tr_b16 v[52:53], v23 offset:0
    ds_read_b64_tr_b16 v[54:55], v23 offset:256
    s_waitcnt lgkmcnt(10)
    v_mfma_f32_16x16x32_bf16 v[160:163], v[28:31], v[64:67], 0
    buffer_load_dwordx4 v18, s[4:7], s64 offen offset:256 lds
    s_add_u32 m0, s67, 33536
    v_mfma_f32_16x16x32_bf16 v[192:195], v[28:31], v[68:71], 0
    buffer_load_dwordx4 v19, s[4:7], s64 offen offset:256 lds
    s_add_u32 m0, s67, 34560
    v_mfma_f32_16x16x32_bf16 v[224:227], v[28:31], v[72:75], 0
    buffer_load_dwordx4 v18, s[4:7], s65 offen offset:256 lds
    v_mfma_f32_16x16x32_bf16 v[164:167], v[32:35], v[64:67], 0
    s_waitcnt vmcnt(7)
    ds_read_b64_tr_b16 v[56:57], v27 offset:0
    ds_read_b64_tr_b16 v[58:59], v27 offset:256
    v_mfma_f32_16x16x32_bf16 v[196:199], v[32:35], v[68:71], 0
    ds_read_b128 v[88:91], v60 offset:24576
    v_mfma_f32_16x16x32_bf16 v[228:231], v[32:35], v[72:75], 0
    ds_read_b128 v[92:95], v60 offset:26624
    s_waitcnt lgkmcnt(10)
    v_mfma_f32_16x16x32_bf16 v[168:171], v[36:39], v[64:67], 0
    ds_read_b128 v[96:99], v60 offset:28672
    v_mfma_f32_16x16x32_bf16 v[200:203], v[36:39], v[68:71], 0
    ds_read_b128 v[100:103], v61 offset:24576
    v_mfma_f32_16x16x32_bf16 v[232:235], v[36:39], v[72:75], 0
    ds_read_b128 v[104:107], v61 offset:26624
    s_add_u32 m0, s67, 35584
    v_mfma_f32_16x16x32_bf16 v[172:175], v[40:43], v[64:67], 0
    ds_read_b128 v[108:111], v61 offset:28672
    buffer_load_dwordx4 v19, s[4:7], s65 offen offset:256 lds
    s_add_u32 m0, s67, 36608
    v_mfma_f32_16x16x32_bf16 v[204:207], v[40:43], v[68:71], 0
    buffer_load_dwordx4 v18, s[4:7], s66 offen offset:256 lds
    s_add_u32 m0, s67, 37632
    v_mfma_f32_16x16x32_bf16 v[236:239], v[40:43], v[72:75], 0
    buffer_load_dwordx4 v19, s[4:7], s66 offen offset:256 lds
    s_waitcnt lgkmcnt(0)
    s_barrier
    v_mfma_f32_16x16x32_bf16 v[176:179], v[44:47], v[64:67], 0
    ds_read_b64_tr_b16 v[28:29], v20 offset:8192
    ds_read_b64_tr_b16 v[30:31], v20 offset:8448
    s_add_u32 m0, s68, 0
    v_mfma_f32_16x16x32_bf16 v[208:211], v[44:47], v[68:71], 0
    buffer_load_dwordx4 v16, s[8:11], s28 offen lds
    ds_read_b64_tr_b16 v[32:33], v24 offset:8192
    ds_read_b64_tr_b16 v[34:35], v24 offset:8448
    v_mfma_f32_16x16x32_bf16 v[240:243], v[44:47], v[72:75], 0
    ds_read_b64_tr_b16 v[36:37], v21 offset:8192
    ds_read_b64_tr_b16 v[38:39], v21 offset:8448
    s_add_u32 m0, s68, 1024
    v_mfma_f32_16x16x32_bf16 v[180:183], v[48:51], v[64:67], 0
    buffer_load_dwordx4 v17, s[8:11], s28 offen lds
    ds_read_b64_tr_b16 v[40:41], v25 offset:8192
    ds_read_b64_tr_b16 v[42:43], v25 offset:8448
    v_mfma_f32_16x16x32_bf16 v[212:215], v[48:51], v[68:71], 0
    ds_read_b64_tr_b16 v[44:45], v22 offset:8192
    ds_read_b64_tr_b16 v[46:47], v22 offset:8448
    v_mfma_f32_16x16x32_bf16 v[244:247], v[48:51], v[72:75], 0
    s_add_u32 m0, s67, 56960
    v_mfma_f32_16x16x32_bf16 v[184:187], v[52:55], v[64:67], 0
    buffer_load_dwordx4 v18, s[4:7], s64 offen offset:384 lds
    ds_read_b64_tr_b16 v[48:49], v26 offset:8192
    ds_read_b64_tr_b16 v[50:51], v26 offset:8448
    v_mfma_f32_16x16x32_bf16 v[216:219], v[52:55], v[68:71], 0
    v_mfma_f32_16x16x32_bf16 v[248:251], v[52:55], v[72:75], 0
    s_add_u32 m0, s67, 57984
    v_mfma_f32_16x16x32_bf16 v[188:191], v[56:59], v[64:67], 0
    buffer_load_dwordx4 v19, s[4:7], s64 offen offset:384 lds
    ds_read_b64_tr_b16 v[52:53], v23 offset:8192
    ds_read_b64_tr_b16 v[54:55], v23 offset:8448
    v_mfma_f32_16x16x32_bf16 v[220:223], v[56:59], v[68:71], 0
    s_add_u32 s28, s28, 0x40000
    v_mfma_f32_16x16x32_bf16 v[252:255], v[56:59], v[72:75], 0
    s_add_u32 m0, s67, 59008
    s_waitcnt lgkmcnt(10)
    v_mfma_f32_16x16x32_bf16 v[160:163], v[28:31], v[76:79], v[160:163]
    buffer_load_dwordx4 v18, s[4:7], s65 offen offset:384 lds
    v_mfma_f32_16x16x32_bf16 v[192:195], v[28:31], v[80:83], v[192:195]
    v_mfma_f32_16x16x32_bf16 v[224:227], v[28:31], v[84:87], v[224:227]
    s_add_u32 m0, s67, 60032
    v_mfma_f32_16x16x32_bf16 v[164:167], v[32:35], v[76:79], v[164:167]
    buffer_load_dwordx4 v19, s[4:7], s65 offen offset:384 lds
    ds_read_b64_tr_b16 v[56:57], v27 offset:8192
    ds_read_b64_tr_b16 v[58:59], v27 offset:8448
    v_mfma_f32_16x16x32_bf16 v[196:199], v[32:35], v[80:83], v[196:199]
    v_mfma_f32_16x16x32_bf16 v[228:231], v[32:35], v[84:87], v[228:231]
    s_add_u32 m0, s67, 61056
    s_waitcnt lgkmcnt(8)
    v_mfma_f32_16x16x32_bf16 v[168:171], v[36:39], v[76:79], v[168:171]
    buffer_load_dwordx4 v18, s[4:7], s66 offen offset:384 lds
    v_mfma_f32_16x16x32_bf16 v[200:203], v[36:39], v[80:83], v[200:203]
    v_mfma_f32_16x16x32_bf16 v[232:235], v[36:39], v[84:87], v[232:235]
    s_add_u32 m0, s67, 62080
    v_mfma_f32_16x16x32_bf16 v[172:175], v[40:43], v[76:79], v[172:175]
    buffer_load_dwordx4 v19, s[4:7], s66 offen offset:384 lds
    v_mfma_f32_16x16x32_bf16 v[204:207], v[40:43], v[80:83], v[204:207]
    v_mfma_f32_16x16x32_bf16 v[236:239], v[40:43], v[84:87], v[236:239]
    s_waitcnt vmcnt(16) lgkmcnt(0)
    s_barrier
    v_mfma_f32_16x16x32_bf16 v[176:179], v[44:47], v[76:79], v[176:179]
    ds_read_b64_tr_b16 v[28:29], v20 offset:16384
    ds_read_b64_tr_b16 v[30:31], v20 offset:16640
    s_add_u32 m0, s68, 8192
    v_mfma_f32_16x16x32_bf16 v[208:211], v[44:47], v[80:83], v[208:211]
    buffer_load_dwordx4 v16, s[8:11], s28 offen lds
    ds_read_b64_tr_b16 v[32:33], v24 offset:16384
    ds_read_b64_tr_b16 v[34:35], v24 offset:16640
    v_mfma_f32_16x16x32_bf16 v[240:243], v[44:47], v[84:87], v[240:243]
    ds_read_b64_tr_b16 v[36:37], v21 offset:16384
    ds_read_b64_tr_b16 v[38:39], v21 offset:16640
    s_add_u32 m0, s68, 9216
    v_mfma_f32_16x16x32_bf16 v[180:183], v[48:51], v[76:79], v[180:183]
    buffer_load_dwordx4 v17, s[8:11], s28 offen lds
    ds_read_b64_tr_b16 v[40:41], v25 offset:16384
    ds_read_b64_tr_b16 v[42:43], v25 offset:16640
    v_mfma_f32_16x16x32_bf16 v[212:215], v[48:51], v[80:83], v[212:215]
    ds_read_b64_tr_b16 v[44:45], v22 offset:16384
    ds_read_b64_tr_b16 v[46:47], v22 offset:16640
    v_mfma_f32_16x16x32_bf16 v[244:247], v[48:51], v[84:87], v[244:247]
    v_mfma_f32_16x16x32_bf16 v[184:187], v[52:55], v[76:79], v[184:187]
    ds_read_b64_tr_b16 v[48:49], v26 offset:16384
    ds_read_b64_tr_b16 v[50:51], v26 offset:16640
    v_mfma_f32_16x16x32_bf16 v[216:219], v[52:55], v[80:83], v[216:219]
    v_mfma_f32_16x16x32_bf16 v[248:251], v[52:55], v[84:87], v[248:251]
    v_mfma_f32_16x16x32_bf16 v[188:191], v[56:59], v[76:79], v[188:191]
    ds_read_b64_tr_b16 v[52:53], v23 offset:16384
    ds_read_b64_tr_b16 v[54:55], v23 offset:16640
    v_mfma_f32_16x16x32_bf16 v[220:223], v[56:59], v[80:83], v[220:223]
    s_add_u32 s28, s28, 0x40000
    v_mfma_f32_16x16x32_bf16 v[252:255], v[56:59], v[84:87], v[252:255]
    s_waitcnt lgkmcnt(10)
    v_mfma_f32_16x16x32_bf16 v[160:163], v[28:31], v[88:91], v[160:163]
    v_mfma_f32_16x16x32_bf16 v[192:195], v[28:31], v[92:95], v[192:195]
    v_mfma_f32_16x16x32_bf16 v[224:227], v[28:31], v[96:99], v[224:227]
    v_mfma_f32_16x16x32_bf16 v[164:167], v[32:35], v[88:91], v[164:167]
    s_waitcnt vmcnt(10)
    ds_read_b64_tr_b16 v[56:57], v27 offset:16384
    ds_read_b64_tr_b16 v[58:59], v27 offset:16640
    v_mfma_f32_16x16x32_bf16 v[196:199], v[32:35], v[92:95], v[196:199]
    ds_read_b128 v[64:67], v60 offset:0
    v_mfma_f32_16x16x32_bf16 v[228:231], v[32:35], v[96:99], v[228:231]
    ds_read_b128 v[68:71], v60 offset:2048
    s_waitcnt lgkmcnt(10)
    v_mfma_f32_16x16x32_bf16 v[168:171], v[36:39], v[88:91], v[168:171]
    ds_read_b128 v[72:75], v60 offset:4096
    v_mfma_f32_16x16x32_bf16 v[200:203], v[36:39], v[92:95], v[200:203]
    ds_read_b128 v[76:79], v61 offset:0
    v_mfma_f32_16x16x32_bf16 v[232:235], v[36:39], v[96:99], v[232:235]
    ds_read_b128 v[80:83], v61 offset:2048
    v_mfma_f32_16x16x32_bf16 v[172:175], v[40:43], v[88:91], v[172:175]
    ds_read_b128 v[84:87], v61 offset:4096
    v_mfma_f32_16x16x32_bf16 v[204:207], v[40:43], v[92:95], v[204:207]
    v_mfma_f32_16x16x32_bf16 v[236:239], v[40:43], v[96:99], v[236:239]
    s_waitcnt lgkmcnt(0)
    s_barrier
    v_mfma_f32_16x16x32_bf16 v[176:179], v[44:47], v[88:91], v[176:179]
    ds_read_b64_tr_b16 v[28:29], v20 offset:24576
    ds_read_b64_tr_b16 v[30:31], v20 offset:24832
    s_add_u32 m0, s68, 16384
    v_mfma_f32_16x16x32_bf16 v[208:211], v[44:47], v[92:95], v[208:211]
    buffer_load_dwordx4 v16, s[8:11], s28 offen lds
    ds_read_b64_tr_b16 v[32:33], v24 offset:24576
    ds_read_b64_tr_b16 v[34:35], v24 offset:24832
    v_mfma_f32_16x16x32_bf16 v[240:243], v[44:47], v[96:99], v[240:243]
    ds_read_b64_tr_b16 v[36:37], v21 offset:24576
    ds_read_b64_tr_b16 v[38:39], v21 offset:24832
    s_add_u32 m0, s68, 17408
    v_mfma_f32_16x16x32_bf16 v[180:183], v[48:51], v[88:91], v[180:183]
    buffer_load_dwordx4 v17, s[8:11], s28 offen lds
    ds_read_b64_tr_b16 v[40:41], v25 offset:24576
    ds_read_b64_tr_b16 v[42:43], v25 offset:24832
    v_mfma_f32_16x16x32_bf16 v[212:215], v[48:51], v[92:95], v[212:215]
    ds_read_b64_tr_b16 v[44:45], v22 offset:24576
    ds_read_b64_tr_b16 v[46:47], v22 offset:24832
    v_mfma_f32_16x16x32_bf16 v[244:247], v[48:51], v[96:99], v[244:247]
    s_add_u32 m0, s67, 32256
    v_mfma_f32_16x16x32_bf16 v[184:187], v[52:55], v[88:91], v[184:187]
    buffer_load_dwordx4 v18, s[4:7], s64 offen offset:512 lds
    ds_read_b64_tr_b16 v[48:49], v26 offset:24576
    ds_read_b64_tr_b16 v[50:51], v26 offset:24832
    v_mfma_f32_16x16x32_bf16 v[216:219], v[52:55], v[92:95], v[216:219]
    v_mfma_f32_16x16x32_bf16 v[248:251], v[52:55], v[96:99], v[248:251]
    s_add_u32 m0, s67, 33280
    v_mfma_f32_16x16x32_bf16 v[188:191], v[56:59], v[88:91], v[188:191]
    buffer_load_dwordx4 v19, s[4:7], s64 offen offset:512 lds
    ds_read_b64_tr_b16 v[52:53], v23 offset:24576
    ds_read_b64_tr_b16 v[54:55], v23 offset:24832
    v_mfma_f32_16x16x32_bf16 v[220:223], v[56:59], v[92:95], v[220:223]
    s_add_u32 s28, s28, 0x40000
    v_mfma_f32_16x16x32_bf16 v[252:255], v[56:59], v[96:99], v[252:255]
    s_add_u32 m0, s67, 34304
    s_waitcnt lgkmcnt(10)
    v_mfma_f32_16x16x32_bf16 v[160:163], v[28:31], v[100:103], v[160:163]
    buffer_load_dwordx4 v18, s[4:7], s65 offen offset:512 lds
    v_mfma_f32_16x16x32_bf16 v[192:195], v[28:31], v[104:107], v[192:195]
    v_mfma_f32_16x16x32_bf16 v[224:227], v[28:31], v[108:111], v[224:227]
    s_add_u32 m0, s67, 35328
    v_mfma_f32_16x16x32_bf16 v[164:167], v[32:35], v[100:103], v[164:167]
    buffer_load_dwordx4 v19, s[4:7], s65 offen offset:512 lds
    ds_read_b64_tr_b16 v[56:57], v27 offset:24576
    ds_read_b64_tr_b16 v[58:59], v27 offset:24832
    v_mfma_f32_16x16x32_bf16 v[196:199], v[32:35], v[104:107], v[196:199]
    v_mfma_f32_16x16x32_bf16 v[228:231], v[32:35], v[108:111], v[228:231]
    s_add_u32 m0, s67, 36352
    s_waitcnt lgkmcnt(8)
    v_mfma_f32_16x16x32_bf16 v[168:171], v[36:39], v[100:103], v[168:171]
    buffer_load_dwordx4 v18, s[4:7], s66 offen offset:512 lds
    v_mfma_f32_16x16x32_bf16 v[200:203], v[36:39], v[104:107], v[200:203]
    v_mfma_f32_16x16x32_bf16 v[232:235], v[36:39], v[108:111], v[232:235]
    s_add_u32 m0, s67, 37376
    v_mfma_f32_16x16x32_bf16 v[172:175], v[40:43], v[100:103], v[172:175]
    buffer_load_dwordx4 v19, s[4:7], s66 offen offset:512 lds
    v_mfma_f32_16x16x32_bf16 v[204:207], v[40:43], v[104:107], v[204:207]
    v_mfma_f32_16x16x32_bf16 v[236:239], v[40:43], v[108:111], v[236:239]
    s_waitcnt vmcnt(16) lgkmcnt(0)
    s_barrier
    v_mfma_f32_16x16x32_bf16 v[176:179], v[44:47], v[100:103], v[176:179]
    ds_read_b64_tr_b16 v[28:29], v20 offset:0
    ds_read_b64_tr_b16 v[30:31], v20 offset:256
    s_add_u32 m0, s68, 24576
    v_mfma_f32_16x16x32_bf16 v[208:211], v[44:47], v[104:107], v[208:211]
    buffer_load_dwordx4 v16, s[8:11], s28 offen lds
    ds_read_b64_tr_b16 v[32:33], v24 offset:0
    ds_read_b64_tr_b16 v[34:35], v24 offset:256
    v_mfma_f32_16x16x32_bf16 v[240:243], v[44:47], v[108:111], v[240:243]
    ds_read_b64_tr_b16 v[36:37], v21 offset:0
    ds_read_b64_tr_b16 v[38:39], v21 offset:256
    s_add_u32 m0, s68, 25600
    v_mfma_f32_16x16x32_bf16 v[180:183], v[48:51], v[100:103], v[180:183]
    buffer_load_dwordx4 v17, s[8:11], s28 offen lds
    ds_read_b64_tr_b16 v[40:41], v25 offset:0
    ds_read_b64_tr_b16 v[42:43], v25 offset:256
    v_mfma_f32_16x16x32_bf16 v[212:215], v[48:51], v[104:107], v[212:215]
    ds_read_b64_tr_b16 v[44:45], v22 offset:0
    ds_read_b64_tr_b16 v[46:47], v22 offset:256
    v_mfma_f32_16x16x32_bf16 v[244:247], v[48:51], v[108:111], v[244:247]
    v_mfma_f32_16x16x32_bf16 v[184:187], v[52:55], v[100:103], v[184:187]
    ds_read_b64_tr_b16 v[48:49], v26 offset:0
    ds_read_b64_tr_b16 v[50:51], v26 offset:256
    v_mfma_f32_16x16x32_bf16 v[216:219], v[52:55], v[104:107], v[216:219]
    v_mfma_f32_16x16x32_bf16 v[248:251], v[52:55], v[108:111], v[248:251]
    v_mfma_f32_16x16x32_bf16 v[188:191], v[56:59], v[100:103], v[188:191]
    ds_read_b64_tr_b16 v[52:53], v23 offset:0
    ds_read_b64_tr_b16 v[54:55], v23 offset:256
    v_mfma_f32_16x16x32_bf16 v[220:223], v[56:59], v[104:107], v[220:223]
    s_add_u32 s28, s28, 0x40000
    v_mfma_f32_16x16x32_bf16 v[252:255], v[56:59], v[108:111], v[252:255]
    s_waitcnt lgkmcnt(10)
    v_mfma_f32_16x16x32_bf16 v[160:163], v[28:31], v[64:67], v[160:163]
    v_mfma_f32_16x16x32_bf16 v[192:195], v[28:31], v[68:71], v[192:195]
    v_mfma_f32_16x16x32_bf16 v[224:227], v[28:31], v[72:75], v[224:227]
    v_mfma_f32_16x16x32_bf16 v[164:167], v[32:35], v[64:67], v[164:167]
    s_waitcnt vmcnt(12)
    ds_read_b64_tr_b16 v[56:57], v27 offset:0
    ds_read_b64_tr_b16 v[58:59], v27 offset:256
    v_mfma_f32_16x16x32_bf16 v[196:199], v[32:35], v[68:71], v[196:199]
    ds_read_b128 v[88:91], v60 offset:24576
    v_mfma_f32_16x16x32_bf16 v[228:231], v[32:35], v[72:75], v[228:231]
    ds_read_b128 v[92:95], v60 offset:26624
    s_waitcnt lgkmcnt(10)
    v_mfma_f32_16x16x32_bf16 v[168:171], v[36:39], v[64:67], v[168:171]
    ds_read_b128 v[96:99], v60 offset:28672
    v_mfma_f32_16x16x32_bf16 v[200:203], v[36:39], v[68:71], v[200:203]
    ds_read_b128 v[100:103], v61 offset:24576
    v_mfma_f32_16x16x32_bf16 v[232:235], v[36:39], v[72:75], v[232:235]
    ds_read_b128 v[104:107], v61 offset:26624
    v_mfma_f32_16x16x32_bf16 v[172:175], v[40:43], v[64:67], v[172:175]
    ds_read_b128 v[108:111], v61 offset:28672
    v_mfma_f32_16x16x32_bf16 v[204:207], v[40:43], v[68:71], v[204:207]
    v_mfma_f32_16x16x32_bf16 v[236:239], v[40:43], v[72:75], v[236:239]
    s_waitcnt vmcnt(10) lgkmcnt(0)
    s_barrier
    v_mfma_f32_16x16x32_bf16 v[176:179], v[44:47], v[64:67], v[176:179]
    ds_read_b64_tr_b16 v[28:29], v20 offset:8192
    ds_read_b64_tr_b16 v[30:31], v20 offset:8448
    s_add_u32 m0, s68, 0
    v_mfma_f32_16x16x32_bf16 v[208:211], v[44:47], v[68:71], v[208:211]
    buffer_load_dwordx4 v16, s[8:11], s28 offen lds
    ds_read_b64_tr_b16 v[32:33], v24 offset:8192
    ds_read_b64_tr_b16 v[34:35], v24 offset:8448
    v_mfma_f32_16x16x32_bf16 v[240:243], v[44:47], v[72:75], v[240:243]
    ds_read_b64_tr_b16 v[36:37], v21 offset:8192
    ds_read_b64_tr_b16 v[38:39], v21 offset:8448
    s_add_u32 m0, s68, 1024
    v_mfma_f32_16x16x32_bf16 v[180:183], v[48:51], v[64:67], v[180:183]
    buffer_load_dwordx4 v17, s[8:11], s28 offen lds
    ds_read_b64_tr_b16 v[40:41], v25 offset:8192
    ds_read_b64_tr_b16 v[42:43], v25 offset:8448
    v_mfma_f32_16x16x32_bf16 v[212:215], v[48:51], v[68:71], v[212:215]
    ds_read_b64_tr_b16 v[44:45], v22 offset:8192
    ds_read_b64_tr_b16 v[46:47], v22 offset:8448
    v_mfma_f32_16x16x32_bf16 v[244:247], v[48:51], v[72:75], v[244:247]
    s_add_u32 m0, s67, 56704
    v_mfma_f32_16x16x32_bf16 v[184:187], v[52:55], v[64:67], v[184:187]
    buffer_load_dwordx4 v18, s[4:7], s64 offen offset:640 lds
    ds_read_b64_tr_b16 v[48:49], v26 offset:8192
    ds_read_b64_tr_b16 v[50:51], v26 offset:8448
    v_mfma_f32_16x16x32_bf16 v[216:219], v[52:55], v[68:71], v[216:219]
    v_mfma_f32_16x16x32_bf16 v[248:251], v[52:55], v[72:75], v[248:251]
    s_add_u32 m0, s67, 57728
    v_mfma_f32_16x16x32_bf16 v[188:191], v[56:59], v[64:67], v[188:191]
    buffer_load_dwordx4 v19, s[4:7], s64 offen offset:640 lds
    ds_read_b64_tr_b16 v[52:53], v23 offset:8192
    ds_read_b64_tr_b16 v[54:55], v23 offset:8448
    v_mfma_f32_16x16x32_bf16 v[220:223], v[56:59], v[68:71], v[220:223]
    s_add_u32 s28, s28, 0x40000
    v_mfma_f32_16x16x32_bf16 v[252:255], v[56:59], v[72:75], v[252:255]
    s_add_u32 m0, s67, 58752
    s_waitcnt lgkmcnt(10)
    v_mfma_f32_16x16x32_bf16 v[160:163], v[28:31], v[76:79], v[160:163]
    buffer_load_dwordx4 v18, s[4:7], s65 offen offset:640 lds
    v_mfma_f32_16x16x32_bf16 v[192:195], v[28:31], v[80:83], v[192:195]
    v_mfma_f32_16x16x32_bf16 v[224:227], v[28:31], v[84:87], v[224:227]
    s_add_u32 m0, s67, 59776
    v_mfma_f32_16x16x32_bf16 v[164:167], v[32:35], v[76:79], v[164:167]
    buffer_load_dwordx4 v19, s[4:7], s65 offen offset:640 lds
    ds_read_b64_tr_b16 v[56:57], v27 offset:8192
    ds_read_b64_tr_b16 v[58:59], v27 offset:8448
    v_mfma_f32_16x16x32_bf16 v[196:199], v[32:35], v[80:83], v[196:199]
    v_mfma_f32_16x16x32_bf16 v[228:231], v[32:35], v[84:87], v[228:231]
    s_add_u32 m0, s67, 60800
    s_waitcnt lgkmcnt(8)
    v_mfma_f32_16x16x32_bf16 v[168:171], v[36:39], v[76:79], v[168:171]
    buffer_load_dwordx4 v18, s[4:7], s66 offen offset:640 lds
    v_mfma_f32_16x16x32_bf16 v[200:203], v[36:39], v[80:83], v[200:203]
    v_mfma_f32_16x16x32_bf16 v[232:235], v[36:39], v[84:87], v[232:235]
    s_add_u32 m0, s67, 61824
    v_mfma_f32_16x16x32_bf16 v[172:175], v[40:43], v[76:79], v[172:175]
    buffer_load_dwordx4 v19, s[4:7], s66 offen offset:640 lds
    v_mfma_f32_16x16x32_bf16 v[204:207], v[40:43], v[80:83], v[204:207]
    v_mfma_f32_16x16x32_bf16 v[236:239], v[40:43], v[84:87], v[236:239]
    s_waitcnt vmcnt(16) lgkmcnt(0)
    s_barrier
    v_mfma_f32_16x16x32_bf16 v[176:179], v[44:47], v[76:79], v[176:179]
    ds_read_b64_tr_b16 v[28:29], v20 offset:16384
    ds_read_b64_tr_b16 v[30:31], v20 offset:16640
    s_add_u32 m0, s68, 8192
    v_mfma_f32_16x16x32_bf16 v[208:211], v[44:47], v[80:83], v[208:211]
    buffer_load_dwordx4 v16, s[8:11], s28 offen lds
    ds_read_b64_tr_b16 v[32:33], v24 offset:16384
    ds_read_b64_tr_b16 v[34:35], v24 offset:16640
    v_mfma_f32_16x16x32_bf16 v[240:243], v[44:47], v[84:87], v[240:243]
    ds_read_b64_tr_b16 v[36:37], v21 offset:16384
    ds_read_b64_tr_b16 v[38:39], v21 offset:16640
    s_add_u32 m0, s68, 9216
    v_mfma_f32_16x16x32_bf16 v[180:183], v[48:51], v[76:79], v[180:183]
    buffer_load_dwordx4 v17, s[8:11], s28 offen lds
    ds_read_b64_tr_b16 v[40:41], v25 offset:16384
    ds_read_b64_tr_b16 v[42:43], v25 offset:16640
    v_mfma_f32_16x16x32_bf16 v[212:215], v[48:51], v[80:83], v[212:215]
    ds_read_b64_tr_b16 v[44:45], v22 offset:16384
    ds_read_b64_tr_b16 v[46:47], v22 offset:16640
    v_mfma_f32_16x16x32_bf16 v[244:247], v[48:51], v[84:87], v[244:247]
    v_mfma_f32_16x16x32_bf16 v[184:187], v[52:55], v[76:79], v[184:187]
    ds_read_b64_tr_b16 v[48:49], v26 offset:16384
    ds_read_b64_tr_b16 v[50:51], v26 offset:16640
    v_mfma_f32_16x16x32_bf16 v[216:219], v[52:55], v[80:83], v[216:219]
    v_mfma_f32_16x16x32_bf16 v[248:251], v[52:55], v[84:87], v[248:251]
    v_mfma_f32_16x16x32_bf16 v[188:191], v[56:59], v[76:79], v[188:191]
    ds_read_b64_tr_b16 v[52:53], v23 offset:16384
    ds_read_b64_tr_b16 v[54:55], v23 offset:16640
    v_mfma_f32_16x16x32_bf16 v[220:223], v[56:59], v[80:83], v[220:223]
    s_add_u32 s28, s28, 0x40000
    v_mfma_f32_16x16x32_bf16 v[252:255], v[56:59], v[84:87], v[252:255]
    s_waitcnt lgkmcnt(10)
    v_mfma_f32_16x16x32_bf16 v[160:163], v[28:31], v[88:91], v[160:163]
    v_mfma_f32_16x16x32_bf16 v[192:195], v[28:31], v[92:95], v[192:195]
    v_mfma_f32_16x16x32_bf16 v[224:227], v[28:31], v[96:99], v[224:227]
    v_mfma_f32_16x16x32_bf16 v[164:167], v[32:35], v[88:91], v[164:167]
    s_waitcnt vmcnt(12)
    ds_read_b64_tr_b16 v[56:57], v27 offset:16384
    ds_read_b64_tr_b16 v[58:59], v27 offset:16640
    v_mfma_f32_16x16x32_bf16 v[196:199], v[32:35], v[92:95], v[196:199]
    ds_read_b128 v[64:67], v60 offset:0
    v_mfma_f32_16x16x32_bf16 v[228:231], v[32:35], v[96:99], v[228:231]
    ds_read_b128 v[68:71], v60 offset:2048
    s_waitcnt lgkmcnt(10)
    v_mfma_f32_16x16x32_bf16 v[168:171], v[36:39], v[88:91], v[168:171]
    ds_read_b128 v[72:75], v60 offset:4096
    v_mfma_f32_16x16x32_bf16 v[200:203], v[36:39], v[92:95], v[200:203]
    ds_read_b128 v[76:79], v61 offset:0
    v_mfma_f32_16x16x32_bf16 v[232:235], v[36:39], v[96:99], v[232:235]
    ds_read_b128 v[80:83], v61 offset:2048
    v_mfma_f32_16x16x32_bf16 v[172:175], v[40:43], v[88:91], v[172:175]
    ds_read_b128 v[84:87], v61 offset:4096
    v_mfma_f32_16x16x32_bf16 v[204:207], v[40:43], v[92:95], v[204:207]
    v_mfma_f32_16x16x32_bf16 v[236:239], v[40:43], v[96:99], v[236:239]
    s_waitcnt vmcnt(10) lgkmcnt(0)
    s_barrier
    v_mfma_f32_16x16x32_bf16 v[176:179], v[44:47], v[88:91], v[176:179]
    ds_read_b64_tr_b16 v[28:29], v20 offset:24576
    ds_read_b64_tr_b16 v[30:31], v20 offset:24832
    s_add_u32 m0, s68, 16384
    v_mfma_f32_16x16x32_bf16 v[208:211], v[44:47], v[92:95], v[208:211]
    buffer_load_dwordx4 v16, s[8:11], s28 offen lds
    ds_read_b64_tr_b16 v[32:33], v24 offset:24576
    ds_read_b64_tr_b16 v[34:35], v24 offset:24832
    v_mfma_f32_16x16x32_bf16 v[240:243], v[44:47], v[96:99], v[240:243]
    ds_read_b64_tr_b16 v[36:37], v21 offset:24576
    ds_read_b64_tr_b16 v[38:39], v21 offset:24832
    s_add_u32 m0, s68, 17408
    v_mfma_f32_16x16x32_bf16 v[180:183], v[48:51], v[88:91], v[180:183]
    buffer_load_dwordx4 v17, s[8:11], s28 offen lds
    ds_read_b64_tr_b16 v[40:41], v25 offset:24576
    ds_read_b64_tr_b16 v[42:43], v25 offset:24832
    v_mfma_f32_16x16x32_bf16 v[212:215], v[48:51], v[92:95], v[212:215]
    ds_read_b64_tr_b16 v[44:45], v22 offset:24576
    ds_read_b64_tr_b16 v[46:47], v22 offset:24832
    v_mfma_f32_16x16x32_bf16 v[244:247], v[48:51], v[96:99], v[244:247]
    s_add_u32 m0, s67, 32000
    v_mfma_f32_16x16x32_bf16 v[184:187], v[52:55], v[88:91], v[184:187]
    buffer_load_dwordx4 v18, s[4:7], s64 offen offset:768 lds
    ds_read_b64_tr_b16 v[48:49], v26 offset:24576
    ds_read_b64_tr_b16 v[50:51], v26 offset:24832
    v_mfma_f32_16x16x32_bf16 v[216:219], v[52:55], v[92:95], v[216:219]
    v_mfma_f32_16x16x32_bf16 v[248:251], v[52:55], v[96:99], v[248:251]
    s_add_u32 m0, s67, 33024
    v_mfma_f32_16x16x32_bf16 v[188:191], v[56:59], v[88:91], v[188:191]
    buffer_load_dwordx4 v19, s[4:7], s64 offen offset:768 lds
    ds_read_b64_tr_b16 v[52:53], v23 offset:24576
    ds_read_b64_tr_b16 v[54:55], v23 offset:24832
    v_mfma_f32_16x16x32_bf16 v[220:223], v[56:59], v[92:95], v[220:223]
    s_add_u32 s28, s28, 0x40000
    v_mfma_f32_16x16x32_bf16 v[252:255], v[56:59], v[96:99], v[252:255]
    s_add_u32 m0, s67, 34048
    s_waitcnt lgkmcnt(10)
    v_mfma_f32_16x16x32_bf16 v[160:163], v[28:31], v[100:103], v[160:163]
    buffer_load_dwordx4 v18, s[4:7], s65 offen offset:768 lds
    v_mfma_f32_16x16x32_bf16 v[192:195], v[28:31], v[104:107], v[192:195]
    v_mfma_f32_16x16x32_bf16 v[224:227], v[28:31], v[108:111], v[224:227]
    s_add_u32 m0, s67, 35072
    v_mfma_f32_16x16x32_bf16 v[164:167], v[32:35], v[100:103], v[164:167]
    buffer_load_dwordx4 v19, s[4:7], s65 offen offset:768 lds
    ds_read_b64_tr_b16 v[56:57], v27 offset:24576
    ds_read_b64_tr_b16 v[58:59], v27 offset:24832
    v_mfma_f32_16x16x32_bf16 v[196:199], v[32:35], v[104:107], v[196:199]
    v_mfma_f32_16x16x32_bf16 v[228:231], v[32:35], v[108:111], v[228:231]
    s_add_u32 m0, s67, 36096
    s_waitcnt lgkmcnt(8)
    v_mfma_f32_16x16x32_bf16 v[168:171], v[36:39], v[100:103], v[168:171]
    buffer_load_dwordx4 v18, s[4:7], s66 offen offset:768 lds
    v_mfma_f32_16x16x32_bf16 v[200:203], v[36:39], v[104:107], v[200:203]
    v_mfma_f32_16x16x32_bf16 v[232:235], v[36:39], v[108:111], v[232:235]
    s_add_u32 m0, s67, 37120
    v_mfma_f32_16x16x32_bf16 v[172:175], v[40:43], v[100:103], v[172:175]
    buffer_load_dwordx4 v19, s[4:7], s66 offen offset:768 lds
    v_mfma_f32_16x16x32_bf16 v[204:207], v[40:43], v[104:107], v[204:207]
    v_mfma_f32_16x16x32_bf16 v[236:239], v[40:43], v[108:111], v[236:239]
    s_waitcnt vmcnt(16) lgkmcnt(0)
    s_barrier
    v_mfma_f32_16x16x32_bf16 v[176:179], v[44:47], v[100:103], v[176:179]
    ds_read_b64_tr_b16 v[28:29], v20 offset:0
    ds_read_b64_tr_b16 v[30:31], v20 offset:256
    s_add_u32 m0, s68, 24576
    v_mfma_f32_16x16x32_bf16 v[208:211], v[44:47], v[104:107], v[208:211]
    buffer_load_dwordx4 v16, s[8:11], s28 offen lds
    ds_read_b64_tr_b16 v[32:33], v24 offset:0
    ds_read_b64_tr_b16 v[34:35], v24 offset:256
    v_mfma_f32_16x16x32_bf16 v[240:243], v[44:47], v[108:111], v[240:243]
    ds_read_b64_tr_b16 v[36:37], v21 offset:0
    ds_read_b64_tr_b16 v[38:39], v21 offset:256
    s_add_u32 m0, s68, 25600
    v_mfma_f32_16x16x32_bf16 v[180:183], v[48:51], v[100:103], v[180:183]
    buffer_load_dwordx4 v17, s[8:11], s28 offen lds
    ds_read_b64_tr_b16 v[40:41], v25 offset:0
    ds_read_b64_tr_b16 v[42:43], v25 offset:256
    v_mfma_f32_16x16x32_bf16 v[212:215], v[48:51], v[104:107], v[212:215]
    ds_read_b64_tr_b16 v[44:45], v22 offset:0
    ds_read_b64_tr_b16 v[46:47], v22 offset:256
    v_mfma_f32_16x16x32_bf16 v[244:247], v[48:51], v[108:111], v[244:247]
    v_mfma_f32_16x16x32_bf16 v[184:187], v[52:55], v[100:103], v[184:187]
    ds_read_b64_tr_b16 v[48:49], v26 offset:0
    ds_read_b64_tr_b16 v[50:51], v26 offset:256
    v_mfma_f32_16x16x32_bf16 v[216:219], v[52:55], v[104:107], v[216:219]
    v_mfma_f32_16x16x32_bf16 v[248:251], v[52:55], v[108:111], v[248:251]
    v_mfma_f32_16x16x32_bf16 v[188:191], v[56:59], v[100:103], v[188:191]
    ds_read_b64_tr_b16 v[52:53], v23 offset:0
    ds_read_b64_tr_b16 v[54:55], v23 offset:256
    v_mfma_f32_16x16x32_bf16 v[220:223], v[56:59], v[104:107], v[220:223]
    s_add_u32 s28, s28, 0x40000
    v_mfma_f32_16x16x32_bf16 v[252:255], v[56:59], v[108:111], v[252:255]
    s_waitcnt lgkmcnt(10)
    v_mfma_f32_16x16x32_bf16 v[160:163], v[28:31], v[64:67], v[160:163]
    v_mfma_f32_16x16x32_bf16 v[192:195], v[28:31], v[68:71], v[192:195]
    v_mfma_f32_16x16x32_bf16 v[224:227], v[28:31], v[72:75], v[224:227]
    v_mfma_f32_16x16x32_bf16 v[164:167], v[32:35], v[64:67], v[164:167]
    s_waitcnt vmcnt(12)
    ds_read_b64_tr_b16 v[56:57], v27 offset:0
    ds_read_b64_tr_b16 v[58:59], v27 offset:256
    v_mfma_f32_16x16x32_bf16 v[196:199], v[32:35], v[68:71], v[196:199]
    ds_read_b128 v[88:91], v60 offset:24576
    v_mfma_f32_16x16x32_bf16 v[228:231], v[32:35], v[72:75], v[228:231]
    ds_read_b128 v[92:95], v60 offset:26624
    s_waitcnt lgkmcnt(10)
    v_mfma_f32_16x16x32_bf16 v[168:171], v[36:39], v[64:67], v[168:171]
    ds_read_b128 v[96:99], v60 offset:28672
    v_mfma_f32_16x16x32_bf16 v[200:203], v[36:39], v[68:71], v[200:203]
    ds_read_b128 v[100:103], v61 offset:24576
    v_mfma_f32_16x16x32_bf16 v[232:235], v[36:39], v[72:75], v[232:235]
    ds_read_b128 v[104:107], v61 offset:26624
    v_mfma_f32_16x16x32_bf16 v[172:175], v[40:43], v[64:67], v[172:175]
    ds_read_b128 v[108:111], v61 offset:28672
    v_mfma_f32_16x16x32_bf16 v[204:207], v[40:43], v[68:71], v[204:207]
    v_mfma_f32_16x16x32_bf16 v[236:239], v[40:43], v[72:75], v[236:239]
    s_waitcnt vmcnt(10) lgkmcnt(0)
    s_barrier
    v_mfma_f32_16x16x32_bf16 v[176:179], v[44:47], v[64:67], v[176:179]
    ds_read_b64_tr_b16 v[28:29], v20 offset:8192
    ds_read_b64_tr_b16 v[30:31], v20 offset:8448
    s_add_u32 m0, s68, 0
    v_mfma_f32_16x16x32_bf16 v[208:211], v[44:47], v[68:71], v[208:211]
    buffer_load_dwordx4 v16, s[8:11], s28 offen lds
    ds_read_b64_tr_b16 v[32:33], v24 offset:8192
    ds_read_b64_tr_b16 v[34:35], v24 offset:8448
    v_mfma_f32_16x16x32_bf16 v[240:243], v[44:47], v[72:75], v[240:243]
    ds_read_b64_tr_b16 v[36:37], v21 offset:8192
    ds_read_b64_tr_b16 v[38:39], v21 offset:8448
    s_add_u32 m0, s68, 1024
    v_mfma_f32_16x16x32_bf16 v[180:183], v[48:51], v[64:67], v[180:183]
    buffer_load_dwordx4 v17, s[8:11], s28 offen lds
    ds_read_b64_tr_b16 v[40:41], v25 offset:8192
    ds_read_b64_tr_b16 v[42:43], v25 offset:8448
    v_mfma_f32_16x16x32_bf16 v[212:215], v[48:51], v[68:71], v[212:215]
    ds_read_b64_tr_b16 v[44:45], v22 offset:8192
    ds_read_b64_tr_b16 v[46:47], v22 offset:8448
    v_mfma_f32_16x16x32_bf16 v[244:247], v[48:51], v[72:75], v[244:247]
    s_add_u32 m0, s67, 56448
    v_mfma_f32_16x16x32_bf16 v[184:187], v[52:55], v[64:67], v[184:187]
    buffer_load_dwordx4 v18, s[4:7], s64 offen offset:896 lds
    ds_read_b64_tr_b16 v[48:49], v26 offset:8192
    ds_read_b64_tr_b16 v[50:51], v26 offset:8448
    v_mfma_f32_16x16x32_bf16 v[216:219], v[52:55], v[68:71], v[216:219]
    v_mfma_f32_16x16x32_bf16 v[248:251], v[52:55], v[72:75], v[248:251]
    s_add_u32 m0, s67, 57472
    v_mfma_f32_16x16x32_bf16 v[188:191], v[56:59], v[64:67], v[188:191]
    buffer_load_dwordx4 v19, s[4:7], s64 offen offset:896 lds
    ds_read_b64_tr_b16 v[52:53], v23 offset:8192
    ds_read_b64_tr_b16 v[54:55], v23 offset:8448
    v_mfma_f32_16x16x32_bf16 v[220:223], v[56:59], v[68:71], v[220:223]
    s_add_u32 s28, s28, 0x40000
    v_mfma_f32_16x16x32_bf16 v[252:255], v[56:59], v[72:75], v[252:255]
    s_add_u32 m0, s67, 58496
    s_waitcnt lgkmcnt(10)
    v_mfma_f32_16x16x32_bf16 v[160:163], v[28:31], v[76:79], v[160:163]
    buffer_load_dwordx4 v18, s[4:7], s65 offen offset:896 lds
    v_mfma_f32_16x16x32_bf16 v[192:195], v[28:31], v[80:83], v[192:195]
    v_mfma_f32_16x16x32_bf16 v[224:227], v[28:31], v[84:87], v[224:227]
    s_add_u32 m0, s67, 59520
    v_mfma_f32_16x16x32_bf16 v[164:167], v[32:35], v[76:79], v[164:167]
    buffer_load_dwordx4 v19, s[4:7], s65 offen offset:896 lds
    ds_read_b64_tr_b16 v[56:57], v27 offset:8192
    ds_read_b64_tr_b16 v[58:59], v27 offset:8448
    v_mfma_f32_16x16x32_bf16 v[196:199], v[32:35], v[80:83], v[196:199]
    v_mfma_f32_16x16x32_bf16 v[228:231], v[32:35], v[84:87], v[228:231]
    s_add_u32 m0, s67, 60544
    s_waitcnt lgkmcnt(8)
    v_mfma_f32_16x16x32_bf16 v[168:171], v[36:39], v[76:79], v[168:171]
    buffer_load_dwordx4 v18, s[4:7], s66 offen offset:896 lds
    v_mfma_f32_16x16x32_bf16 v[200:203], v[36:39], v[80:83], v[200:203]
    v_mfma_f32_16x16x32_bf16 v[232:235], v[36:39], v[84:87], v[232:235]
    s_add_u32 m0, s67, 61568
    v_mfma_f32_16x16x32_bf16 v[172:175], v[40:43], v[76:79], v[172:175]
    buffer_load_dwordx4 v19, s[4:7], s66 offen offset:896 lds
    v_mfma_f32_16x16x32_bf16 v[204:207], v[40:43], v[80:83], v[204:207]
    v_mfma_f32_16x16x32_bf16 v[236:239], v[40:43], v[84:87], v[236:239]
    s_waitcnt vmcnt(16) lgkmcnt(0)
    s_barrier
    v_mfma_f32_16x16x32_bf16 v[176:179], v[44:47], v[76:79], v[176:179]
    ds_read_b64_tr_b16 v[28:29], v20 offset:16384
    ds_read_b64_tr_b16 v[30:31], v20 offset:16640
    s_add_u32 m0, s68, 8192
    v_mfma_f32_16x16x32_bf16 v[208:211], v[44:47], v[80:83], v[208:211]
    buffer_load_dwordx4 v16, s[8:11], s28 offen lds
    ds_read_b64_tr_b16 v[32:33], v24 offset:16384
    ds_read_b64_tr_b16 v[34:35], v24 offset:16640
    v_mfma_f32_16x16x32_bf16 v[240:243], v[44:47], v[84:87], v[240:243]
    ds_read_b64_tr_b16 v[36:37], v21 offset:16384
    ds_read_b64_tr_b16 v[38:39], v21 offset:16640
    s_add_u32 m0, s68, 9216
    v_mfma_f32_16x16x32_bf16 v[180:183], v[48:51], v[76:79], v[180:183]
    buffer_load_dwordx4 v17, s[8:11], s28 offen lds
    ds_read_b64_tr_b16 v[40:41], v25 offset:16384
    ds_read_b64_tr_b16 v[42:43], v25 offset:16640
    v_mfma_f32_16x16x32_bf16 v[212:215], v[48:51], v[80:83], v[212:215]
    ds_read_b64_tr_b16 v[44:45], v22 offset:16384
    ds_read_b64_tr_b16 v[46:47], v22 offset:16640
    v_mfma_f32_16x16x32_bf16 v[244:247], v[48:51], v[84:87], v[244:247]
    v_mfma_f32_16x16x32_bf16 v[184:187], v[52:55], v[76:79], v[184:187]
    ds_read_b64_tr_b16 v[48:49], v26 offset:16384
    ds_read_b64_tr_b16 v[50:51], v26 offset:16640
    v_mfma_f32_16x16x32_bf16 v[216:219], v[52:55], v[80:83], v[216:219]
    v_mfma_f32_16x16x32_bf16 v[248:251], v[52:55], v[84:87], v[248:251]
    v_mfma_f32_16x16x32_bf16 v[188:191], v[56:59], v[76:79], v[188:191]
    ds_read_b64_tr_b16 v[52:53], v23 offset:16384
    ds_read_b64_tr_b16 v[54:55], v23 offset:16640
    v_mfma_f32_16x16x32_bf16 v[220:223], v[56:59], v[80:83], v[220:223]
    s_add_u32 s28, s28, 0x40000
    v_mfma_f32_16x16x32_bf16 v[252:255], v[56:59], v[84:87], v[252:255]
    s_waitcnt lgkmcnt(10)
    v_mfma_f32_16x16x32_bf16 v[160:163], v[28:31], v[88:91], v[160:163]
    v_mfma_f32_16x16x32_bf16 v[192:195], v[28:31], v[92:95], v[192:195]
    v_mov_b32 v62, 0
    v_mfma_f32_16x16x32_bf16 v[224:227], v[28:31], v[96:99], v[224:227]
    v_mfma_f32_16x16x32_bf16 v[164:167], v[32:35], v[88:91], v[164:167]
    s_waitcnt vmcnt(12)
    ds_read_b64_tr_b16 v[56:57], v27 offset:16384
    ds_read_b64_tr_b16 v[58:59], v27 offset:16640
    v_mfma_f32_16x16x32_bf16 v[196:199], v[32:35], v[92:95], v[196:199]
    ds_read_b128 v[64:67], v60 offset:0
    v_mfma_f32_16x16x32_bf16 v[228:231], v[32:35], v[96:99], v[228:231]
    ds_read_b128 v[68:71], v60 offset:2048
    s_waitcnt lgkmcnt(10)
    v_mfma_f32_16x16x32_bf16 v[168:171], v[36:39], v[88:91], v[168:171]
    ds_read_b128 v[72:75], v60 offset:4096
    v_mfma_f32_16x16x32_bf16 v[200:203], v[36:39], v[92:95], v[200:203]
    ds_read_b128 v[76:79], v61 offset:0
    v_mfma_f32_16x16x32_bf16 v[232:235], v[36:39], v[96:99], v[232:235]
    ds_read_b128 v[80:83], v61 offset:2048
    v_mfma_f32_16x16x32_bf16 v[172:175], v[40:43], v[88:91], v[172:175]
    ds_read_b128 v[84:87], v61 offset:4096
    v_mfma_f32_16x16x32_bf16 v[204:207], v[40:43], v[92:95], v[204:207]
    v_mfma_f32_16x16x32_bf16 v[236:239], v[40:43], v[96:99], v[236:239]
    buffer_load_dword v63, v62, s[96:99], 0 offen sc1
    s_waitcnt vmcnt(11) lgkmcnt(0)
    s_barrier
    v_mfma_f32_16x16x32_bf16 v[176:179], v[44:47], v[88:91], v[176:179]
    ds_read_b64_tr_b16 v[28:29], v20 offset:24576
    ds_read_b64_tr_b16 v[30:31], v20 offset:24832
    s_add_u32 m0, s68, 16384
    v_mfma_f32_16x16x32_bf16 v[208:211], v[44:47], v[92:95], v[208:211]
    buffer_load_dwordx4 v16, s[8:11], s28 offen lds
    ds_read_b64_tr_b16 v[32:33], v24 offset:24576
    ds_read_b64_tr_b16 v[34:35], v24 offset:24832
    v_mfma_f32_16x16x32_bf16 v[240:243], v[44:47], v[96:99], v[240:243]
    ds_read_b64_tr_b16 v[36:37], v21 offset:24576
    ds_read_b64_tr_b16 v[38:39], v21 offset:24832
    s_add_u32 m0, s68, 17408
    v_mfma_f32_16x16x32_bf16 v[180:183], v[48:51], v[88:91], v[180:183]
    buffer_load_dwordx4 v17, s[8:11], s28 offen lds
    ds_read_b64_tr_b16 v[40:41], v25 offset:24576
    ds_read_b64_tr_b16 v[42:43], v25 offset:24832
    v_mfma_f32_16x16x32_bf16 v[212:215], v[48:51], v[92:95], v[212:215]
    ds_read_b64_tr_b16 v[44:45], v22 offset:24576
    ds_read_b64_tr_b16 v[46:47], v22 offset:24832
    v_mfma_f32_16x16x32_bf16 v[244:247], v[48:51], v[96:99], v[244:247]
    s_add_u32 m0, s67, 31744
    v_mfma_f32_16x16x32_bf16 v[184:187], v[52:55], v[88:91], v[184:187]
    buffer_load_dwordx4 v18, s[4:7], s64 offen offset:1024 lds
    ds_read_b64_tr_b16 v[48:49], v26 offset:24576
    ds_read_b64_tr_b16 v[50:51], v26 offset:24832
    v_mfma_f32_16x16x32_bf16 v[216:219], v[52:55], v[92:95], v[216:219]
    v_mfma_f32_16x16x32_bf16 v[248:251], v[52:55], v[96:99], v[248:251]
    s_add_u32 m0, s67, 32768
    v_mfma_f32_16x16x32_bf16 v[188:191], v[56:59], v[88:91], v[188:191]
    buffer_load_dwordx4 v19, s[4:7], s64 offen offset:1024 lds
    ds_read_b64_tr_b16 v[52:53], v23 offset:24576
    ds_read_b64_tr_b16 v[54:55], v23 offset:24832
    v_mfma_f32_16x16x32_bf16 v[220:223], v[56:59], v[92:95], v[220:223]
    s_add_u32 s28, s28, 0x40000
    v_mfma_f32_16x16x32_bf16 v[252:255], v[56:59], v[96:99], v[252:255]
    s_add_u32 m0, s67, 33792
    s_waitcnt lgkmcnt(10)
    v_mfma_f32_16x16x32_bf16 v[160:163], v[28:31], v[100:103], v[160:163]
    buffer_load_dwordx4 v18, s[4:7], s65 offen offset:1024 lds
    v_mfma_f32_16x16x32_bf16 v[192:195], v[28:31], v[104:107], v[192:195]
    v_mfma_f32_16x16x32_bf16 v[224:227], v[28:31], v[108:111], v[224:227]
    s_add_u32 m0, s67, 34816
    v_mfma_f32_16x16x32_bf16 v[164:167], v[32:35], v[100:103], v[164:167]
    buffer_load_dwordx4 v19, s[4:7], s65 offen offset:1024 lds
    ds_read_b64_tr_b16 v[56:57], v27 offset:24576
    ds_read_b64_tr_b16 v[58:59], v27 offset:24832
    v_mfma_f32_16x16x32_bf16 v[196:199], v[32:35], v[104:107], v[196:199]
    v_mfma_f32_16x16x32_bf16 v[228:231], v[32:35], v[108:111], v[228:231]
    s_add_u32 m0, s67, 35840
    s_waitcnt lgkmcnt(8)
    v_mfma_f32_16x16x32_bf16 v[168:171], v[36:39], v[100:103], v[168:171]
    buffer_load_dwordx4 v18, s[4:7], s66 offen offset:1024 lds
    v_mfma_f32_16x16x32_bf16 v[200:203], v[36:39], v[104:107], v[200:203]
    v_mfma_f32_16x16x32_bf16 v[232:235], v[36:39], v[108:111], v[232:235]
    s_add_u32 m0, s67, 36864
    v_mfma_f32_16x16x32_bf16 v[172:175], v[40:43], v[100:103], v[172:175]
    buffer_load_dwordx4 v19, s[4:7], s66 offen offset:1024 lds
    v_mfma_f32_16x16x32_bf16 v[204:207], v[40:43], v[104:107], v[204:207]
    v_mfma_f32_16x16x32_bf16 v[236:239], v[40:43], v[108:111], v[236:239]
    s_waitcnt vmcnt(17) lgkmcnt(0)
    s_barrier
    v_mfma_f32_16x16x32_bf16 v[176:179], v[44:47], v[100:103], v[176:179]
    ds_read_b64_tr_b16 v[28:29], v20 offset:0
    ds_read_b64_tr_b16 v[30:31], v20 offset:256
    s_add_u32 m0, s68, 24576
    v_mfma_f32_16x16x32_bf16 v[208:211], v[44:47], v[104:107], v[208:211]
    buffer_load_dwordx4 v16, s[8:11], s28 offen lds
    ds_read_b64_tr_b16 v[32:33], v24 offset:0
    ds_read_b64_tr_b16 v[34:35], v24 offset:256
    v_mfma_f32_16x16x32_bf16 v[240:243], v[44:47], v[108:111], v[240:243]
    ds_read_b64_tr_b16 v[36:37], v21 offset:0
    ds_read_b64_tr_b16 v[38:39], v21 offset:256
    s_add_u32 m0, s68, 25600
    v_mfma_f32_16x16x32_bf16 v[180:183], v[48:51], v[100:103], v[180:183]
    buffer_load_dwordx4 v17, s[8:11], s28 offen lds
    ds_read_b64_tr_b16 v[40:41], v25 offset:0
    ds_read_b64_tr_b16 v[42:43], v25 offset:256
    v_mfma_f32_16x16x32_bf16 v[212:215], v[48:51], v[104:107], v[212:215]
    ds_read_b64_tr_b16 v[44:45], v22 offset:0
    ds_read_b64_tr_b16 v[46:47], v22 offset:256
    v_mfma_f32_16x16x32_bf16 v[244:247], v[48:51], v[108:111], v[244:247]
    v_mfma_f32_16x16x32_bf16 v[184:187], v[52:55], v[100:103], v[184:187]
    ds_read_b64_tr_b16 v[48:49], v26 offset:0
    ds_read_b64_tr_b16 v[50:51], v26 offset:256
    v_mfma_f32_16x16x32_bf16 v[216:219], v[52:55], v[104:107], v[216:219]
    v_mfma_f32_16x16x32_bf16 v[248:251], v[52:55], v[108:111], v[248:251]
    v_mfma_f32_16x16x32_bf16 v[188:191], v[56:59], v[100:103], v[188:191]
    ds_read_b64_tr_b16 v[52:53], v23 offset:0
    ds_read_b64_tr_b16 v[54:55], v23 offset:256
    v_mfma_f32_16x16x32_bf16 v[220:223], v[56:59], v[104:107], v[220:223]
    s_add_u32 s28, s28, 0x40000
    v_mfma_f32_16x16x32_bf16 v[252:255], v[56:59], v[108:111], v[252:255]
    s_waitcnt lgkmcnt(10)
    v_mfma_f32_16x16x32_bf16 v[160:163], v[28:31], v[64:67], v[160:163]
    v_mfma_f32_16x16x32_bf16 v[192:195], v[28:31], v[68:71], v[192:195]
    v_mfma_f32_16x16x32_bf16 v[224:227], v[28:31], v[72:75], v[224:227]
    v_mfma_f32_16x16x32_bf16 v[164:167], v[32:35], v[64:67], v[164:167]
    s_waitcnt vmcnt(13)
    ds_read_b64_tr_b16 v[56:57], v27 offset:0
    ds_read_b64_tr_b16 v[58:59], v27 offset:256
    v_mfma_f32_16x16x32_bf16 v[196:199], v[32:35], v[68:71], v[196:199]
    ds_read_b128 v[88:91], v60 offset:24576
    v_mfma_f32_16x16x32_bf16 v[228:231], v[32:35], v[72:75], v[228:231]
    ds_read_b128 v[92:95], v60 offset:26624
    s_waitcnt lgkmcnt(10)
    v_mfma_f32_16x16x32_bf16 v[168:171], v[36:39], v[64:67], v[168:171]
    ds_read_b128 v[96:99], v60 offset:28672
    v_mfma_f32_16x16x32_bf16 v[200:203], v[36:39], v[68:71], v[200:203]
    ds_read_b128 v[100:103], v61 offset:24576
    v_mfma_f32_16x16x32_bf16 v[232:235], v[36:39], v[72:75], v[232:235]
    ds_read_b128 v[104:107], v61 offset:26624
    v_mfma_f32_16x16x32_bf16 v[172:175], v[40:43], v[64:67], v[172:175]
    ds_read_b128 v[108:111], v61 offset:28672
    v_mfma_f32_16x16x32_bf16 v[204:207], v[40:43], v[68:71], v[204:207]
    v_mfma_f32_16x16x32_bf16 v[236:239], v[40:43], v[72:75], v[236:239]
    s_waitcnt vmcnt(11) lgkmcnt(0)
    s_barrier
    v_mfma_f32_16x16x32_bf16 v[176:179], v[44:47], v[64:67], v[176:179]
    ds_read_b64_tr_b16 v[28:29], v20 offset:8192
    ds_read_b64_tr_b16 v[30:31], v20 offset:8448
    s_add_u32 m0, s68, 0
    v_mfma_f32_16x16x32_bf16 v[208:211], v[44:47], v[68:71], v[208:211]
    buffer_load_dwordx4 v16, s[8:11], s28 offen lds
    ds_read_b64_tr_b16 v[32:33], v24 offset:8192
    ds_read_b64_tr_b16 v[34:35], v24 offset:8448
    v_mfma_f32_16x16x32_bf16 v[240:243], v[44:47], v[72:75], v[240:243]
    ds_read_b64_tr_b16 v[36:37], v21 offset:8192
    ds_read_b64_tr_b16 v[38:39], v21 offset:8448
    s_add_u32 m0, s68, 1024
    v_mfma_f32_16x16x32_bf16 v[180:183], v[48:51], v[64:67], v[180:183]
    buffer_load_dwordx4 v17, s[8:11], s28 offen lds
    ds_read_b64_tr_b16 v[40:41], v25 offset:8192
    ds_read_b64_tr_b16 v[42:43], v25 offset:8448
    v_mfma_f32_16x16x32_bf16 v[212:215], v[48:51], v[68:71], v[212:215]
    ds_read_b64_tr_b16 v[44:45], v22 offset:8192
    ds_read_b64_tr_b16 v[46:47], v22 offset:8448
    v_mfma_f32_16x16x32_bf16 v[244:247], v[48:51], v[72:75], v[244:247]
    s_add_u32 m0, s67, 56192
    v_mfma_f32_16x16x32_bf16 v[184:187], v[52:55], v[64:67], v[184:187]
    buffer_load_dwordx4 v18, s[4:7], s64 offen offset:1152 lds
    ds_read_b64_tr_b16 v[48:49], v26 offset:8192
    ds_read_b64_tr_b16 v[50:51], v26 offset:8448
    v_mfma_f32_16x16x32_bf16 v[216:219], v[52:55], v[68:71], v[216:219]
    v_mfma_f32_16x16x32_bf16 v[248:251], v[52:55], v[72:75], v[248:251]
    s_add_u32 m0, s67, 57216
    v_mfma_f32_16x16x32_bf16 v[188:191], v[56:59], v[64:67], v[188:191]
    buffer_load_dwordx4 v19, s[4:7], s64 offen offset:1152 lds
    ds_read_b64_tr_b16 v[52:53], v23 offset:8192
    ds_read_b64_tr_b16 v[54:55], v23 offset:8448
    v_mfma_f32_16x16x32_bf16 v[220:223], v[56:59], v[68:71], v[220:223]
    s_add_u32 s28, s28, 0x40000
    v_mfma_f32_16x16x32_bf16 v[252:255], v[56:59], v[72:75], v[252:255]
    s_add_u32 m0, s67, 58240
    s_waitcnt lgkmcnt(10)
    v_mfma_f32_16x16x32_bf16 v[160:163], v[28:31], v[76:79], v[160:163]
    buffer_load_dwordx4 v18, s[4:7], s65 offen offset:1152 lds
    v_mfma_f32_16x16x32_bf16 v[192:195], v[28:31], v[80:83], v[192:195]
    v_mfma_f32_16x16x32_bf16 v[224:227], v[28:31], v[84:87], v[224:227]
    s_add_u32 m0, s67, 59264
    v_mfma_f32_16x16x32_bf16 v[164:167], v[32:35], v[76:79], v[164:167]
    buffer_load_dwordx4 v19, s[4:7], s65 offen offset:1152 lds
    ds_read_b64_tr_b16 v[56:57], v27 offset:8192
    ds_read_b64_tr_b16 v[58:59], v27 offset:8448
    v_mfma_f32_16x16x32_bf16 v[196:199], v[32:35], v[80:83], v[196:199]
    v_mfma_f32_16x16x32_bf16 v[228:231], v[32:35], v[84:87], v[228:231]
    s_add_u32 m0, s67, 60288
    s_waitcnt lgkmcnt(8)
    v_mfma_f32_16x16x32_bf16 v[168:171], v[36:39], v[76:79], v[168:171]
    buffer_load_dwordx4 v18, s[4:7], s66 offen offset:1152 lds
    v_mfma_f32_16x16x32_bf16 v[200:203], v[36:39], v[80:83], v[200:203]
    v_mfma_f32_16x16x32_bf16 v[232:235], v[36:39], v[84:87], v[232:235]
    s_add_u32 m0, s67, 61312
    v_mfma_f32_16x16x32_bf16 v[172:175], v[40:43], v[76:79], v[172:175]
    buffer_load_dwordx4 v19, s[4:7], s66 offen offset:1152 lds
    v_mfma_f32_16x16x32_bf16 v[204:207], v[40:43], v[80:83], v[204:207]
    v_mfma_f32_16x16x32_bf16 v[236:239], v[40:43], v[84:87], v[236:239]
    s_waitcnt vmcnt(16) lgkmcnt(0)
    s_barrier
    v_mfma_f32_16x16x32_bf16 v[176:179], v[44:47], v[76:79], v[176:179]
    ds_read_b64_tr_b16 v[28:29], v20 offset:16384
    ds_read_b64_tr_b16 v[30:31], v20 offset:16640
    s_add_u32 m0, s68, 8192
    v_mfma_f32_16x16x32_bf16 v[208:211], v[44:47], v[80:83], v[208:211]
    buffer_load_dwordx4 v16, s[8:11], s28 offen lds
    ds_read_b64_tr_b16 v[32:33], v24 offset:16384
    ds_read_b64_tr_b16 v[34:35], v24 offset:16640
    v_mfma_f32_16x16x32_bf16 v[240:243], v[44:47], v[84:87], v[240:243]
    ds_read_b64_tr_b16 v[36:37], v21 offset:16384
    ds_read_b64_tr_b16 v[38:39], v21 offset:16640
    s_add_u32 m0, s68, 9216
    v_mfma_f32_16x16x32_bf16 v[180:183], v[48:51], v[76:79], v[180:183]
    buffer_load_dwordx4 v17, s[8:11], s28 offen lds
    ds_read_b64_tr_b16 v[40:41], v25 offset:16384
    ds_read_b64_tr_b16 v[42:43], v25 offset:16640
    v_mfma_f32_16x16x32_bf16 v[212:215], v[48:51], v[80:83], v[212:215]
    ds_read_b64_tr_b16 v[44:45], v22 offset:16384
    ds_read_b64_tr_b16 v[46:47], v22 offset:16640
    v_mfma_f32_16x16x32_bf16 v[244:247], v[48:51], v[84:87], v[244:247]
    v_mfma_f32_16x16x32_bf16 v[184:187], v[52:55], v[76:79], v[184:187]
    ds_read_b64_tr_b16 v[48:49], v26 offset:16384
    ds_read_b64_tr_b16 v[50:51], v26 offset:16640
    v_mfma_f32_16x16x32_bf16 v[216:219], v[52:55], v[80:83], v[216:219]
    v_mfma_f32_16x16x32_bf16 v[248:251], v[52:55], v[84:87], v[248:251]
    v_mfma_f32_16x16x32_bf16 v[188:191], v[56:59], v[76:79], v[188:191]
    ds_read_b64_tr_b16 v[52:53], v23 offset:16384
    ds_read_b64_tr_b16 v[54:55], v23 offset:16640
    v_mfma_f32_16x16x32_bf16 v[220:223], v[56:59], v[80:83], v[220:223]
    s_add_u32 s28, s28, 0x40000
    v_mfma_f32_16x16x32_bf16 v[252:255], v[56:59], v[84:87], v[252:255]
    s_waitcnt lgkmcnt(10)
    v_mfma_f32_16x16x32_bf16 v[160:163], v[28:31], v[88:91], v[160:163]
    v_mfma_f32_16x16x32_bf16 v[192:195], v[28:31], v[92:95], v[192:195]
    v_mfma_f32_16x16x32_bf16 v[224:227], v[28:31], v[96:99], v[224:227]
    v_mfma_f32_16x16x32_bf16 v[164:167], v[32:35], v[88:91], v[164:167]
    s_waitcnt vmcnt(12)
    ds_read_b64_tr_b16 v[56:57], v27 offset:16384
    ds_read_b64_tr_b16 v[58:59], v27 offset:16640
    v_mfma_f32_16x16x32_bf16 v[196:199], v[32:35], v[92:95], v[196:199]
    ds_read_b128 v[64:67], v60 offset:0
    v_mfma_f32_16x16x32_bf16 v[228:231], v[32:35], v[96:99], v[228:231]
    ds_read_b128 v[68:71], v60 offset:2048
    s_waitcnt lgkmcnt(10)
    v_mfma_f32_16x16x32_bf16 v[168:171], v[36:39], v[88:91], v[168:171]
    ds_read_b128 v[72:75], v60 offset:4096
    v_mfma_f32_16x16x32_bf16 v[200:203], v[36:39], v[92:95], v[200:203]
    ds_read_b128 v[76:79], v61 offset:0
    v_mfma_f32_16x16x32_bf16 v[232:235], v[36:39], v[96:99], v[232:235]
    ds_read_b128 v[80:83], v61 offset:2048
    v_mfma_f32_16x16x32_bf16 v[172:175], v[40:43], v[88:91], v[172:175]
    ds_read_b128 v[84:87], v61 offset:4096
    v_mfma_f32_16x16x32_bf16 v[204:207], v[40:43], v[92:95], v[204:207]
    v_mfma_f32_16x16x32_bf16 v[236:239], v[40:43], v[96:99], v[236:239]
    s_waitcnt vmcnt(10) lgkmcnt(0)
    s_barrier
    v_mfma_f32_16x16x32_bf16 v[176:179], v[44:47], v[88:91], v[176:179]
    ds_read_b64_tr_b16 v[28:29], v20 offset:24576
    ds_read_b64_tr_b16 v[30:31], v20 offset:24832
    s_add_u32 m0, s68, 16384
    v_mfma_f32_16x16x32_bf16 v[208:211], v[44:47], v[92:95], v[208:211]
    buffer_load_dwordx4 v16, s[8:11], s28 offen lds
    ds_read_b64_tr_b16 v[32:33], v24 offset:24576
    ds_read_b64_tr_b16 v[34:35], v24 offset:24832
    v_mfma_f32_16x16x32_bf16 v[240:243], v[44:47], v[96:99], v[240:243]
    ds_read_b64_tr_b16 v[36:37], v21 offset:24576
    ds_read_b64_tr_b16 v[38:39], v21 offset:24832
    s_add_u32 m0, s68, 17408
    v_mfma_f32_16x16x32_bf16 v[180:183], v[48:51], v[88:91], v[180:183]
    buffer_load_dwordx4 v17, s[8:11], s28 offen lds
    ds_read_b64_tr_b16 v[40:41], v25 offset:24576
    ds_read_b64_tr_b16 v[42:43], v25 offset:24832
    v_mfma_f32_16x16x32_bf16 v[212:215], v[48:51], v[92:95], v[212:215]
    ds_read_b64_tr_b16 v[44:45], v22 offset:24576
    ds_read_b64_tr_b16 v[46:47], v22 offset:24832
    v_mfma_f32_16x16x32_bf16 v[244:247], v[48:51], v[96:99], v[244:247]
    s_add_u32 m0, s67, 31488
    v_mfma_f32_16x16x32_bf16 v[184:187], v[52:55], v[88:91], v[184:187]
    buffer_load_dwordx4 v18, s[4:7], s64 offen offset:1280 lds
    ds_read_b64_tr_b16 v[48:49], v26 offset:24576
    ds_read_b64_tr_b16 v[50:51], v26 offset:24832
    v_mfma_f32_16x16x32_bf16 v[216:219], v[52:55], v[92:95], v[216:219]
    v_mfma_f32_16x16x32_bf16 v[248:251], v[52:55], v[96:99], v[248:251]
    s_add_u32 m0, s67, 32512
    v_mfma_f32_16x16x32_bf16 v[188:191], v[56:59], v[88:91], v[188:191]
    buffer_load_dwordx4 v19, s[4:7], s64 offen offset:1280 lds
    ds_read_b64_tr_b16 v[52:53], v23 offset:24576
    ds_read_b64_tr_b16 v[54:55], v23 offset:24832
    v_mfma_f32_16x16x32_bf16 v[220:223], v[56:59], v[92:95], v[220:223]
    s_add_u32 s28, s28, 0x40000
    v_mfma_f32_16x16x32_bf16 v[252:255], v[56:59], v[96:99], v[252:255]
    s_add_u32 m0, s67, 33536
    s_waitcnt lgkmcnt(10)
    v_mfma_f32_16x16x32_bf16 v[160:163], v[28:31], v[100:103], v[160:163]
    buffer_load_dwordx4 v18, s[4:7], s65 offen offset:1280 lds
    v_mfma_f32_16x16x32_bf16 v[192:195], v[28:31], v[104:107], v[192:195]
    v_mfma_f32_16x16x32_bf16 v[224:227], v[28:31], v[108:111], v[224:227]
    s_add_u32 m0, s67, 34560
    v_mfma_f32_16x16x32_bf16 v[164:167], v[32:35], v[100:103], v[164:167]
    buffer_load_dwordx4 v19, s[4:7], s65 offen offset:1280 lds
    ds_read_b64_tr_b16 v[56:57], v27 offset:24576
    ds_read_b64_tr_b16 v[58:59], v27 offset:24832
    v_mfma_f32_16x16x32_bf16 v[196:199], v[32:35], v[104:107], v[196:199]
    v_mfma_f32_16x16x32_bf16 v[228:231], v[32:35], v[108:111], v[228:231]
    s_add_u32 m0, s67, 35584
    s_waitcnt lgkmcnt(8)
    v_mfma_f32_16x16x32_bf16 v[168:171], v[36:39], v[100:103], v[168:171]
    buffer_load_dwordx4 v18, s[4:7], s66 offen offset:1280 lds
    v_mfma_f32_16x16x32_bf16 v[200:203], v[36:39], v[104:107], v[200:203]
    v_mfma_f32_16x16x32_bf16 v[232:235], v[36:39], v[108:111], v[232:235]
    s_add_u32 m0, s67, 36608
    v_mfma_f32_16x16x32_bf16 v[172:175], v[40:43], v[100:103], v[172:175]
    buffer_load_dwordx4 v19, s[4:7], s66 offen offset:1280 lds
    v_mfma_f32_16x16x32_bf16 v[204:207], v[40:43], v[104:107], v[204:207]
    v_mfma_f32_16x16x32_bf16 v[236:239], v[40:43], v[108:111], v[236:239]
    s_waitcnt vmcnt(16) lgkmcnt(0)
    s_barrier
    v_mfma_f32_16x16x32_bf16 v[176:179], v[44:47], v[100:103], v[176:179]
    ds_read_b64_tr_b16 v[28:29], v20 offset:0
    ds_read_b64_tr_b16 v[30:31], v20 offset:256
    s_add_u32 m0, s68, 24576
    v_mfma_f32_16x16x32_bf16 v[208:211], v[44:47], v[104:107], v[208:211]
    buffer_load_dwordx4 v16, s[8:11], s28 offen lds
    ds_read_b64_tr_b16 v[32:33], v24 offset:0
    ds_read_b64_tr_b16 v[34:35], v24 offset:256
    v_mfma_f32_16x16x32_bf16 v[240:243], v[44:47], v[108:111], v[240:243]
    ds_read_b64_tr_b16 v[36:37], v21 offset:0
    ds_read_b64_tr_b16 v[38:39], v21 offset:256
    s_add_u32 m0, s68, 25600
    v_mfma_f32_16x16x32_bf16 v[180:183], v[48:51], v[100:103], v[180:183]
    buffer_load_dwordx4 v17, s[8:11], s28 offen lds
    ds_read_b64_tr_b16 v[40:41], v25 offset:0
    ds_read_b64_tr_b16 v[42:43], v25 offset:256
    v_mfma_f32_16x16x32_bf16 v[212:215], v[48:51], v[104:107], v[212:215]
    ds_read_b64_tr_b16 v[44:45], v22 offset:0
    ds_read_b64_tr_b16 v[46:47], v22 offset:256
    v_mfma_f32_16x16x32_bf16 v[244:247], v[48:51], v[108:111], v[244:247]
    v_mfma_f32_16x16x32_bf16 v[184:187], v[52:55], v[100:103], v[184:187]
    ds_read_b64_tr_b16 v[48:49], v26 offset:0
    ds_read_b64_tr_b16 v[50:51], v26 offset:256
    v_mfma_f32_16x16x32_bf16 v[216:219], v[52:55], v[104:107], v[216:219]
    v_mfma_f32_16x16x32_bf16 v[248:251], v[52:55], v[108:111], v[248:251]
    v_mfma_f32_16x16x32_bf16 v[188:191], v[56:59], v[100:103], v[188:191]
    ds_read_b64_tr_b16 v[52:53], v23 offset:0
    ds_read_b64_tr_b16 v[54:55], v23 offset:256
    v_mfma_f32_16x16x32_bf16 v[220:223], v[56:59], v[104:107], v[220:223]
    s_add_u32 s28, s28, 0x40000
    v_mfma_f32_16x16x32_bf16 v[252:255], v[56:59], v[108:111], v[252:255]
    s_waitcnt lgkmcnt(10)
    v_mfma_f32_16x16x32_bf16 v[160:163], v[28:31], v[64:67], v[160:163]
    v_mfma_f32_16x16x32_bf16 v[192:195], v[28:31], v[68:71], v[192:195]
    v_mfma_f32_16x16x32_bf16 v[224:227], v[28:31], v[72:75], v[224:227]
    v_mfma_f32_16x16x32_bf16 v[164:167], v[32:35], v[64:67], v[164:167]
    s_waitcnt vmcnt(12)
    ds_read_b64_tr_b16 v[56:57], v27 offset:0
    ds_read_b64_tr_b16 v[58:59], v27 offset:256
    v_mfma_f32_16x16x32_bf16 v[196:199], v[32:35], v[68:71], v[196:199]
    ds_read_b128 v[88:91], v60 offset:24576
    v_mfma_f32_16x16x32_bf16 v[228:231], v[32:35], v[72:75], v[228:231]
    ds_read_b128 v[92:95], v60 offset:26624
    s_waitcnt lgkmcnt(10)
    v_mfma_f32_16x16x32_bf16 v[168:171], v[36:39], v[64:67], v[168:171]
    ds_read_b128 v[96:99], v60 offset:28672
    v_mfma_f32_16x16x32_bf16 v[200:203], v[36:39], v[68:71], v[200:203]
    ds_read_b128 v[100:103], v61 offset:24576
    v_mfma_f32_16x16x32_bf16 v[232:235], v[36:39], v[72:75], v[232:235]
    ds_read_b128 v[104:107], v61 offset:26624
    v_mfma_f32_16x16x32_bf16 v[172:175], v[40:43], v[64:67], v[172:175]
    ds_read_b128 v[108:111], v61 offset:28672
    v_mfma_f32_16x16x32_bf16 v[204:207], v[40:43], v[68:71], v[204:207]
    v_mfma_f32_16x16x32_bf16 v[236:239], v[40:43], v[72:75], v[236:239]
    s_waitcnt vmcnt(10) lgkmcnt(0)
    s_barrier
    v_mfma_f32_16x16x32_bf16 v[176:179], v[44:47], v[64:67], v[176:179]
    ds_read_b64_tr_b16 v[28:29], v20 offset:8192
    ds_read_b64_tr_b16 v[30:31], v20 offset:8448
    s_add_u32 m0, s68, 0
    v_mfma_f32_16x16x32_bf16 v[208:211], v[44:47], v[68:71], v[208:211]
    buffer_load_dwordx4 v16, s[8:11], s28 offen lds
    ds_read_b64_tr_b16 v[32:33], v24 offset:8192
    ds_read_b64_tr_b16 v[34:35], v24 offset:8448
    v_mfma_f32_16x16x32_bf16 v[240:243], v[44:47], v[72:75], v[240:243]
    ds_read_b64_tr_b16 v[36:37], v21 offset:8192
    ds_read_b64_tr_b16 v[38:39], v21 offset:8448
    s_add_u32 m0, s68, 1024
    v_mfma_f32_16x16x32_bf16 v[180:183], v[48:51], v[64:67], v[180:183]
    buffer_load_dwordx4 v17, s[8:11], s28 offen lds
    ds_read_b64_tr_b16 v[40:41], v25 offset:8192
    ds_read_b64_tr_b16 v[42:43], v25 offset:8448
    v_mfma_f32_16x16x32_bf16 v[212:215], v[48:51], v[68:71], v[212:215]
    ds_read_b64_tr_b16 v[44:45], v22 offset:8192
    ds_read_b64_tr_b16 v[46:47], v22 offset:8448
    v_mfma_f32_16x16x32_bf16 v[244:247], v[48:51], v[72:75], v[244:247]
    s_add_u32 m0, s67, 55936
    v_mfma_f32_16x16x32_bf16 v[184:187], v[52:55], v[64:67], v[184:187]
    buffer_load_dwordx4 v18, s[4:7], s64 offen offset:1408 lds
    ds_read_b64_tr_b16 v[48:49], v26 offset:8192
    ds_read_b64_tr_b16 v[50:51], v26 offset:8448
    v_mfma_f32_16x16x32_bf16 v[216:219], v[52:55], v[68:71], v[216:219]
    v_mfma_f32_16x16x32_bf16 v[248:251], v[52:55], v[72:75], v[248:251]
    s_add_u32 m0, s67, 56960
    v_mfma_f32_16x16x32_bf16 v[188:191], v[56:59], v[64:67], v[188:191]
    buffer_load_dwordx4 v19, s[4:7], s64 offen offset:1408 lds
    ds_read_b64_tr_b16 v[52:53], v23 offset:8192
    ds_read_b64_tr_b16 v[54:55], v23 offset:8448
    v_mfma_f32_16x16x32_bf16 v[220:223], v[56:59], v[68:71], v[220:223]
    s_add_u32 s28, s28, 0x40000
    v_mfma_f32_16x16x32_bf16 v[252:255], v[56:59], v[72:75], v[252:255]
    s_add_u32 m0, s67, 57984
    s_waitcnt lgkmcnt(10)
    v_mfma_f32_16x16x32_bf16 v[160:163], v[28:31], v[76:79], v[160:163]
    buffer_load_dwordx4 v18, s[4:7], s65 offen offset:1408 lds
    v_mfma_f32_16x16x32_bf16 v[192:195], v[28:31], v[80:83], v[192:195]
    v_mfma_f32_16x16x32_bf16 v[224:227], v[28:31], v[84:87], v[224:227]
    s_add_u32 m0, s67, 59008
    v_mfma_f32_16x16x32_bf16 v[164:167], v[32:35], v[76:79], v[164:167]
    buffer_load_dwordx4 v19, s[4:7], s65 offen offset:1408 lds
    ds_read_b64_tr_b16 v[56:57], v27 offset:8192
    ds_read_b64_tr_b16 v[58:59], v27 offset:8448
    v_mfma_f32_16x16x32_bf16 v[196:199], v[32:35], v[80:83], v[196:199]
    v_mfma_f32_16x16x32_bf16 v[228:231], v[32:35], v[84:87], v[228:231]
    s_add_u32 m0, s67, 60032
    s_waitcnt lgkmcnt(8)
    v_mfma_f32_16x16x32_bf16 v[168:171], v[36:39], v[76:79], v[168:171]
    buffer_load_dwordx4 v18, s[4:7], s66 offen offset:1408 lds
    v_mfma_f32_16x16x32_bf16 v[200:203], v[36:39], v[80:83], v[200:203]
    v_mfma_f32_16x16x32_bf16 v[232:235], v[36:39], v[84:87], v[232:235]
    s_add_u32 m0, s67, 61056
    v_mfma_f32_16x16x32_bf16 v[172:175], v[40:43], v[76:79], v[172:175]
    buffer_load_dwordx4 v19, s[4:7], s66 offen offset:1408 lds
    v_mfma_f32_16x16x32_bf16 v[204:207], v[40:43], v[80:83], v[204:207]
    v_mfma_f32_16x16x32_bf16 v[236:239], v[40:43], v[84:87], v[236:239]
    s_waitcnt vmcnt(16) lgkmcnt(0)
    s_barrier
    v_mfma_f32_16x16x32_bf16 v[176:179], v[44:47], v[76:79], v[176:179]
    ds_read_b64_tr_b16 v[28:29], v20 offset:16384
    ds_read_b64_tr_b16 v[30:31], v20 offset:16640
    s_add_u32 m0, s68, 8192
    v_mfma_f32_16x16x32_bf16 v[208:211], v[44:47], v[80:83], v[208:211]
    buffer_load_dwordx4 v16, s[8:11], s28 offen lds
    ds_read_b64_tr_b16 v[32:33], v24 offset:16384
    ds_read_b64_tr_b16 v[34:35], v24 offset:16640
    v_mfma_f32_16x16x32_bf16 v[240:243], v[44:47], v[84:87], v[240:243]
    ds_read_b64_tr_b16 v[36:37], v21 offset:16384
    ds_read_b64_tr_b16 v[38:39], v21 offset:16640
    s_add_u32 m0, s68, 9216
    v_mfma_f32_16x16x32_bf16 v[180:183], v[48:51], v[76:79], v[180:183]
    buffer_load_dwordx4 v17, s[8:11], s28 offen lds
    ds_read_b64_tr_b16 v[40:41], v25 offset:16384
    ds_read_b64_tr_b16 v[42:43], v25 offset:16640
    v_mfma_f32_16x16x32_bf16 v[212:215], v[48:51], v[80:83], v[212:215]
    ds_read_b64_tr_b16 v[44:45], v22 offset:16384
    ds_read_b64_tr_b16 v[46:47], v22 offset:16640
    v_mfma_f32_16x16x32_bf16 v[244:247], v[48:51], v[84:87], v[244:247]
    v_mfma_f32_16x16x32_bf16 v[184:187], v[52:55], v[76:79], v[184:187]
    ds_read_b64_tr_b16 v[48:49], v26 offset:16384
    ds_read_b64_tr_b16 v[50:51], v26 offset:16640
    v_mfma_f32_16x16x32_bf16 v[216:219], v[52:55], v[80:83], v[216:219]
    v_mfma_f32_16x16x32_bf16 v[248:251], v[52:55], v[84:87], v[248:251]
    v_mfma_f32_16x16x32_bf16 v[188:191], v[56:59], v[76:79], v[188:191]
    ds_read_b64_tr_b16 v[52:53], v23 offset:16384
    ds_read_b64_tr_b16 v[54:55], v23 offset:16640
    v_mfma_f32_16x16x32_bf16 v[220:223], v[56:59], v[80:83], v[220:223]
    s_add_u32 s28, s28, 0x40000
    v_mfma_f32_16x16x32_bf16 v[252:255], v[56:59], v[84:87], v[252:255]
    s_waitcnt lgkmcnt(10)
    v_mfma_f32_16x16x32_bf16 v[160:163], v[28:31], v[88:91], v[160:163]
    v_mfma_f32_16x16x32_bf16 v[192:195], v[28:31], v[92:95], v[192:195]
    v_mfma_f32_16x16x32_bf16 v[224:227], v[28:31], v[96:99], v[224:227]
    v_mfma_f32_16x16x32_bf16 v[164:167], v[32:35], v[88:91], v[164:167]
    s_waitcnt vmcnt(12)
    ds_read_b64_tr_b16 v[56:57], v27 offset:16384
    ds_read_b64_tr_b16 v[58:59], v27 offset:16640
    v_mfma_f32_16x16x32_bf16 v[196:199], v[32:35], v[92:95], v[196:199]
    ds_read_b128 v[64:67], v60 offset:0
    v_mfma_f32_16x16x32_bf16 v[228:231], v[32:35], v[96:99], v[228:231]
    ds_read_b128 v[68:71], v60 offset:2048
    s_waitcnt lgkmcnt(10)
    v_mfma_f32_16x16x32_bf16 v[168:171], v[36:39], v[88:91], v[168:171]
    ds_read_b128 v[72:75], v60 offset:4096
    v_mfma_f32_16x16x32_bf16 v[200:203], v[36:39], v[92:95], v[200:203]
    ds_read_b128 v[76:79], v61 offset:0
    v_mfma_f32_16x16x32_bf16 v[232:235], v[36:39], v[96:99], v[232:235]
    ds_read_b128 v[80:83], v61 offset:2048
    v_mfma_f32_16x16x32_bf16 v[172:175], v[40:43], v[88:91], v[172:175]
    ds_read_b128 v[84:87], v61 offset:4096
    v_mfma_f32_16x16x32_bf16 v[204:207], v[40:43], v[92:95], v[204:207]
    v_mfma_f32_16x16x32_bf16 v[236:239], v[40:43], v[96:99], v[236:239]
    s_waitcnt vmcnt(10) lgkmcnt(0)
    s_barrier
    v_mfma_f32_16x16x32_bf16 v[176:179], v[44:47], v[88:91], v[176:179]
    ds_read_b64_tr_b16 v[28:29], v20 offset:24576
    ds_read_b64_tr_b16 v[30:31], v20 offset:24832
    s_add_u32 m0, s68, 16384
    v_mfma_f32_16x16x32_bf16 v[208:211], v[44:47], v[92:95], v[208:211]
    buffer_load_dwordx4 v16, s[8:11], s28 offen lds
    ds_read_b64_tr_b16 v[32:33], v24 offset:24576
    ds_read_b64_tr_b16 v[34:35], v24 offset:24832
    v_mfma_f32_16x16x32_bf16 v[240:243], v[44:47], v[96:99], v[240:243]
    ds_read_b64_tr_b16 v[36:37], v21 offset:24576
    ds_read_b64_tr_b16 v[38:39], v21 offset:24832
    s_add_u32 m0, s68, 17408
    v_mfma_f32_16x16x32_bf16 v[180:183], v[48:51], v[88:91], v[180:183]
    buffer_load_dwordx4 v17, s[8:11], s28 offen lds
    ds_read_b64_tr_b16 v[40:41], v25 offset:24576
    ds_read_b64_tr_b16 v[42:43], v25 offset:24832
    v_mfma_f32_16x16x32_bf16 v[212:215], v[48:51], v[92:95], v[212:215]
    ds_read_b64_tr_b16 v[44:45], v22 offset:24576
    ds_read_b64_tr_b16 v[46:47], v22 offset:24832
    v_mfma_f32_16x16x32_bf16 v[244:247], v[48:51], v[96:99], v[244:247]
    s_add_u32 m0, s67, 31232
    v_mfma_f32_16x16x32_bf16 v[184:187], v[52:55], v[88:91], v[184:187]
    buffer_load_dwordx4 v18, s[4:7], s64 offen offset:1536 lds
    ds_read_b64_tr_b16 v[48:49], v26 offset:24576
    ds_read_b64_tr_b16 v[50:51], v26 offset:24832
    v_mfma_f32_16x16x32_bf16 v[216:219], v[52:55], v[92:95], v[216:219]
    v_mfma_f32_16x16x32_bf16 v[248:251], v[52:55], v[96:99], v[248:251]
    s_add_u32 m0, s67, 32256
    v_mfma_f32_16x16x32_bf16 v[188:191], v[56:59], v[88:91], v[188:191]
    buffer_load_dwordx4 v19, s[4:7], s64 offen offset:1536 lds
    ds_read_b64_tr_b16 v[52:53], v23 offset:24576
    ds_read_b64_tr_b16 v[54:55], v23 offset:24832
    v_mfma_f32_16x16x32_bf16 v[220:223], v[56:59], v[92:95], v[220:223]
    s_add_u32 s28, s28, 0x40000
    v_mfma_f32_16x16x32_bf16 v[252:255], v[56:59], v[96:99], v[252:255]
    s_add_u32 m0, s67, 33280
    s_waitcnt lgkmcnt(10)
    v_mfma_f32_16x16x32_bf16 v[160:163], v[28:31], v[100:103], v[160:163]
    buffer_load_dwordx4 v18, s[4:7], s65 offen offset:1536 lds
    v_mfma_f32_16x16x32_bf16 v[192:195], v[28:31], v[104:107], v[192:195]
    v_mfma_f32_16x16x32_bf16 v[224:227], v[28:31], v[108:111], v[224:227]
    s_add_u32 m0, s67, 34304
    v_mfma_f32_16x16x32_bf16 v[164:167], v[32:35], v[100:103], v[164:167]
    buffer_load_dwordx4 v19, s[4:7], s65 offen offset:1536 lds
    ds_read_b64_tr_b16 v[56:57], v27 offset:24576
    ds_read_b64_tr_b16 v[58:59], v27 offset:24832
    v_mfma_f32_16x16x32_bf16 v[196:199], v[32:35], v[104:107], v[196:199]
    v_mfma_f32_16x16x32_bf16 v[228:231], v[32:35], v[108:111], v[228:231]
    s_add_u32 m0, s67, 35328
    s_waitcnt lgkmcnt(8)
    v_mfma_f32_16x16x32_bf16 v[168:171], v[36:39], v[100:103], v[168:171]
    buffer_load_dwordx4 v18, s[4:7], s66 offen offset:1536 lds
    v_mfma_f32_16x16x32_bf16 v[200:203], v[36:39], v[104:107], v[200:203]
    v_mfma_f32_16x16x32_bf16 v[232:235], v[36:39], v[108:111], v[232:235]
    s_add_u32 m0, s67, 36352
    v_mfma_f32_16x16x32_bf16 v[172:175], v[40:43], v[100:103], v[172:175]
    buffer_load_dwordx4 v19, s[4:7], s66 offen offset:1536 lds
    v_mfma_f32_16x16x32_bf16 v[204:207], v[40:43], v[104:107], v[204:207]
    v_mfma_f32_16x16x32_bf16 v[236:239], v[40:43], v[108:111], v[236:239]
    s_waitcnt vmcnt(16) lgkmcnt(0)
    s_barrier
    v_mfma_f32_16x16x32_bf16 v[176:179], v[44:47], v[100:103], v[176:179]
    ds_read_b64_tr_b16 v[28:29], v20 offset:0
    ds_read_b64_tr_b16 v[30:31], v20 offset:256
    s_add_u32 m0, s68, 24576
    v_mfma_f32_16x16x32_bf16 v[208:211], v[44:47], v[104:107], v[208:211]
    buffer_load_dwordx4 v16, s[8:11], s28 offen lds
    ds_read_b64_tr_b16 v[32:33], v24 offset:0
    ds_read_b64_tr_b16 v[34:35], v24 offset:256
    v_mfma_f32_16x16x32_bf16 v[240:243], v[44:47], v[108:111], v[240:243]
    ds_read_b64_tr_b16 v[36:37], v21 offset:0
    ds_read_b64_tr_b16 v[38:39], v21 offset:256
    s_add_u32 m0, s68, 25600
    v_mfma_f32_16x16x32_bf16 v[180:183], v[48:51], v[100:103], v[180:183]
    buffer_load_dwordx4 v17, s[8:11], s28 offen lds
    ds_read_b64_tr_b16 v[40:41], v25 offset:0
    ds_read_b64_tr_b16 v[42:43], v25 offset:256
    v_mfma_f32_16x16x32_bf16 v[212:215], v[48:51], v[104:107], v[212:215]
    ds_read_b64_tr_b16 v[44:45], v22 offset:0
    ds_read_b64_tr_b16 v[46:47], v22 offset:256
    v_mfma_f32_16x16x32_bf16 v[244:247], v[48:51], v[108:111], v[244:247]
    v_mfma_f32_16x16x32_bf16 v[184:187], v[52:55], v[100:103], v[184:187]
    ds_read_b64_tr_b16 v[48:49], v26 offset:0
    ds_read_b64_tr_b16 v[50:51], v26 offset:256
    v_mfma_f32_16x16x32_bf16 v[216:219], v[52:55], v[104:107], v[216:219]
    v_mfma_f32_16x16x32_bf16 v[248:251], v[52:55], v[108:111], v[248:251]
    v_mfma_f32_16x16x32_bf16 v[188:191], v[56:59], v[100:103], v[188:191]
    ds_read_b64_tr_b16 v[52:53], v23 offset:0
    ds_read_b64_tr_b16 v[54:55], v23 offset:256
    v_mfma_f32_16x16x32_bf16 v[220:223], v[56:59], v[104:107], v[220:223]
    s_add_u32 s28, s28, 0x40000
    v_mfma_f32_16x16x32_bf16 v[252:255], v[56:59], v[108:111], v[252:255]
    s_waitcnt lgkmcnt(10)
    v_mfma_f32_16x16x32_bf16 v[160:163], v[28:31], v[64:67], v[160:163]
    v_mfma_f32_16x16x32_bf16 v[192:195], v[28:31], v[68:71], v[192:195]
    v_mfma_f32_16x16x32_bf16 v[224:227], v[28:31], v[72:75], v[224:227]
    v_mfma_f32_16x16x32_bf16 v[164:167], v[32:35], v[64:67], v[164:167]
    s_waitcnt vmcnt(12)
    ds_read_b64_tr_b16 v[56:57], v27 offset:0
    ds_read_b64_tr_b16 v[58:59], v27 offset:256
    v_mfma_f32_16x16x32_bf16 v[196:199], v[32:35], v[68:71], v[196:199]
    ds_read_b128 v[88:91], v60 offset:24576
    v_mfma_f32_16x16x32_bf16 v[228:231], v[32:35], v[72:75], v[228:231]
    ds_read_b128 v[92:95], v60 offset:26624
    s_waitcnt lgkmcnt(10)
    v_mfma_f32_16x16x32_bf16 v[168:171], v[36:39], v[64:67], v[168:171]
    ds_read_b128 v[96:99], v60 offset:28672
    v_mfma_f32_16x16x32_bf16 v[200:203], v[36:39], v[68:71], v[200:203]
    ds_read_b128 v[100:103], v61 offset:24576
    v_mfma_f32_16x16x32_bf16 v[232:235], v[36:39], v[72:75], v[232:235]
    ds_read_b128 v[104:107], v61 offset:26624
    v_mfma_f32_16x16x32_bf16 v[172:175], v[40:43], v[64:67], v[172:175]
    ds_read_b128 v[108:111], v61 offset:28672
    v_mfma_f32_16x16x32_bf16 v[204:207], v[40:43], v[68:71], v[204:207]
    v_mfma_f32_16x16x32_bf16 v[236:239], v[40:43], v[72:75], v[236:239]
    s_waitcnt vmcnt(10) lgkmcnt(0)
    s_barrier
    v_mfma_f32_16x16x32_bf16 v[176:179], v[44:47], v[64:67], v[176:179]
    ds_read_b64_tr_b16 v[28:29], v20 offset:8192
    ds_read_b64_tr_b16 v[30:31], v20 offset:8448
    s_add_u32 m0, s68, 0
    v_mfma_f32_16x16x32_bf16 v[208:211], v[44:47], v[68:71], v[208:211]
    buffer_load_dwordx4 v16, s[8:11], s28 offen lds
    ds_read_b64_tr_b16 v[32:33], v24 offset:8192
    ds_read_b64_tr_b16 v[34:35], v24 offset:8448
    v_mfma_f32_16x16x32_bf16 v[240:243], v[44:47], v[72:75], v[240:243]
    ds_read_b64_tr_b16 v[36:37], v21 offset:8192
    ds_read_b64_tr_b16 v[38:39], v21 offset:8448
    s_add_u32 m0, s68, 1024
    v_mfma_f32_16x16x32_bf16 v[180:183], v[48:51], v[64:67], v[180:183]
    buffer_load_dwordx4 v17, s[8:11], s28 offen lds
    ds_read_b64_tr_b16 v[40:41], v25 offset:8192
    ds_read_b64_tr_b16 v[42:43], v25 offset:8448
    v_mfma_f32_16x16x32_bf16 v[212:215], v[48:51], v[68:71], v[212:215]
    ds_read_b64_tr_b16 v[44:45], v22 offset:8192
    ds_read_b64_tr_b16 v[46:47], v22 offset:8448
    v_mfma_f32_16x16x32_bf16 v[244:247], v[48:51], v[72:75], v[244:247]
    s_add_u32 m0, s67, 55680
    v_mfma_f32_16x16x32_bf16 v[184:187], v[52:55], v[64:67], v[184:187]
    buffer_load_dwordx4 v18, s[4:7], s64 offen offset:1664 lds
    ds_read_b64_tr_b16 v[48:49], v26 offset:8192
    ds_read_b64_tr_b16 v[50:51], v26 offset:8448
    v_mfma_f32_16x16x32_bf16 v[216:219], v[52:55], v[68:71], v[216:219]
    v_mfma_f32_16x16x32_bf16 v[248:251], v[52:55], v[72:75], v[248:251]
    s_add_u32 m0, s67, 56704
    v_mfma_f32_16x16x32_bf16 v[188:191], v[56:59], v[64:67], v[188:191]
    buffer_load_dwordx4 v19, s[4:7], s64 offen offset:1664 lds
    ds_read_b64_tr_b16 v[52:53], v23 offset:8192
    ds_read_b64_tr_b16 v[54:55], v23 offset:8448
    v_mfma_f32_16x16x32_bf16 v[220:223], v[56:59], v[68:71], v[220:223]
    s_add_u32 s28, s28, 0x40000
    v_mfma_f32_16x16x32_bf16 v[252:255], v[56:59], v[72:75], v[252:255]
    s_add_u32 m0, s67, 57728
    s_waitcnt lgkmcnt(10)
    v_mfma_f32_16x16x32_bf16 v[160:163], v[28:31], v[76:79], v[160:163]
    buffer_load_dwordx4 v18, s[4:7], s65 offen offset:1664 lds
    v_mfma_f32_16x16x32_bf16 v[192:195], v[28:31], v[80:83], v[192:195]
    v_mfma_f32_16x16x32_bf16 v[224:227], v[28:31], v[84:87], v[224:227]
    s_add_u32 m0, s67, 58752
    v_mfma_f32_16x16x32_bf16 v[164:167], v[32:35], v[76:79], v[164:167]
    buffer_load_dwordx4 v19, s[4:7], s65 offen offset:1664 lds
    ds_read_b64_tr_b16 v[56:57], v27 offset:8192
    ds_read_b64_tr_b16 v[58:59], v27 offset:8448
    v_mfma_f32_16x16x32_bf16 v[196:199], v[32:35], v[80:83], v[196:199]
    v_mfma_f32_16x16x32_bf16 v[228:231], v[32:35], v[84:87], v[228:231]
    s_add_u32 m0, s67, 59776
    s_waitcnt lgkmcnt(8)
    v_mfma_f32_16x16x32_bf16 v[168:171], v[36:39], v[76:79], v[168:171]
    buffer_load_dwordx4 v18, s[4:7], s66 offen offset:1664 lds
    v_mfma_f32_16x16x32_bf16 v[200:203], v[36:39], v[80:83], v[200:203]
    v_mfma_f32_16x16x32_bf16 v[232:235], v[36:39], v[84:87], v[232:235]
    s_add_u32 m0, s67, 60800
    v_mfma_f32_16x16x32_bf16 v[172:175], v[40:43], v[76:79], v[172:175]
    buffer_load_dwordx4 v19, s[4:7], s66 offen offset:1664 lds
    v_mfma_f32_16x16x32_bf16 v[204:207], v[40:43], v[80:83], v[204:207]
    v_mfma_f32_16x16x32_bf16 v[236:239], v[40:43], v[84:87], v[236:239]
    s_waitcnt vmcnt(16) lgkmcnt(0)
    s_barrier
    v_mfma_f32_16x16x32_bf16 v[176:179], v[44:47], v[76:79], v[176:179]
    ds_read_b64_tr_b16 v[28:29], v20 offset:16384
    ds_read_b64_tr_b16 v[30:31], v20 offset:16640
    s_add_u32 m0, s68, 8192
    v_mfma_f32_16x16x32_bf16 v[208:211], v[44:47], v[80:83], v[208:211]
    buffer_load_dwordx4 v16, s[8:11], s28 offen lds
    ds_read_b64_tr_b16 v[32:33], v24 offset:16384
    ds_read_b64_tr_b16 v[34:35], v24 offset:16640
    v_mfma_f32_16x16x32_bf16 v[240:243], v[44:47], v[84:87], v[240:243]
    ds_read_b64_tr_b16 v[36:37], v21 offset:16384
    ds_read_b64_tr_b16 v[38:39], v21 offset:16640
    s_add_u32 m0, s68, 9216
    v_mfma_f32_16x16x32_bf16 v[180:183], v[48:51], v[76:79], v[180:183]
    buffer_load_dwordx4 v17, s[8:11], s28 offen lds
    ds_read_b64_tr_b16 v[40:41], v25 offset:16384
    ds_read_b64_tr_b16 v[42:43], v25 offset:16640
    v_mfma_f32_16x16x32_bf16 v[212:215], v[48:51], v[80:83], v[212:215]
    ds_read_b64_tr_b16 v[44:45], v22 offset:16384
    ds_read_b64_tr_b16 v[46:47], v22 offset:16640
    v_mfma_f32_16x16x32_bf16 v[244:247], v[48:51], v[84:87], v[244:247]
    v_mfma_f32_16x16x32_bf16 v[184:187], v[52:55], v[76:79], v[184:187]
    ds_read_b64_tr_b16 v[48:49], v26 offset:16384
    ds_read_b64_tr_b16 v[50:51], v26 offset:16640
    v_mfma_f32_16x16x32_bf16 v[216:219], v[52:55], v[80:83], v[216:219]
    v_mfma_f32_16x16x32_bf16 v[248:251], v[52:55], v[84:87], v[248:251]
    v_mfma_f32_16x16x32_bf16 v[188:191], v[56:59], v[76:79], v[188:191]
    ds_read_b64_tr_b16 v[52:53], v23 offset:16384
    ds_read_b64_tr_b16 v[54:55], v23 offset:16640
    v_mfma_f32_16x16x32_bf16 v[220:223], v[56:59], v[80:83], v[220:223]
    s_add_u32 s28, s28, 0x40000
    v_mfma_f32_16x16x32_bf16 v[252:255], v[56:59], v[84:87], v[252:255]
    s_waitcnt lgkmcnt(10)
    v_mfma_f32_16x16x32_bf16 v[160:163], v[28:31], v[88:91], v[160:163]
    v_mfma_f32_16x16x32_bf16 v[192:195], v[28:31], v[92:95], v[192:195]
    v_mfma_f32_16x16x32_bf16 v[224:227], v[28:31], v[96:99], v[224:227]
    v_mfma_f32_16x16x32_bf16 v[164:167], v[32:35], v[88:91], v[164:167]
    s_waitcnt vmcnt(12)
    ds_read_b64_tr_b16 v[56:57], v27 offset:16384
    ds_read_b64_tr_b16 v[58:59], v27 offset:16640
    v_mfma_f32_16x16x32_bf16 v[196:199], v[32:35], v[92:95], v[196:199]
    ds_read_b128 v[64:67], v60 offset:0
    v_mfma_f32_16x16x32_bf16 v[228:231], v[32:35], v[96:99], v[228:231]
    ds_read_b128 v[68:71], v60 offset:2048
    s_waitcnt lgkmcnt(10)
    v_mfma_f32_16x16x32_bf16 v[168:171], v[36:39], v[88:91], v[168:171]
    ds_read_b128 v[72:75], v60 offset:4096
    v_mfma_f32_16x16x32_bf16 v[200:203], v[36:39], v[92:95], v[200:203]
    ds_read_b128 v[76:79], v61 offset:0
    v_mfma_f32_16x16x32_bf16 v[232:235], v[36:39], v[96:99], v[232:235]
    ds_read_b128 v[80:83], v61 offset:2048
    v_mfma_f32_16x16x32_bf16 v[172:175], v[40:43], v[88:91], v[172:175]
    ds_read_b128 v[84:87], v61 offset:4096
    v_mfma_f32_16x16x32_bf16 v[204:207], v[40:43], v[92:95], v[204:207]
    v_mfma_f32_16x16x32_bf16 v[236:239], v[40:43], v[96:99], v[236:239]
    s_waitcnt vmcnt(10) lgkmcnt(0)
    s_barrier
    v_mfma_f32_16x16x32_bf16 v[176:179], v[44:47], v[88:91], v[176:179]
    ds_read_b64_tr_b16 v[28:29], v20 offset:24576
    ds_read_b64_tr_b16 v[30:31], v20 offset:24832
    s_add_u32 m0, s68, 16384
    v_mfma_f32_16x16x32_bf16 v[208:211], v[44:47], v[92:95], v[208:211]
    buffer_load_dwordx4 v16, s[8:11], s28 offen lds
    ds_read_b64_tr_b16 v[32:33], v24 offset:24576
    ds_read_b64_tr_b16 v[34:35], v24 offset:24832
    v_mfma_f32_16x16x32_bf16 v[240:243], v[44:47], v[96:99], v[240:243]
    ds_read_b64_tr_b16 v[36:37], v21 offset:24576
    ds_read_b64_tr_b16 v[38:39], v21 offset:24832
    s_add_u32 m0, s68, 17408
    v_mfma_f32_16x16x32_bf16 v[180:183], v[48:51], v[88:91], v[180:183]
    buffer_load_dwordx4 v17, s[8:11], s28 offen lds
    ds_read_b64_tr_b16 v[40:41], v25 offset:24576
    ds_read_b64_tr_b16 v[42:43], v25 offset:24832
    v_mfma_f32_16x16x32_bf16 v[212:215], v[48:51], v[92:95], v[212:215]
    ds_read_b64_tr_b16 v[44:45], v22 offset:24576
    ds_read_b64_tr_b16 v[46:47], v22 offset:24832
    v_mfma_f32_16x16x32_bf16 v[244:247], v[48:51], v[96:99], v[244:247]
    s_add_u32 m0, s67, 30976
    v_mfma_f32_16x16x32_bf16 v[184:187], v[52:55], v[88:91], v[184:187]
    buffer_load_dwordx4 v18, s[4:7], s64 offen offset:1792 lds
    ds_read_b64_tr_b16 v[48:49], v26 offset:24576
    ds_read_b64_tr_b16 v[50:51], v26 offset:24832
    v_mfma_f32_16x16x32_bf16 v[216:219], v[52:55], v[92:95], v[216:219]
    v_mfma_f32_16x16x32_bf16 v[248:251], v[52:55], v[96:99], v[248:251]
    s_add_u32 m0, s67, 32000
    v_mfma_f32_16x16x32_bf16 v[188:191], v[56:59], v[88:91], v[188:191]
    buffer_load_dwordx4 v19, s[4:7], s64 offen offset:1792 lds
    ds_read_b64_tr_b16 v[52:53], v23 offset:24576
    ds_read_b64_tr_b16 v[54:55], v23 offset:24832
    v_mfma_f32_16x16x32_bf16 v[220:223], v[56:59], v[92:95], v[220:223]
    s_add_u32 s28, s28, 0x40000
    v_mfma_f32_16x16x32_bf16 v[252:255], v[56:59], v[96:99], v[252:255]
    s_add_u32 m0, s67, 33024
    s_waitcnt lgkmcnt(10)
    v_mfma_f32_16x16x32_bf16 v[160:163], v[28:31], v[100:103], v[160:163]
    buffer_load_dwordx4 v18, s[4:7], s65 offen offset:1792 lds
    v_mfma_f32_16x16x32_bf16 v[192:195], v[28:31], v[104:107], v[192:195]
    v_mfma_f32_16x16x32_bf16 v[224:227], v[28:31], v[108:111], v[224:227]
    s_add_u32 m0, s67, 34048
    v_mfma_f32_16x16x32_bf16 v[164:167], v[32:35], v[100:103], v[164:167]
    buffer_load_dwordx4 v19, s[4:7], s65 offen offset:1792 lds
    ds_read_b64_tr_b16 v[56:57], v27 offset:24576
    ds_read_b64_tr_b16 v[58:59], v27 offset:24832
    v_mfma_f32_16x16x32_bf16 v[196:199], v[32:35], v[104:107], v[196:199]
    v_mfma_f32_16x16x32_bf16 v[228:231], v[32:35], v[108:111], v[228:231]
    s_add_u32 m0, s67, 35072
    s_waitcnt lgkmcnt(8)
    v_mfma_f32_16x16x32_bf16 v[168:171], v[36:39], v[100:103], v[168:171]
    buffer_load_dwordx4 v18, s[4:7], s66 offen offset:1792 lds
    v_mfma_f32_16x16x32_bf16 v[200:203], v[36:39], v[104:107], v[200:203]
    v_mfma_f32_16x16x32_bf16 v[232:235], v[36:39], v[108:111], v[232:235]
    s_add_u32 m0, s67, 36096
    v_mfma_f32_16x16x32_bf16 v[172:175], v[40:43], v[100:103], v[172:175]
    buffer_load_dwordx4 v19, s[4:7], s66 offen offset:1792 lds
    v_mfma_f32_16x16x32_bf16 v[204:207], v[40:43], v[104:107], v[204:207]
    v_mfma_f32_16x16x32_bf16 v[236:239], v[40:43], v[108:111], v[236:239]
    s_waitcnt vmcnt(16) lgkmcnt(0)
    s_barrier
    v_mfma_f32_16x16x32_bf16 v[176:179], v[44:47], v[100:103], v[176:179]
    ds_read_b64_tr_b16 v[28:29], v20 offset:0
    ds_read_b64_tr_b16 v[30:31], v20 offset:256
    s_add_u32 m0, s68, 24576
    v_mfma_f32_16x16x32_bf16 v[208:211], v[44:47], v[104:107], v[208:211]
    buffer_load_dwordx4 v16, s[8:11], s28 offen lds
    ds_read_b64_tr_b16 v[32:33], v24 offset:0
    ds_read_b64_tr_b16 v[34:35], v24 offset:256
    v_mfma_f32_16x16x32_bf16 v[240:243], v[44:47], v[108:111], v[240:243]
    ds_read_b64_tr_b16 v[36:37], v21 offset:0
    ds_read_b64_tr_b16 v[38:39], v21 offset:256
    s_add_u32 m0, s68, 25600
    v_mfma_f32_16x16x32_bf16 v[180:183], v[48:51], v[100:103], v[180:183]
    buffer_load_dwordx4 v17, s[8:11], s28 offen lds
    ds_read_b64_tr_b16 v[40:41], v25 offset:0
    ds_read_b64_tr_b16 v[42:43], v25 offset:256
    v_mfma_f32_16x16x32_bf16 v[212:215], v[48:51], v[104:107], v[212:215]
    ds_read_b64_tr_b16 v[44:45], v22 offset:0
    ds_read_b64_tr_b16 v[46:47], v22 offset:256
    v_mfma_f32_16x16x32_bf16 v[244:247], v[48:51], v[108:111], v[244:247]
    v_mfma_f32_16x16x32_bf16 v[184:187], v[52:55], v[100:103], v[184:187]
    ds_read_b64_tr_b16 v[48:49], v26 offset:0
    ds_read_b64_tr_b16 v[50:51], v26 offset:256
    v_mfma_f32_16x16x32_bf16 v[216:219], v[52:55], v[104:107], v[216:219]
    v_mfma_f32_16x16x32_bf16 v[248:251], v[52:55], v[108:111], v[248:251]
    v_mfma_f32_16x16x32_bf16 v[188:191], v[56:59], v[100:103], v[188:191]
    ds_read_b64_tr_b16 v[52:53], v23 offset:0
    ds_read_b64_tr_b16 v[54:55], v23 offset:256
    v_mfma_f32_16x16x32_bf16 v[220:223], v[56:59], v[104:107], v[220:223]
    s_add_u32 s28, s28, 0x40000
    v_mfma_f32_16x16x32_bf16 v[252:255], v[56:59], v[108:111], v[252:255]
    s_waitcnt lgkmcnt(10)
    v_mfma_f32_16x16x32_bf16 v[160:163], v[28:31], v[64:67], v[160:163]
    v_mfma_f32_16x16x32_bf16 v[192:195], v[28:31], v[68:71], v[192:195]
    s_or_b32 s37, s71, s24
    s_cmp_lg_u32 s37, 0
    s_cbranch_scc1 L_nopf
    s_and_b32 s37, s2, 255
    s_lshl_b32 s37, s37, 7
    s_add_u32 s37, s37, 46211072
    s_mov_b64 exec, 1
    s_nop 0
    buffer_store_dword v63, v62, s[20:23], s37 offen sc1
    s_mov_b64 exec, -1
L_nopf:
    v_mfma_f32_16x16x32_bf16 v[224:227], v[28:31], v[72:75], v[224:227]
    v_mfma_f32_16x16x32_bf16 v[164:167], v[32:35], v[64:67], v[164:167]
    s_waitcnt vmcnt(12)
    ds_read_b64_tr_b16 v[56:57], v27 offset:0
    ds_read_b64_tr_b16 v[58:59], v27 offset:256
    v_mfma_f32_16x16x32_bf16 v[196:199], v[32:35], v[68:71], v[196:199]
    ds_read_b128 v[88:91], v60 offset:24576
    v_mfma_f32_16x16x32_bf16 v[228:231], v[32:35], v[72:75], v[228:231]
    ds_read_b128 v[92:95], v60 offset:26624
    s_waitcnt lgkmcnt(10)
    v_mfma_f32_16x16x32_bf16 v[168:171], v[36:39], v[64:67], v[168:171]
    ds_read_b128 v[96:99], v60 offset:28672
    v_mfma_f32_16x16x32_bf16 v[200:203], v[36:39], v[68:71], v[200:203]
    ds_read_b128 v[100:103], v61 offset:24576
    v_mfma_f32_16x16x32_bf16 v[232:235], v[36:39], v[72:75], v[232:235]
    ds_read_b128 v[104:107], v61 offset:26624
    v_mfma_f32_16x16x32_bf16 v[172:175], v[40:43], v[64:67], v[172:175]
    ds_read_b128 v[108:111], v61 offset:28672
    v_mfma_f32_16x16x32_bf16 v[204:207], v[40:43], v[68:71], v[204:207]
    v_mfma_f32_16x16x32_bf16 v[236:239], v[40:43], v[72:75], v[236:239]
    s_waitcnt vmcnt(10) lgkmcnt(0)
    s_barrier
    v_mfma_f32_16x16x32_bf16 v[176:179], v[44:47], v[64:67], v[176:179]
    ds_read_b64_tr_b16 v[28:29], v20 offset:8192
    ds_read_b64_tr_b16 v[30:31], v20 offset:8448
    s_add_u32 m0, s68, 0
    v_mfma_f32_16x16x32_bf16 v[208:211], v[44:47], v[68:71], v[208:211]
    buffer_load_dwordx4 v16, s[8:11], s28 offen lds
    ds_read_b64_tr_b16 v[32:33], v24 offset:8192
    ds_read_b64_tr_b16 v[34:35], v24 offset:8448
    v_mfma_f32_16x16x32_bf16 v[240:243], v[44:47], v[72:75], v[240:243]
    ds_read_b64_tr_b16 v[36:37], v21 offset:8192
    ds_read_b64_tr_b16 v[38:39], v21 offset:8448
    s_add_u32 m0, s68, 1024
    v_mfma_f32_16x16x32_bf16 v[180:183], v[48:51], v[64:67], v[180:183]
    buffer_load_dwordx4 v17, s[8:11], s28 offen lds
    ds_read_b64_tr_b16 v[40:41], v25 offset:8192
    ds_read_b64_tr_b16 v[42:43], v25 offset:8448
    v_mfma_f32_16x16x32_bf16 v[212:215], v[48:51], v[68:71], v[212:215]
    ds_read_b64_tr_b16 v[44:45], v22 offset:8192
    ds_read_b64_tr_b16 v[46:47], v22 offset:8448
    v_mfma_f32_16x16x32_bf16 v[244:247], v[48:51], v[72:75], v[244:247]
    s_add_u32 m0, s67, 55424
    v_mfma_f32_16x16x32_bf16 v[184:187], v[52:55], v[64:67], v[184:187]
    buffer_load_dwordx4 v18, s[4:7], s64 offen offset:1920 lds
    ds_read_b64_tr_b16 v[48:49], v26 offset:8192
    ds_read_b64_tr_b16 v[50:51], v26 offset:8448
    v_mfma_f32_16x16x32_bf16 v[216:219], v[52:55], v[68:71], v[216:219]
    v_mfma_f32_16x16x32_bf16 v[248:251], v[52:55], v[72:75], v[248:251]
    s_add_u32 m0, s67, 56448
    v_mfma_f32_16x16x32_bf16 v[188:191], v[56:59], v[64:67], v[188:191]
    buffer_load_dwordx4 v19, s[4:7], s64 offen offset:1920 lds
    ds_read_b64_tr_b16 v[52:53], v23 offset:8192
    ds_read_b64_tr_b16 v[54:55], v23 offset:8448
    v_mfma_f32_16x16x32_bf16 v[220:223], v[56:59], v[68:71], v[220:223]
    s_add_u32 s28, s28, 0x40000
    v_mfma_f32_16x16x32_bf16 v[252:255], v[56:59], v[72:75], v[252:255]
    s_add_u32 m0, s67, 57472
    s_waitcnt lgkmcnt(10)
    v_mfma_f32_16x16x32_bf16 v[160:163], v[28:31], v[76:79], v[160:163]
    buffer_load_dwordx4 v18, s[4:7], s65 offen offset:1920 lds
    v_mfma_f32_16x16x32_bf16 v[192:195], v[28:31], v[80:83], v[192:195]
    v_mfma_f32_16x16x32_bf16 v[224:227], v[28:31], v[84:87], v[224:227]
    s_add_u32 m0, s67, 58496
    v_mfma_f32_16x16x32_bf16 v[164:167], v[32:35], v[76:79], v[164:167]
    buffer_load_dwordx4 v19, s[4:7], s65 offen offset:1920 lds
    ds_read_b64_tr_b16 v[56:57], v27 offset:8192
    ds_read_b64_tr_b16 v[58:59], v27 offset:8448
    v_mfma_f32_16x16x32_bf16 v[196:199], v[32:35], v[80:83], v[196:199]
    v_mfma_f32_16x16x32_bf16 v[228:231], v[32:35], v[84:87], v[228:231]
    s_add_u32 m0, s67, 59520
    s_waitcnt lgkmcnt(8)
    v_mfma_f32_16x16x32_bf16 v[168:171], v[36:39], v[76:79], v[168:171]
    buffer_load_dwordx4 v18, s[4:7], s66 offen offset:1920 lds
    v_mfma_f32_16x16x32_bf16 v[200:203], v[36:39], v[80:83], v[200:203]
    v_mfma_f32_16x16x32_bf16 v[232:235], v[36:39], v[84:87], v[232:235]
    s_add_u32 m0, s67, 60544
    v_mfma_f32_16x16x32_bf16 v[172:175], v[40:43], v[76:79], v[172:175]
    buffer_load_dwordx4 v19, s[4:7], s66 offen offset:1920 lds
    v_mfma_f32_16x16x32_bf16 v[204:207], v[40:43], v[80:83], v[204:207]
    v_mfma_f32_16x16x32_bf16 v[236:239], v[40:43], v[84:87], v[236:239]
    s_waitcnt vmcnt(16) lgkmcnt(0)
    s_barrier
    v_mfma_f32_16x16x32_bf16 v[176:179], v[44:47], v[76:79], v[176:179]
    ds_read_b64_tr_b16 v[28:29], v20 offset:16384
    ds_read_b64_tr_b16 v[30:31], v20 offset:16640
    s_add_u32 m0, s68, 8192
    v_mfma_f32_16x16x32_bf16 v[208:211], v[44:47], v[80:83], v[208:211]
    buffer_load_dwordx4 v16, s[8:11], s28 offen lds
    ds_read_b64_tr_b16 v[32:33], v24 offset:16384
    ds_read_b64_tr_b16 v[34:35], v24 offset:16640
    v_mfma_f32_16x16x32_bf16 v[240:243], v[44:47], v[84:87], v[240:243]
    ds_read_b64_tr_b16 v[36:37], v21 offset:16384
    ds_read_b64_tr_b16 v[38:39], v21 offset:16640
    s_add_u32 m0, s68, 9216
    v_mfma_f32_16x16x32_bf16 v[180:183], v[48:51], v[76:79], v[180:183]
    buffer_load_dwordx4 v17, s[8:11], s28 offen lds
    ds_read_b64_tr_b16 v[40:41], v25 offset:16384
    ds_read_b64_tr_b16 v[42:43], v25 offset:16640
    v_mfma_f32_16x16x32_bf16 v[212:215], v[48:51], v[80:83], v[212:215]
    ds_read_b64_tr_b16 v[44:45], v22 offset:16384
    ds_read_b64_tr_b16 v[46:47], v22 offset:16640
    v_mfma_f32_16x16x32_bf16 v[244:247], v[48:51], v[84:87], v[244:247]
    v_mfma_f32_16x16x32_bf16 v[184:187], v[52:55], v[76:79], v[184:187]
    ds_read_b64_tr_b16 v[48:49], v26 offset:16384
    ds_read_b64_tr_b16 v[50:51], v26 offset:16640
    v_mfma_f32_16x16x32_bf16 v[216:219], v[52:55], v[80:83], v[216:219]
    v_mfma_f32_16x16x32_bf16 v[248:251], v[52:55], v[84:87], v[248:251]
    v_mfma_f32_16x16x32_bf16 v[188:191], v[56:59], v[76:79], v[188:191]
    ds_read_b64_tr_b16 v[52:53], v23 offset:16384
    ds_read_b64_tr_b16 v[54:55], v23 offset:16640
    v_mfma_f32_16x16x32_bf16 v[220:223], v[56:59], v[80:83], v[220:223]
    s_add_u32 s28, s28, 0x40000
    v_mfma_f32_16x16x32_bf16 v[252:255], v[56:59], v[84:87], v[252:255]
    s_waitcnt lgkmcnt(10)
    v_mfma_f32_16x16x32_bf16 v[160:163], v[28:31], v[88:91], v[160:163]
    v_mfma_f32_16x16x32_bf16 v[192:195], v[28:31], v[92:95], v[192:195]
    v_mfma_f32_16x16x32_bf16 v[224:227], v[28:31], v[96:99], v[224:227]
    v_mfma_f32_16x16x32_bf16 v[164:167], v[32:35], v[88:91], v[164:167]
    s_waitcnt vmcnt(12)
    ds_read_b64_tr_b16 v[56:57], v27 offset:16384
    ds_read_b64_tr_b16 v[58:59], v27 offset:16640
    v_mfma_f32_16x16x32_bf16 v[196:199], v[32:35], v[92:95], v[196:199]
    ds_read_b128 v[64:67], v60 offset:0
    v_mfma_f32_16x16x32_bf16 v[228:231], v[32:35], v[96:99], v[228:231]
    ds_read_b128 v[68:71], v60 offset:2048
    s_waitcnt lgkmcnt(10)
    v_mfma_f32_16x16x32_bf16 v[168:171], v[36:39], v[88:91], v[168:171]
    ds_read_b128 v[72:75], v60 offset:4096
    v_mfma_f32_16x16x32_bf16 v[200:203], v[36:39], v[92:95], v[200:203]
    ds_read_b128 v[76:79], v61 offset:0
    v_mfma_f32_16x16x32_bf16 v[232:235], v[36:39], v[96:99], v[232:235]
    ds_read_b128 v[80:83], v61 offset:2048
    v_mfma_f32_16x16x32_bf16 v[172:175], v[40:43], v[88:91], v[172:175]
    ds_read_b128 v[84:87], v61 offset:4096
    v_mfma_f32_16x16x32_bf16 v[204:207], v[40:43], v[92:95], v[204:207]
    v_mfma_f32_16x16x32_bf16 v[236:239], v[40:43], v[96:99], v[236:239]
    s_waitcnt vmcnt(10) lgkmcnt(0)
    s_barrier
    v_mfma_f32_16x16x32_bf16 v[176:179], v[44:47], v[88:91], v[176:179]
    ds_read_b64_tr_b16 v[28:29], v20 offset:24576
    ds_read_b64_tr_b16 v[30:31], v20 offset:24832
    s_add_u32 m0, s68, 16384
    v_mfma_f32_16x16x32_bf16 v[208:211], v[44:47], v[92:95], v[208:211]
    buffer_load_dwordx4 v16, s[8:11], s28 offen lds
    ds_read_b64_tr_b16 v[32:33], v24 offset:24576
    ds_read_b64_tr_b16 v[34:35], v24 offset:24832
    v_mfma_f32_16x16x32_bf16 v[240:243], v[44:47], v[96:99], v[240:243]
    ds_read_b64_tr_b16 v[36:37], v21 offset:24576
    ds_read_b64_tr_b16 v[38:39], v21 offset:24832
    s_add_u32 m0, s68, 17408
    v_mfma_f32_16x16x32_bf16 v[180:183], v[48:51], v[88:91], v[180:183]
    buffer_load_dwordx4 v17, s[8:11], s28 offen lds
    ds_read_b64_tr_b16 v[40:41], v25 offset:24576
    ds_read_b64_tr_b16 v[42:43], v25 offset:24832
    v_mfma_f32_16x16x32_bf16 v[212:215], v[48:51], v[92:95], v[212:215]
    ds_read_b64_tr_b16 v[44:45], v22 offset:24576
    ds_read_b64_tr_b16 v[46:47], v22 offset:24832
    s_add_u32 m0, s33, 34816
    v_mfma_f32_16x16x32_bf16 v[244:247], v[48:51], v[96:99], v[244:247]
    buffer_load_dwordx4 v11, s[12:15], s30 offen nt lds
    v_mfma_f32_16x16x32_bf16 v[184:187], v[52:55], v[88:91], v[184:187]
    ds_read_b64_tr_b16 v[48:49], v26 offset:24576
    ds_read_b64_tr_b16 v[50:51], v26 offset:24832
    s_add_u32 m0, s33, 34880
    v_mfma_f32_16x16x32_bf16 v[216:219], v[52:55], v[92:95], v[216:219]
    buffer_load_dwordx4 v11, s[12:15], s30 offen offset:1024 nt lds
    v_mfma_f32_16x16x32_bf16 v[248:251], v[52:55], v[96:99], v[248:251]
    v_mfma_f32_16x16x32_bf16 v[188:191], v[56:59], v[88:91], v[188:191]
    ds_read_b64_tr_b16 v[52:53], v23 offset:24576
    ds_read_b64_tr_b16 v[54:55], v23 offset:24832
    v_mfma_f32_16x16x32_bf16 v[220:223], v[56:59], v[92:95], v[220:223]
    s_add_u32 s28, s28, 0x40000
    s_add_u32 s30, s30, 0x2000
    s_and_b32 s30, s30, 0x3ffff
    v_mfma_f32_16x16x32_bf16 v[252:255], v[56:59], v[96:99], v[252:255]
    s_waitcnt lgkmcnt(10)
    v_mfma_f32_16x16x32_bf16 v[160:163], v[28:31], v[100:103], v[160:163]
    v_mfma_f32_16x16x32_bf16 v[192:195], v[28:31], v[104:107], v[192:195]
    v_mfma_f32_16x16x32_bf16 v[224:227], v[28:31], v[108:111], v[224:227]
    v_mfma_f32_16x16x32_bf16 v[164:167], v[32:35], v[100:103], v[164:167]
    ds_read_b64_tr_b16 v[56:57], v27 offset:24576
    ds_read_b64_tr_b16 v[58:59], v27 offset:24832
    v_mfma_f32_16x16x32_bf16 v[196:199], v[32:35], v[104:107], v[196:199]
    v_mfma_f32_16x16x32_bf16 v[228:231], v[32:35], v[108:111], v[228:231]
    s_waitcnt lgkmcnt(8)
    v_mfma_f32_16x16x32_bf16 v[168:171], v[36:39], v[100:103], v[168:171]
    v_mfma_f32_16x16x32_bf16 v[200:203], v[36:39], v[104:107], v[200:203]
    v_mfma_f32_16x16x32_bf16 v[232:235], v[36:39], v[108:111], v[232:235]
    v_mfma_f32_16x16x32_bf16 v[172:175], v[40:43], v[100:103], v[172:175]
    v_mfma_f32_16x16x32_bf16 v[204:207], v[40:43], v[104:107], v[204:207]
    v_mfma_f32_16x16x32_bf16 v[236:239], v[40:43], v[108:111], v[236:239]
    s_waitcnt vmcnt(12) lgkmcnt(0)
    s_barrier
    v_mfma_f32_16x16x32_bf16 v[176:179], v[44:47], v[100:103], v[176:179]
    ds_read_b64_tr_b16 v[28:29], v20 offset:0
    ds_read_b64_tr_b16 v[30:31], v20 offset:256
    s_add_u32 m0, s68, 24576
    v_mfma_f32_16x16x32_bf16 v[208:211], v[44:47], v[104:107], v[208:211]
    buffer_load_dwordx4 v16, s[8:11], s28 offen lds
    ds_read_b64_tr_b16 v[32:33], v24 offset:0
    ds_read_b64_tr_b16 v[34:35], v24 offset:256
    v_mfma_f32_16x16x32_bf16 v[240:243], v[44:47], v[108:111], v[240:243]
    ds_read_b64_tr_b16 v[36:37], v21 offset:0
    ds_read_b64_tr_b16 v[38:39], v21 offset:256
    s_add_u32 m0, s68, 25600
    v_mfma_f32_16x16x32_bf16 v[180:183], v[48:51], v[100:103], v[180:183]
    buffer_load_dwordx4 v17, s[8:11], s28 offen lds
    ds_read_b64_tr_b16 v[40:41], v25 offset:0
    ds_read_b64_tr_b16 v[42:43], v25 offset:256
    v_mfma_f32_16x16x32_bf16 v[212:215], v[48:51], v[104:107], v[212:215]
    ds_read_b64_tr_b16 v[44:45], v22 offset:0
    ds_read_b64_tr_b16 v[46:47], v22 offset:256
    s_add_u32 m0, s34, 43520
    v_mfma_f32_16x16x32_bf16 v[244:247], v[48:51], v[108:111], v[244:247]
    buffer_load_dwordx4 v12, s[16:19], s31 offen nt lds
    v_mfma_f32_16x16x32_bf16 v[184:187], v[52:55], v[100:103], v[184:187]
    ds_read_b64_tr_b16 v[48:49], v26 offset:0
    ds_read_b64_tr_b16 v[50:51], v26 offset:256
    s_add_u32 m0, s34, 44320
    v_mfma_f32_16x16x32_bf16 v[216:219], v[52:55], v[104:107], v[216:219]
    buffer_load_dwordx4 v12, s[16:19], s31 offen offset:256 nt lds
    v_mfma_f32_16x16x32_bf16 v[248:251], v[52:55], v[108:111], v[248:251]
    v_mfma_f32_16x16x32_bf16 v[188:191], v[56:59], v[100:103], v[188:191]
    ds_read_b64_tr_b16 v[52:53], v23 offset:0
    ds_read_b64_tr_b16 v[54:55], v23 offset:256
    v_mfma_f32_16x16x32_bf16 v[220:223], v[56:59], v[104:107], v[220:223]
    s_add_u32 s28, s28, 0x40000
    s_add_u32 s31, s31, 0x2000
    s_and_b32 s31, s31, 0x3ffff
    v_mfma_f32_16x16x32_bf16 v[252:255], v[56:59], v[108:111], v[252:255]
    s_waitcnt lgkmcnt(10)
    v_mfma_f32_16x16x32_bf16 v[160:163], v[28:31], v[64:67], v[160:163]
    v_mfma_f32_16x16x32_bf16 v[192:195], v[28:31], v[68:71], v[192:195]
    v_mfma_f32_16x16x32_bf16 v[224:227], v[28:31], v[72:75], v[224:227]
    v_mfma_f32_16x16x32_bf16 v[164:167], v[32:35], v[64:67], v[164:167]
    s_waitcnt vmcnt(10)
    ds_read_b64_tr_b16 v[56:57], v27 offset:0
    ds_read_b64_tr_b16 v[58:59], v27 offset:256
    v_mfma_f32_16x16x32_bf16 v[196:199], v[32:35], v[68:71], v[196:199]
    ds_read_b128 v[88:91], v60 offset:24576
    v_mfma_f32_16x16x32_bf16 v[228:231], v[32:35], v[72:75], v[228:231]
    ds_read_b128 v[92:95], v60 offset:26624
    s_waitcnt lgkmcnt(10)
    v_mfma_f32_16x16x32_bf16 v[168:171], v[36:39], v[64:67], v[168:171]
    ds_read_b128 v[96:99], v60 offset:28672
    v_mfma_f32_16x16x32_bf16 v[200:203], v[36:39], v[68:71], v[200:203]
    ds_read_b128 v[100:103], v61 offset:24576
    v_mfma_f32_16x16x32_bf16 v[232:235], v[36:39], v[72:75], v[232:235]
    ds_read_b128 v[104:107], v61 offset:26624
    v_mfma_f32_16x16x32_bf16 v[172:175], v[40:43], v[64:67], v[172:175]
    ds_read_b128 v[108:111], v61 offset:28672
    v_mfma_f32_16x16x32_bf16 v[204:207], v[40:43], v[68:71], v[204:207]
    v_mfma_f32_16x16x32_bf16 v[236:239], v[40:43], v[72:75], v[236:239]
    s_waitcnt vmcnt(8) lgkmcnt(0)
    s_barrier
    v_mfma_f32_16x16x32_bf16 v[176:179], v[44:47], v[64:67], v[176:179]
    ds_read_b64_tr_b16 v[28:29], v20 offset:8192
    ds_read_b64_tr_b16 v[30:31], v20 offset:8448
    s_add_u32 m0, s33, 52224
    v_mfma_f32_16x16x32_bf16 v[208:211], v[44:47], v[68:71], v[208:211]
    buffer_load_dwordx4 v11, s[12:15], s30 offen nt lds
    ds_read_b64_tr_b16 v[32:33], v24 offset:8192
    ds_read_b64_tr_b16 v[34:35], v24 offset:8448
    v_mfma_f32_16x16x32_bf16 v[240:243], v[44:47], v[72:75], v[240:243]
    ds_read_b64_tr_b16 v[36:37], v21 offset:8192
    ds_read_b64_tr_b16 v[38:39], v21 offset:8448
    s_add_u32 m0, s33, 52288
    v_mfma_f32_16x16x32_bf16 v[180:183], v[48:51], v[64:67], v[180:183]
    buffer_load_dwordx4 v11, s[12:15], s30 offen offset:1024 nt lds
    ds_read_b64_tr_b16 v[40:41], v25 offset:8192
    ds_read_b64_tr_b16 v[42:43], v25 offset:8448
    v_mfma_f32_16x16x32_bf16 v[212:215], v[48:51], v[68:71], v[212:215]
    ds_read_b64_tr_b16 v[44:45], v22 offset:8192
    ds_read_b64_tr_b16 v[46:47], v22 offset:8448
    s_add_u32 m0, s34, 60928
    v_mfma_f32_16x16x32_bf16 v[244:247], v[48:51], v[72:75], v[244:247]
    buffer_load_dwordx4 v12, s[16:19], s31 offen nt lds
    v_mfma_f32_16x16x32_bf16 v[184:187], v[52:55], v[64:67], v[184:187]
    ds_read_b64_tr_b16 v[48:49], v26 offset:8192
    ds_read_b64_tr_b16 v[50:51], v26 offset:8448
    s_add_u32 m0, s34, 61728
    v_mfma_f32_16x16x32_bf16 v[216:219], v[52:55], v[68:71], v[216:219]
    buffer_load_dwordx4 v12, s[16:19], s31 offen offset:256 nt lds
    v_mfma_f32_16x16x32_bf16 v[248:251], v[52:55], v[72:75], v[248:251]
    v_mfma_f32_16x16x32_bf16 v[188:191], v[56:59], v[64:67], v[188:191]
    ds_read_b64_tr_b16 v[52:53], v23 offset:8192
    ds_read_b64_tr_b16 v[54:55], v23 offset:8448
    v_mfma_f32_16x16x32_bf16 v[220:223], v[56:59], v[68:71], v[220:223]
    s_add_u32 s30, s30, 0x2000
    s_and_b32 s30, s30, 0x3ffff
    s_add_u32 s31, s31, 0x2000
    s_and_b32 s31, s31, 0x3ffff
    v_mfma_f32_16x16x32_bf16 v[252:255], v[56:59], v[72:75], v[252:255]
    s_waitcnt lgkmcnt(10)
    v_mfma_f32_16x16x32_bf16 v[160:163], v[28:31], v[76:79], v[160:163]
    v_mfma_f32_16x16x32_bf16 v[192:195], v[28:31], v[80:83], v[192:195]
    v_mfma_f32_16x16x32_bf16 v[224:227], v[28:31], v[84:87], v[224:227]
    v_mfma_f32_16x16x32_bf16 v[164:167], v[32:35], v[76:79], v[164:167]
    ds_read_b64_tr_b16 v[56:57], v27 offset:8192
    ds_read_b64_tr_b16 v[58:59], v27 offset:8448
    v_mfma_f32_16x16x32_bf16 v[196:199], v[32:35], v[80:83], v[196:199]
    v_mfma_f32_16x16x32_bf16 v[228:231], v[32:35], v[84:87], v[228:231]
    s_waitcnt lgkmcnt(8)
    v_mfma_f32_16x16x32_bf16 v[168:171], v[36:39], v[76:79], v[168:171]
    v_mfma_f32_16x16x32_bf16 v[200:203], v[36:39], v[80:83], v[200:203]
    v_mfma_f32_16x16x32_bf16 v[232:235], v[36:39], v[84:87], v[232:235]
    v_mfma_f32_16x16x32_bf16 v[172:175], v[40:43], v[76:79], v[172:175]
    v_mfma_f32_16x16x32_bf16 v[204:207], v[40:43], v[80:83], v[204:207]
    v_mfma_f32_16x16x32_bf16 v[236:239], v[40:43], v[84:87], v[236:239]
    s_waitcnt vmcnt(10) lgkmcnt(0)
    s_barrier
    v_mfma_f32_16x16x32_bf16 v[176:179], v[44:47], v[76:79], v[176:179]
    ds_read_b64_tr_b16 v[28:29], v20 offset:16384
    ds_read_b64_tr_b16 v[30:31], v20 offset:16640
    s_add_u32 m0, s33, 69632
    v_mfma_f32_16x16x32_bf16 v[208:211], v[44:47], v[80:83], v[208:211]
    buffer_load_dwordx4 v11, s[12:15], s30 offen nt lds
    ds_read_b64_tr_b16 v[32:33], v24 offset:16384
    ds_read_b64_tr_b16 v[34:35], v24 offset:16640
    v_mfma_f32_16x16x32_bf16 v[240:243], v[44:47], v[84:87], v[240:243]
    ds_read_b64_tr_b16 v[36:37], v21 offset:16384
    ds_read_b64_tr_b16 v[38:39], v21 offset:16640
    s_add_u32 m0, s33, 69696
    v_mfma_f32_16x16x32_bf16 v[180:183], v[48:51], v[76:79], v[180:183]
    buffer_load_dwordx4 v11, s[12:15], s30 offen offset:1024 nt lds
    ds_read_b64_tr_b16 v[40:41], v25 offset:16384
    ds_read_b64_tr_b16 v[42:43], v25 offset:16640
    v_mfma_f32_16x16x32_bf16 v[212:215], v[48:51], v[80:83], v[212:215]
    ds_read_b64_tr_b16 v[44:45], v22 offset:16384
    ds_read_b64_tr_b16 v[46:47], v22 offset:16640
    s_add_u32 m0, s34, 0
    v_mfma_f32_16x16x32_bf16 v[244:247], v[48:51], v[84:87], v[244:247]
    buffer_load_dwordx4 v12, s[16:19], s31 offen nt lds
    v_mfma_f32_16x16x32_bf16 v[184:187], v[52:55], v[76:79], v[184:187]
    ds_read_b64_tr_b16 v[48:49], v26 offset:16384
    ds_read_b64_tr_b16 v[50:51], v26 offset:16640
    s_add_u32 m0, s34, 800
    v_mfma_f32_16x16x32_bf16 v[216:219], v[52:55], v[80:83], v[216:219]
    buffer_load_dwordx4 v12, s[16:19], s31 offen offset:256 nt lds
    v_mfma_f32_16x16x32_bf16 v[248:251], v[52:55], v[84:87], v[248:251]
    v_mfma_f32_16x16x32_bf16 v[188:191], v[56:59], v[76:79], v[188:191]
    ds_read_b64_tr_b16 v[52:53], v23 offset:16384
    ds_read_b64_tr_b16 v[54:55], v23 offset:16640
    v_mfma_f32_16x16x32_bf16 v[220:223], v[56:59], v[80:83], v[220:223]
    s_add_u32 s30, s30, 0x2000
    s_and_b32 s30, s30, 0x3ffff
    s_add_u32 s31, s31, 0x2000
    s_and_b32 s31, s31, 0x3ffff
    v_mfma_f32_16x16x32_bf16 v[252:255], v[56:59], v[84:87], v[252:255]
    s_waitcnt lgkmcnt(10)
    v_mfma_f32_16x16x32_bf16 v[160:163], v[28:31], v[88:91], v[160:163]
    v_mfma_f32_16x16x32_bf16 v[192:195], v[28:31], v[92:95], v[192:195]
    v_mfma_f32_16x16x32_bf16 v[224:227], v[28:31], v[96:99], v[224:227]
    v_mfma_f32_16x16x32_bf16 v[164:167], v[32:35], v[88:91], v[164:167]
    ds_read_b64_tr_b16 v[56:57], v27 offset:16384
    ds_read_b64_tr_b16 v[58:59], v27 offset:16640
    v_mfma_f32_16x16x32_bf16 v[196:199], v[32:35], v[92:95], v[196:199]
    v_mfma_f32_16x16x32_bf16 v[228:231], v[32:35], v[96:99], v[228:231]
    s_waitcnt lgkmcnt(8)
    v_mfma_f32_16x16x32_bf16 v[168:171], v[36:39], v[88:91], v[168:171]
    v_mfma_f32_16x16x32_bf16 v[200:203], v[36:39], v[92:95], v[200:203]
    v_mfma_f32_16x16x32_bf16 v[232:235], v[36:39], v[96:99], v[232:235]
    v_mfma_f32_16x16x32_bf16 v[172:175], v[40:43], v[88:91], v[172:175]
    v_mfma_f32_16x16x32_bf16 v[204:207], v[40:43], v[92:95], v[204:207]
    v_mfma_f32_16x16x32_bf16 v[236:239], v[40:43], v[96:99], v[236:239]
    s_waitcnt vmcnt(10) lgkmcnt(0)
    s_barrier
    v_mfma_f32_16x16x32_bf16 v[176:179], v[44:47], v[88:91], v[176:179]
    ds_read_b64_tr_b16 v[28:29], v20 offset:24576
    ds_read_b64_tr_b16 v[30:31], v20 offset:24832
    s_add_u32 m0, s33, 8704
    v_mfma_f32_16x16x32_bf16 v[208:211], v[44:47], v[92:95], v[208:211]
    buffer_load_dwordx4 v11, s[12:15], s30 offen nt lds
    ds_read_b64_tr_b16 v[32:33], v24 offset:24576
    ds_read_b64_tr_b16 v[34:35], v24 offset:24832
    v_mfma_f32_16x16x32_bf16 v[240:243], v[44:47], v[96:99], v[240:243]
    ds_read_b64_tr_b16 v[36:37], v21 offset:24576
    ds_read_b64_tr_b16 v[38:39], v21 offset:24832
    s_add_u32 m0, s33, 8768
    v_mfma_f32_16x16x32_bf16 v[180:183], v[48:51], v[88:91], v[180:183]
    buffer_load_dwordx4 v11, s[12:15], s30 offen offset:1024 nt lds
    ds_read_b64_tr_b16 v[40:41], v25 offset:24576
    ds_read_b64_tr_b16 v[42:43], v25 offset:24832
    v_mfma_f32_16x16x32_bf16 v[212:215], v[48:51], v[92:95], v[212:215]
    ds_read_b64_tr_b16 v[44:45], v22 offset:24576
    ds_read_b64_tr_b16 v[46:47], v22 offset:24832
    v_mfma_f32_16x16x32_bf16 v[244:247], v[48:51], v[96:99], v[244:247]
    v_mfma_f32_16x16x32_bf16 v[184:187], v[52:55], v[88:91], v[184:187]
    ds_read_b64_tr_b16 v[48:49], v26 offset:24576
    ds_read_b64_tr_b16 v[50:51], v26 offset:24832
    v_mfma_f32_16x16x32_bf16 v[216:219], v[52:55], v[92:95], v[216:219]
    v_mfma_f32_16x16x32_bf16 v[248:251], v[52:55], v[96:99], v[248:251]
    v_mfma_f32_16x16x32_bf16 v[188:191], v[56:59], v[88:91], v[188:191]
    ds_read_b64_tr_b16 v[52:53], v23 offset:24576
    ds_read_b64_tr_b16 v[54:55], v23 offset:24832
    v_mfma_f32_16x16x32_bf16 v[220:223], v[56:59], v[92:95], v[220:223]
    s_add_u32 s30, s30, 0x2000
    s_and_b32 s30, s30, 0x3ffff
    v_mfma_f32_16x16x32_bf16 v[252:255], v[56:59], v[96:99], v[252:255]
    s_waitcnt lgkmcnt(10)
    v_mfma_f32_16x16x32_bf16 v[160:163], v[28:31], v[100:103], v[160:163]
    v_mfma_f32_16x16x32_bf16 v[192:195], v[28:31], v[104:107], v[192:195]
    v_mfma_f32_16x16x32_bf16 v[224:227], v[28:31], v[108:111], v[224:227]
    v_mfma_f32_16x16x32_bf16 v[164:167], v[32:35], v[100:103], v[164:167]
    ds_read_b64_tr_b16 v[56:57], v27 offset:24576
    ds_read_b64_tr_b16 v[58:59], v27 offset:24832
    v_mfma_f32_16x16x32_bf16 v[196:199], v[32:35], v[104:107], v[196:199]
    v_mfma_f32_16x16x32_bf16 v[228:231], v[32:35], v[108:111], v[228:231]
    s_waitcnt lgkmcnt(8)
    v_mfma_f32_16x16x32_bf16 v[168:171], v[36:39], v[100:103], v[168:171]
    v_mfma_f32_16x16x32_bf16 v[200:203], v[36:39], v[104:107], v[200:203]
    v_mfma_f32_16x16x32_bf16 v[232:235], v[36:39], v[108:111], v[232:235]
    v_mfma_f32_16x16x32_bf16 v[172:175], v[40:43], v[100:103], v[172:175]
    v_mfma_f32_16x16x32_bf16 v[204:207], v[40:43], v[104:107], v[204:207]
    v_mfma_f32_16x16x32_bf16 v[236:239], v[40:43], v[108:111], v[236:239]
    s_waitcnt lgkmcnt(0)
    s_barrier
    v_mfma_f32_16x16x32_bf16 v[176:179], v[44:47], v[100:103], v[176:179]
    ds_read_b128 v[28:31], v9 offset:26112
    s_add_u32 m0, s34, 17408
    v_mfma_f32_16x16x32_bf16 v[208:211], v[44:47], v[104:107], v[208:211]
    buffer_load_dwordx4 v12, s[16:19], s31 offen nt lds
    ds_read_b128 v[32:35], v9 offset:26176
    v_mfma_f32_16x16x32_bf16 v[240:243], v[44:47], v[108:111], v[240:243]
    ds_read_b128 v[36:39], v9 offset:26240
    s_add_u32 m0, s34, 18208
    v_mfma_f32_16x16x32_bf16 v[180:183], v[48:51], v[100:103], v[180:183]
    buffer_load_dwordx4 v12, s[16:19], s31 offen offset:256 nt lds
    ds_read_b128 v[40:43], v9 offset:26304
    v_mfma_f32_16x16x32_bf16 v[212:215], v[48:51], v[104:107], v[212:215]
    ds_read_b128 v[44:47], v9 offset:30464
    v_mfma_f32_16x16x32_bf16 v[244:247], v[48:51], v[108:111], v[244:247]
    v_mfma_f32_16x16x32_bf16 v[184:187], v[52:55], v[100:103], v[184:187]
    ds_read_b128 v[48:51], v9 offset:30528
    v_mfma_f32_16x16x32_bf16 v[216:219], v[52:55], v[104:107], v[216:219]
    v_mfma_f32_16x16x32_bf16 v[248:251], v[52:55], v[108:111], v[248:251]
    v_mfma_f32_16x16x32_bf16 v[188:191], v[56:59], v[100:103], v[188:191]
    ds_read_b128 v[52:55], v9 offset:30592
    v_mfma_f32_16x16x32_bf16 v[220:223], v[56:59], v[104:107], v[220:223]
    s_add_u32 s31, s31, 0x2000
    s_and_b32 s31, s31, 0x3ffff
    v_mfma_f32_16x16x32_bf16 v[252:255], v[56:59], v[108:111], v[252:255]
    s_nop 7
    s_nop 1
    v_mul_f32 v160, s36, v160
    v_mul_f32 v161, s36, v161
    v_mul_f32 v162, s36, v162
    v_mul_f32 v163, s36, v163
    v_mul_f32 v164, s36, v164
    v_mul_f32 v165, s36, v165
    v_mul_f32 v166, s36, v166
    v_mul_f32 v167, s36, v167
    v_mul_f32 v168, s36, v168
    v_mul_f32 v169, s36, v169
    v_mul_f32 v170, s36, v170
    v_mul_f32 v171, s36, v171
    v_mul_f32 v172, s36, v172
    v_mul_f32 v173, s36, v173
    v_mul_f32 v174, s36, v174
    v_mul_f32 v175, s36, v175
    v_mul_f32 v176, s36, v176
    v_mul_f32 v177, s36, v177
    v_mul_f32 v178, s36, v178
    v_mul_f32 v179, s36, v179
    v_mul_f32 v180, s36, v180
    v_mul_f32 v181, s36, v181
    v_mul_f32 v182, s36, v182
    v_mul_f32 v183, s36, v183
    v_mul_f32 v184, s36, v184
    v_mul_f32 v185, s36, v185
    v_mul_f32 v186, s36, v186
    v_mul_f32 v187, s36, v187
    v_mul_f32 v188, s36, v188
    v_mul_f32 v189, s36, v189
    v_mul_f32 v190, s36, v190
    v_mul_f32 v191, s36, v191
    v_mul_f32 v192, s36, v192
    v_mul_f32 v193, s36, v193
    v_mul_f32 v194, s36, v194
    v_mul_f32 v195, s36, v195
    v_mul_f32 v196, s36, v196
    v_mul_f32 v197, s36, v197
    v_mul_f32 v198, s36, v198
    v_mul_f32 v199, s36, v199
    v_mul_f32 v200, s36, v200
    v_mul_f32 v201, s36, v201
    v_mul_f32 v202, s36, v202
    v_mul_f32 v203, s36, v203
    v_mul_f32 v204, s36, v204
    v_mul_f32 v205, s36, v205
    v_mul_f32 v206, s36, v206
    v_mul_f32 v207, s36, v207
    v_mul_f32 v208, s36, v208
    v_mul_f32 v209, s36, v209
    v_mul_f32 v210, s36, v210
    v_mul_f32 v211, s36, v211
    v_mul_f32 v212, s36, v212
    v_mul_f32 v213, s36, v213
    v_mul_f32 v214, s36, v214
    v_mul_f32 v215, s36, v215
    v_mul_f32 v216, s36, v216
    v_mul_f32 v217, s36, v217
    v_mul_f32 v218, s36, v218
    v_mul_f32 v219, s36, v219
    v_mul_f32 v220, s36, v220
    v_mul_f32 v221, s36, v221
    v_mul_f32 v222, s36, v222
    v_mul_f32 v223, s36, v223
    v_mul_f32 v224, s36, v224
    v_mul_f32 v225, s36, v225
    v_mul_f32 v226, s36, v226
    v_mul_f32 v227, s36, v227
    v_mul_f32 v228, s36, v228
    v_mul_f32 v229, s36, v229
    v_mul_f32 v230, s36, v230
    v_mul_f32 v231, s36, v231
    v_mul_f32 v232, s36, v232
    v_mul_f32 v233, s36, v233
    v_mul_f32 v234, s36, v234
    v_mul_f32 v235, s36, v235
    v_mul_f32 v236, s36, v236
    v_mul_f32 v237, s36, v237
    v_mul_f32 v238, s36, v238
    v_mul_f32 v239, s36, v239
    v_mul_f32 v240, s36, v240
    v_mul_f32 v241, s36, v241
    v_mul_f32 v242, s36, v242
    v_mul_f32 v243, s36, v243
    v_mul_f32 v244, s36, v244
    v_mul_f32 v245, s36, v245
    v_mul_f32 v246, s36, v246
    v_mul_f32 v247, s36, v247
    v_mul_f32 v248, s36, v248
    v_mul_f32 v249, s36, v249
    v_mul_f32 v250, s36, v250
    v_mul_f32 v251, s36, v251
    v_mul_f32 v252, s36, v252
    v_mul_f32 v253, s36, v253
    v_mul_f32 v254, s36, v254
    v_mul_f32 v255, s36, v255
    v_cvt_pk_bf16_f32 v112, v160, v161
    v_cvt_pk_bf16_f32 v113, v162, v163
    v_cvt_pk_bf16_f32 v114, v164, v165
    v_cvt_pk_bf16_f32 v115, v166, v167
    v_cvt_pk_bf16_f32 v116, v168, v169
    v_cvt_pk_bf16_f32 v117, v170, v171
    v_cvt_pk_bf16_f32 v118, v172, v173
    v_cvt_pk_bf16_f32 v119, v174, v175
    v_cvt_pk_bf16_f32 v120, v176, v177
    v_cvt_pk_bf16_f32 v121, v178, v179
    v_cvt_pk_bf16_f32 v122, v180, v181
    v_cvt_pk_bf16_f32 v123, v182, v183
    v_cvt_pk_bf16_f32 v124, v184, v185
    v_cvt_pk_bf16_f32 v125, v186, v187
    v_cvt_pk_bf16_f32 v126, v188, v189
    v_cvt_pk_bf16_f32 v127, v190, v191
    v_cvt_pk_bf16_f32 v128, v192, v193
    v_cvt_pk_bf16_f32 v129, v194, v195
    v_cvt_pk_bf16_f32 v130, v196, v197
    v_cvt_pk_bf16_f32 v131, v198, v199
    v_cvt_pk_bf16_f32 v132, v200, v201
    v_cvt_pk_bf16_f32 v133, v202, v203
    v_cvt_pk_bf16_f32 v134, v204, v205
    v_cvt_pk_bf16_f32 v135, v206, v207
    v_cvt_pk_bf16_f32 v136, v208, v209
    v_cvt_pk_bf16_f32 v137, v210, v211
    v_cvt_pk_bf16_f32 v138, v212, v213
    v_cvt_pk_bf16_f32 v139, v214, v215
    v_cvt_pk_bf16_f32 v140, v216, v217
    v_cvt_pk_bf16_f32 v141, v218, v219
    v_cvt_pk_bf16_f32 v142, v220, v221
    v_cvt_pk_bf16_f32 v143, v222, v223
    v_cvt_pk_bf16_f32 v144, v224, v225
    v_cvt_pk_bf16_f32 v145, v226, v227
    v_cvt_pk_bf16_f32 v146, v228, v229
    v_cvt_pk_bf16_f32 v147, v230, v231
    v_cvt_pk_bf16_f32 v148, v232, v233
    v_cvt_pk_bf16_f32 v149, v234, v235
    v_cvt_pk_bf16_f32 v150, v236, v237
    v_cvt_pk_bf16_f32 v151, v238, v239
    v_cvt_pk_bf16_f32 v152, v240, v241
    v_cvt_pk_bf16_f32 v153, v242, v243
    v_cvt_pk_bf16_f32 v154, v244, v245
    v_cvt_pk_bf16_f32 v155, v246, v247
    v_cvt_pk_bf16_f32 v156, v248, v249
    v_cvt_pk_bf16_f32 v157, v250, v251
    v_cvt_pk_bf16_f32 v158, v252, v253
    v_cvt_pk_bf16_f32 v159, v254, v255
    s_mov_b32 exec_lo, 0
    s_nop 0
    v_swap_b32 v112, v114
    v_swap_b32 v113, v115
    v_swap_b32 v116, v118
    v_swap_b32 v117, v119
    v_swap_b32 v120, v122
    v_swap_b32 v121, v123
    v_swap_b32 v124, v126
    v_swap_b32 v125, v127
    v_swap_b32 v128, v130
    v_swap_b32 v129, v131
    v_swap_b32 v132, v134
    v_swap_b32 v133, v135
    v_swap_b32 v136, v138
    v_swap_b32 v137, v139
    v_swap_b32 v140, v142
    v_swap_b32 v141, v143
    v_swap_b32 v144, v146
    v_swap_b32 v145, v147
    v_swap_b32 v148, v150
    v_swap_b32 v149, v151
    v_swap_b32 v152, v154
    v_swap_b32 v153, v155
    v_swap_b32 v156, v158
    v_swap_b32 v157, v159
    s_mov_b32 exec_lo, -1
    s_nop 1
L_tok:
    v_readfirstlane_b32 s3, v63
    s_nop 3
    s_cmp_eq_u32 s3, 0
    s_cbranch_scc1 L_tokslow
    s_cmp_eq_u32 s71, 1
    s_cselect_b32 s66, -1, 0
    s_cmp_eq_u32 s71, 1
    s_cbranch_scc1 L_aw
L_awback:
    s_waitcnt lgkmcnt(5)
    v_mfma_f32_16x16x32_bf16 v[64:67], v[28:31], v[112:115], 0
    v_mov_b32 v160, 0
    v_mov_b32 v161, 0
    v_mov_b32 v162, 0
    v_mov_b32 v163, 0
    v_mfma_f32_16x16x32_bf16 v[72:75], v[28:31], v[128:131], 0
    v_mov_b32 v164, 0
    v_mov_b32 v165, 0
    v_mov_b32 v166, 0
    v_mov_b32 v167, 0
    v_mfma_f32_16x16x32_bf16 v[80:83], v[28:31], v[144:147], 0
    v_mov_b32 v168, 0
    v_mov_b32 v169, 0
    v_mov_b32 v170, 0
    v_mov_b32 v171, 0
    v_mfma_f32_16x16x32_bf16 v[64:67], v[32:35], v[116:119], v[64:67]
    v_mov_b32 v172, 0
    v_mov_b32 v173, 0
    v_mov_b32 v174, 0
    v_mov_b32 v175, 0
    ds_read_b128 v[56:59], v9 offset:30656
    v_mfma_f32_16x16x32_bf16 v[72:75], v[32:35], v[132:135], v[72:75]
    v_mov_b32 v176, 0
    v_mov_b32 v177, 0
    v_mov_b32 v178, 0
    v_mov_b32 v179, 0
    v_mfma_f32_16x16x32_bf16 v[80:83], v[32:35], v[148:151], v[80:83]
    v_mov_b32 v180, 0
    v_mov_b32 v181, 0
    v_mov_b32 v182, 0
    v_mov_b32 v183, 0
    s_waitcnt lgkmcnt(4)
    v_mfma_f32_16x16x32_bf16 v[64:67], v[36:39], v[120:123], v[64:67]
    v_mov_b32 v184, 0
    v_mov_b32 v185, 0
    v_mov_b32 v186, 0
    v_mov_b32 v187, 0
    v_mfma_f32_16x16x32_bf16 v[72:75], v[36:39], v[136:139], v[72:75]
    v_mov_b32 v188, 0
    v_mov_b32 v189, 0
    v_mov_b32 v190, 0
    v_mov_b32 v191, 0
    v_mfma_f32_16x16x32_bf16 v[80:83], v[36:39], v[152:155], v[80:83]
    v_mov_b32 v192, 0
    v_mov_b32 v193, 0
    v_mov_b32 v194, 0
    v_mov_b32 v195, 0
    v_mfma_f32_16x16x32_bf16 v[64:67], v[40:43], v[124:127], v[64:67]
    v_mov_b32 v196, 0
    v_mov_b32 v197, 0
    v_mov_b32 v198, 0
    v_mov_b32 v199, 0
    v_mfma_f32_16x16x32_bf16 v[72:75], v[40:43], v[140:143], v[72:75]
    v_mov_b32 v200, 0
    v_mov_b32 v201, 0
    v_mov_b32 v202, 0
    v_mov_b32 v203, 0
    v_mfma_f32_16x16x32_bf16 v[80:83], v[40:43], v[156:159], v[80:83]
    v_mov_b32 v204, 0
    v_mov_b32 v205, 0
    v_mov_b32 v206, 0
    v_mov_b32 v207, 0
    s_waitcnt lgkmcnt(2)
    v_mfma_f32_16x16x32_bf16 v[68:71], v[44:47], v[112:115], 0
    v_mov_b32 v208, 0
    v_mov_b32 v209, 0
    v_mov_b32 v210, 0
    v_mov_b32 v211, 0
    v_mfma_f32_16x16x32_bf16 v[76:79], v[44:47], v[128:131], 0
    v_mov_b32 v212, 0
    v_mov_b32 v213, 0
    v_mov_b32 v214, 0
    v_mov_b32 v215, 0
    v_mfma_f32_16x16x32_bf16 v[84:87], v[44:47], v[144:147], 0
    v_mov_b32 v216, 0
    v_mov_b32 v217, 0
    v_mov_b32 v218, 0
    v_mov_b32 v219, 0
    v_mfma_f32_16x16x32_bf16 v[68:71], v[48:51], v[116:119], v[68:71]
    v_mov_b32 v220, 0
    v_mov_b32 v221, 0
    v_mov_b32 v222, 0
    v_mov_b32 v223, 0
    v_mfma_f32_16x16x32_bf16 v[76:79], v[48:51], v[132:135], v[76:79]
    v_mov_b32 v224, 0
    v_mov_b32 v225, 0
    v_mov_b32 v226, 0
    v_mov_b32 v227, 0
    v_mfma_f32_16x16x32_bf16 v[84:87], v[48:51], v[148:151], v[84:87]
    v_mov_b32 v228, 0
    v_mov_b32 v229, 0
    v_mov_b32 v230, 0
    v_mov_b32 v231, 0
    s_waitcnt lgkmcnt(0)
    v_mfma_f32_16x16x32_bf16 v[68:71], v[52:55], v[120:123], v[68:71]
    v_mov_b32 v232, 0
    v_mov_b32 v233, 0
    v_mov_b32 v234, 0
    v_mov_b32 v235, 0
    v_mfma_f32_16x16x32_bf16 v[76:79], v[52:55], v[136:139], v[76:79]
    v_mov_b32 v236, 0
    v_mov_b32 v237, 0
    v_mov_b32 v238, 0
    v_mov_b32 v239, 0
    v_mfma_f32_16x16x32_bf16 v[84:87], v[52:55], v[152:155], v[84:87]
    v_mov_b32 v240, 0
    v_mov_b32 v241, 0
    v_mov_b32 v242, 0
    v_mov_b32 v243, 0
    v_mfma_f32_16x16x32_bf16 v[68:71], v[56:59], v[124:127], v[68:71]
    v_mov_b32 v244, 0
    v_mov_b32 v245, 0
    v_mov_b32 v246, 0
    v_mov_b32 v247, 0
    v_mfma_f32_16x16x32_bf16 v[76:79], v[56:59], v[140:143], v[76:79]
    v_mov_b32 v248, 0
    v_mov_b32 v249, 0
    v_mov_b32 v250, 0
    v_mov_b32 v251, 0
    v_mfma_f32_16x16x32_bf16 v[84:87], v[56:59], v[156:159], v[84:87]
    v_mov_b32 v252, 0
    v_mov_b32 v253, 0
    v_mov_b32 v254, 0
    v_mov_b32 v255, 0
    s_nop 7
    s_nop 1
    v_max3_f32 v7, v64, v65, v66
    v_max3_f32 v7, v7, v67, v68
    v_max3_f32 v7, v7, v69, v70
    v_max_f32 v7, v7, v71
    v_mov_b32 v8, v7
    s_nop 1
    v_permlane16_swap_b32 v7, v8
    s_nop 1
    v_max_f32 v7, v7, v8
    v_mov_b32 v8, v7
    s_nop 1
    v_permlane32_swap_b32 v7, v8
    s_nop 1
    v_max_f32 v7, v7, v8
    v_sub_f32 v16, 0, v7
    v_sub_f32 v17, 0, v7
    v_sub_f32 v18, 0, v7
    v_sub_f32 v19, 0, v7
    v_sub_f32 v64, v64, v7
    v_sub_f32 v65, v65, v7
    v_sub_f32 v66, v66, v7
    v_sub_f32 v67, v67, v7
    v_sub_f32 v68, v68, v7
    v_sub_f32 v69, v69, v7
    v_sub_f32 v70, v70, v7
    v_sub_f32 v71, v71, v7
    v_mov_b32 v1, 0
    v_max3_f32 v7, v72, v73, v74
    v_max3_f32 v7, v7, v75, v76
    v_max3_f32 v7, v7, v77, v78
    v_max_f32 v7, v7, v79
    v_mov_b32 v8, v7
    s_nop 1
    v_permlane16_swap_b32 v7, v8
    s_nop 1
    v_max_f32 v7, v7, v8
    v_mov_b32 v8, v7
    s_nop 1
    v_permlane32_swap_b32 v7, v8
    s_nop 1
    v_max_f32 v7, v7, v8
    v_sub_f32 v20, 0, v7
    v_sub_f32 v21, 0, v7
    v_sub_f32 v22, 0, v7
    v_sub_f32 v23, 0, v7
    v_sub_f32 v72, v72, v7
    v_sub_f32 v73, v73, v7
    v_sub_f32 v74, v74, v7
    v_sub_f32 v75, v75, v7
    v_sub_f32 v76, v76, v7
    v_sub_f32 v77, v77, v7
    v_sub_f32 v78, v78, v7
    v_sub_f32 v79, v79, v7
    v_mov_b32 v2, 0
    v_max3_f32 v7, v80, v81, v82
    v_max3_f32 v7, v7, v83, v84
    v_max3_f32 v7, v7, v85, v86
    v_max_f32 v7, v7, v87
    v_mov_b32 v8, v7
    s_nop 1
    v_permlane16_swap_b32 v7, v8
    s_nop 1
    v_max_f32 v7, v7, v8
    v_mov_b32 v8, v7
    s_nop 1
    v_permlane32_swap_b32 v7, v8
    s_nop 1
    v_max_f32 v7, v7, v8
    v_sub_f32 v24, 0, v7
    v_sub_f32 v25, 0, v7
    v_sub_f32 v26, 0, v7
    v_sub_f32 v27, 0, v7
    v_sub_f32 v80, v80, v7
    v_sub_f32 v81, v81, v7
    v_sub_f32 v82, v82, v7
    v_sub_f32 v83, v83, v7
    v_sub_f32 v84, v84, v7
    v_sub_f32 v85, v85, v7
    v_sub_f32 v86, v86, v7
    v_sub_f32 v87, v87, v7
    v_mov_b32 v3, 0
    v_exp_f32 v64, v64
    v_exp_f32 v65, v65
    v_exp_f32 v66, v66
    v_exp_f32 v67, v67
    v_add_f32 v4, v64, v65
    v_exp_f32 v72, v72
    v_cvt_pk_bf16_f32 v64, v64, v65
    v_add_f32 v4, v4, v66
    v_exp_f32 v73, v73
    v_add_f32 v4, v4, v67
    v_cvt_pk_bf16_f32 v65, v66, v67
    v_exp_f32 v74, v74
    v_exp_f32 v75, v75
    v_add_f32 v5, v72, v73
    v_exp_f32 v80, v80
    v_cvt_pk_bf16_f32 v72, v72, v73
    v_add_f32 v5, v5, v74
    v_exp_f32 v81, v81
    v_add_f32 v5, v5, v75
    v_cvt_pk_bf16_f32 v73, v74, v75
    v_exp_f32 v82, v82
    v_exp_f32 v83, v83
    s_waitcnt vmcnt(10) lgkmcnt(0)
    s_barrier
    v_add_f32 v6, v80, v81
    ds_read_b128 v[28:31], v9 offset:43520
    s_add_u32 m0, s33, 34816
    s_nop 0
    v_cvt_pk_bf16_f32 v80, v80, v81
    v_add_f32 v6, v6, v82
    buffer_load_dwordx4 v11, s[12:15], s30 offen nt lds
    ds_read_b128 v[32:35], v9 offset:43584
    v_add_f32 v6, v6, v83
    v_cvt_pk_bf16_f32 v81, v82, v83
    ds_read_b128 v[36:39], v9 offset:43648
    ds_read_b128 v[40:43], v9 offset:43712
    s_add_u32 m0, s33, 34880
    s_nop 0
    buffer_load_dwordx4 v11, s[12:15], s30 offen offset:1024 nt lds
    ds_read_b128 v[44:47], v9 offset:47872
    ds_read_b128 v[48:51], v9 offset:47936
    ds_read_b128 v[52:55], v9 offset:48000
    s_mov_b32 s31, s30
    s_mov_b32 s39, 40960
    s_and_b32 s37, s39, 0xc0000
    s_add_u32 s30, s39, s70
    s_lshl_b32 s37, s37, 4
    s_and_b32 s30, s30, 0x3ffff
    s_or_b32 s30, s30, s37
    s_mov_b32 s32, 7
L_aloop:
    s_waitcnt lgkmcnt(5)
    v_mfma_f32_16x16x32_bf16 v[88:91], v[28:31], v[112:115], v[16:19]
    v_exp_f32 v68, v68
    v_mfma_f32_16x16x32_bf16 v[96:99], v[28:31], v[128:131], v[20:23]
    v_exp_f32 v69, v69
    v_mfma_f32_16x16x32_bf16 v[104:107], v[28:31], v[144:147], v[24:27]
    v_exp_f32 v70, v70
    v_mfma_f32_16x16x32_bf16 v[88:91], v[32:35], v[116:119], v[88:91]
    v_exp_f32 v71, v71
    ds_read_b128 v[56:59], v9 offset:48064
    v_mfma_f32_16x16x32_bf16 v[96:99], v[32:35], v[132:135], v[96:99]
    v_add_f32 v4, v4, v68
    v_add_f32 v4, v4, v69
    v_mfma_f32_16x16x32_bf16 v[104:107], v[32:35], v[148:151], v[104:107]
    v_cvt_pk_bf16_f32 v66, v68, v69
    v_add_f32 v4, v4, v70
    s_waitcnt lgkmcnt(4)
    v_mfma_f32_16x16x32_bf16 v[88:91], v[36:39], v[120:123], v[88:91]
    v_add_f32 v4, v4, v71
    v_cvt_pk_bf16_f32 v67, v70, v71
    ds_read_b64_tr_b16 v[28:29], v10 offset:43520
    ds_read_b64_tr_b16 v[30:31], v10 offset:44032
    v_mfma_f32_16x16x32_bf16 v[96:99], v[36:39], v[136:139], v[96:99]
    v_exp_f32 v76, v76
    v_mfma_f32_16x16x32_bf16 v[104:107], v[36:39], v[152:155], v[104:107]
    v_exp_f32 v77, v77
    v_mfma_f32_16x16x32_bf16 v[88:91], v[40:43], v[124:127], v[88:91]
    v_exp_f32 v78, v78
    ds_read_b64_tr_b16 v[32:33], v10 offset:43552
    ds_read_b64_tr_b16 v[34:35], v10 offset:44064
    v_mfma_f32_16x16x32_bf16 v[96:99], v[40:43], v[140:143], v[96:99]
    v_exp_f32 v79, v79
    v_mfma_f32_16x16x32_bf16 v[104:107], v[40:43], v[156:159], v[104:107]
    v_add_f32 v5, v5, v76
    v_add_f32 v5, v5, v77
    s_waitcnt lgkmcnt(6)
    v_mfma_f32_16x16x32_bf16 v[92:95], v[44:47], v[112:115], v[16:19]
    v_cvt_pk_bf16_f32 v74, v76, v77
    v_add_f32 v5, v5, v78
    ds_read_b64_tr_b16 v[36:37], v10 offset:43584
    ds_read_b64_tr_b16 v[38:39], v10 offset:44096
    v_mfma_f32_16x16x32_bf16 v[100:103], v[44:47], v[128:131], v[20:23]
    v_add_f32 v5, v5, v79
    v_cvt_pk_bf16_f32 v75, v78, v79
    v_mfma_f32_16x16x32_bf16 v[108:111], v[44:47], v[144:147], v[24:27]
    v_exp_f32 v84, v84
    v_mfma_f32_16x16x32_bf16 v[92:95], v[48:51], v[116:119], v[92:95]
    v_exp_f32 v85, v85
    ds_read_b64_tr_b16 v[40:41], v10 offset:43616
    ds_read_b64_tr_b16 v[42:43], v10 offset:44128
    v_mfma_f32_16x16x32_bf16 v[100:103], v[48:51], v[132:135], v[100:103]
    v_exp_f32 v86, v86
    v_mfma_f32_16x16x32_bf16 v[108:111], v[48:51], v[148:151], v[108:111]
    v_exp_f32 v87, v87
    s_waitcnt lgkmcnt(8)
    v_mfma_f32_16x16x32_bf16 v[92:95], v[52:55], v[120:123], v[92:95]
    v_add_f32 v6, v6, v84
    v_add_f32 v6, v6, v85
    ds_read_b64_tr_b16 v[44:45], v10 offset:43648
    ds_read_b64_tr_b16 v[46:47], v10 offset:44160
    v_mfma_f32_16x16x32_bf16 v[100:103], v[52:55], v[136:139], v[100:103]
    v_cvt_pk_bf16_f32 v82, v84, v85
    v_add_f32 v6, v6, v86
    v_mfma_f32_16x16x32_bf16 v[108:111], v[52:55], v[152:155], v[108:111]
    v_add_f32 v6, v6, v87
    v_cvt_pk_bf16_f32 v83, v86, v87
    v_mfma_f32_16x16x32_bf16 v[92:95], v[56:59], v[124:127], v[92:95]
    v_max3_f32 v7, v4, v5, v6
    ds_read_b64_tr_b16 v[48:49], v10 offset:43680
    ds_read_b64_tr_b16 v[50:51], v10 offset:44192
    v_mfma_f32_16x16x32_bf16 v[100:103], v[56:59], v[140:143], v[100:103]
    v_cmp_lt_f32 vcc, s35, v7
    v_mfma_f32_16x16x32_bf16 v[108:111], v[56:59], v[156:159], v[108:111]
    s_cbranch_vccnz L_slow0
L_back0:
    s_waitcnt lgkmcnt(8)
    v_mfma_f32_16x16x32_bf16 v[160:163], v[28:31], v[64:67], v[160:163]
    v_exp_f32 v88, v88
    ds_read_b64_tr_b16 v[52:53], v10 offset:43712
    ds_read_b64_tr_b16 v[54:55], v10 offset:44224
    v_mfma_f32_16x16x32_bf16 v[192:195], v[28:31], v[72:75], v[192:195]
    v_exp_f32 v89, v89
    v_mfma_f32_16x16x32_bf16 v[224:227], v[28:31], v[80:83], v[224:227]
    v_exp_f32 v90, v90
    v_mfma_f32_16x16x32_bf16 v[164:167], v[32:35], v[64:67], v[164:167]
    v_exp_f32 v91, v91
    ds_read_b64_tr_b16 v[56:57], v10 offset:43744
    ds_read_b64_tr_b16 v[58:59], v10 offset:44256
    v_mfma_f32_16x16x32_bf16 v[196:199], v[32:35], v[72:75], v[196:199]
    v_add_f32 v1, v1, v4
    v_add_f32 v4, v88, v89
    v_mfma_f32_16x16x32_bf16 v[228:231], v[32:35], v[80:83], v[228:231]
    v_cvt_pk_bf16_f32 v88, v88, v89
    v_add_f32 v4, v4, v90
    s_waitcnt lgkmcnt(8)
    v_mfma_f32_16x16x32_bf16 v[168:171], v[36:39], v[64:67], v[168:171]
    v_add_f32 v4, v4, v91
    v_cvt_pk_bf16_f32 v89, v90, v91
    v_mfma_f32_16x16x32_bf16 v[200:203], v[36:39], v[72:75], v[200:203]
    v_exp_f32 v96, v96
    v_mfma_f32_16x16x32_bf16 v[232:235], v[36:39], v[80:83], v[232:235]
    v_exp_f32 v97, v97
    v_mfma_f32_16x16x32_bf16 v[172:175], v[40:43], v[64:67], v[172:175]
    v_exp_f32 v98, v98
    v_mfma_f32_16x16x32_bf16 v[204:207], v[40:43], v[72:75], v[204:207]
    v_exp_f32 v99, v99
    v_mfma_f32_16x16x32_bf16 v[236:239], v[40:43], v[80:83], v[236:239]
    v_add_f32 v2, v2, v5
    v_add_f32 v5, v96, v97
    s_waitcnt vmcnt(8) lgkmcnt(0)
    s_barrier
    v_mfma_f32_16x16x32_bf16 v[176:179], v[44:47], v[64:67], v[176:179]
    v_cvt_pk_bf16_f32 v96, v96, v97
    v_add_f32 v5, v5, v98
    ds_read_b128 v[28:31], v9 offset:60928
    s_add_u32 m0, s33, 52224
    v_mfma_f32_16x16x32_bf16 v[208:211], v[44:47], v[72:75], v[208:211]
    v_add_f32 v5, v5, v99
    v_cvt_pk_bf16_f32 v97, v98, v99
    buffer_load_dwordx4 v11, s[12:15], s30 offen nt lds
    ds_read_b128 v[32:35], v9 offset:60992
    v_mfma_f32_16x16x32_bf16 v[240:243], v[44:47], v[80:83], v[240:243]
    v_exp_f32 v104, v104
    s_cmp_eq_u32 s32, s66
    s_cbranch_scc1 L_sig
L_sigback:
    ds_read_b128 v[36:39], v9 offset:61056
    v_mfma_f32_16x16x32_bf16 v[180:183], v[48:51], v[64:67], v[180:183]
    v_exp_f32 v105, v105
    ds_read_b128 v[40:43], v9 offset:61120
    s_add_u32 m0, s33, 52288
    v_mfma_f32_16x16x32_bf16 v[212:215], v[48:51], v[72:75], v[212:215]
    v_exp_f32 v106, v106
    buffer_load_dwordx4 v11, s[12:15], s30 offen offset:1024 nt lds
    ds_read_b128 v[44:47], v9 offset:65280
    v_mfma_f32_16x16x32_bf16 v[244:247], v[48:51], v[80:83], v[244:247]
    v_exp_f32 v107, v107
    v_mfma_f32_16x16x32_bf16 v[184:187], v[52:55], v[64:67], v[184:187]
    v_add_f32 v3, v3, v6
    v_add_f32 v6, v104, v105
    ds_read_b128 v[48:51], v9 offset:65344
    s_add_u32 m0, s34, 43520
    v_mfma_f32_16x16x32_bf16 v[216:219], v[52:55], v[72:75], v[216:219]
    v_cvt_pk_bf16_f32 v104, v104, v105
    v_add_f32 v6, v6, v106
    buffer_load_dwordx4 v12, s[16:19], s31 offen nt lds
    v_mfma_f32_16x16x32_bf16 v[248:251], v[52:55], v[80:83], v[248:251]
    v_add_f32 v6, v6, v107
    v_cvt_pk_bf16_f32 v105, v106, v107
    v_mfma_f32_16x16x32_bf16 v[188:191], v[56:59], v[64:67], v[188:191]
    ds_read_b128 v[52:55], v9 offset:65408
    s_add_u32 m0, s34, 44320
    v_mfma_f32_16x16x32_bf16 v[220:223], v[56:59], v[72:75], v[220:223]
    buffer_load_dwordx4 v12, s[16:19], s31 offen offset:256 nt lds
    v_mfma_f32_16x16x32_bf16 v[252:255], v[56:59], v[80:83], v[252:255]
    s_mov_b32 s31, s30
    s_add_u32 s39, s39, 0x2000
    s_and_b32 s37, s39, 0xc0000
    s_add_u32 s30, s39, s70
    s_lshl_b32 s37, s37, 4
    s_and_b32 s30, s30, 0x3ffff
    s_or_b32 s30, s30, s37
    s_waitcnt lgkmcnt(5)
    v_mfma_f32_16x16x32_bf16 v[64:67], v[28:31], v[112:115], v[16:19]
    v_exp_f32 v92, v92
    v_mfma_f32_16x16x32_bf16 v[72:75], v[28:31], v[128:131], v[20:23]
    v_exp_f32 v93, v93
    v_mfma_f32_16x16x32_bf16 v[80:83], v[28:31], v[144:147], v[24:27]
    v_exp_f32 v94, v94
    v_mfma_f32_16x16x32_bf16 v[64:67], v[32:35], v[116:119], v[64:67]
    v_exp_f32 v95, v95
    ds_read_b128 v[56:59], v9 offset:65472
    v_mfma_f32_16x16x32_bf16 v[72:75], v[32:35], v[132:135], v[72:75]
    v_add_f32 v4, v4, v92
    v_add_f32 v4, v4, v93
    v_mfma_f32_16x16x32_bf16 v[80:83], v[32:35], v[148:151], v[80:83]
    v_cvt_pk_bf16_f32 v90, v92, v93
    v_add_f32 v4, v4, v94
    s_waitcnt lgkmcnt(4)
    v_mfma_f32_16x16x32_bf16 v[64:67], v[36:39], v[120:123], v[64:67]
    v_add_f32 v4, v4, v95
    v_cvt_pk_bf16_f32 v91, v94, v95
    ds_read_b64_tr_b16 v[28:29], v10 offset:60928
    ds_read_b64_tr_b16 v[30:31], v10 offset:61440
    v_mfma_f32_16x16x32_bf16 v[72:75], v[36:39], v[136:139], v[72:75]
    v_exp_f32 v100, v100
    v_mfma_f32_16x16x32_bf16 v[80:83], v[36:39], v[152:155], v[80:83]
    v_exp_f32 v101, v101
    v_mfma_f32_16x16x32_bf16 v[64:67], v[40:43], v[124:127], v[64:67]
    v_exp_f32 v102, v102
    ds_read_b64_tr_b16 v[32:33], v10 offset:60960
    ds_read_b64_tr_b16 v[34:35], v10 offset:61472
    v_mfma_f32_16x16x32_bf16 v[72:75], v[40:43], v[140:143], v[72:75]
    v_exp_f32 v103, v103
    v_mfma_f32_16x16x32_bf16 v[80:83], v[40:43], v[156:159], v[80:83]
    v_add_f32 v5, v5, v100
    v_add_f32 v5, v5, v101
    s_waitcnt lgkmcnt(6)
    v_mfma_f32_16x16x32_bf16 v[68:71], v[44:47], v[112:115], v[16:19]
    v_cvt_pk_bf16_f32 v98, v100, v101
    v_add_f32 v5, v5, v102
    ds_read_b64_tr_b16 v[36:37], v10 offset:60992
    ds_read_b64_tr_b16 v[38:39], v10 offset:61504
    v_mfma_f32_16x16x32_bf16 v[76:79], v[44:47], v[128:131], v[20:23]
    v_add_f32 v5, v5, v103
    v_cvt_pk_bf16_f32 v99, v102, v103
    v_mfma_f32_16x16x32_bf16 v[84:87], v[44:47], v[144:147], v[24:27]
    v_exp_f32 v108, v108
    v_mfma_f32_16x16x32_bf16 v[68:71], v[48:51], v[116:119], v[68:71]
    v_exp_f32 v109, v109
    ds_read_b64_tr_b16 v[40:41], v10 offset:61024
    ds_read_b64_tr_b16 v[42:43], v10 offset:61536
    v_mfma_f32_16x16x32_bf16 v[76:79], v[48:51], v[132:135], v[76:79]
    v_exp_f32 v110, v110
    v_mfma_f32_16x16x32_bf16 v[84:87], v[48:51], v[148:151], v[84:87]
    v_exp_f32 v111, v111
    s_waitcnt lgkmcnt(8)
    v_mfma_f32_16x16x32_bf16 v[68:71], v[52:55], v[120:123], v[68:71]
    v_add_f32 v6, v6, v108
    v_add_f32 v6, v6, v109
    ds_read_b64_tr_b16 v[44:45], v10 offset:61056
    ds_read_b64_tr_b16 v[46:47], v10 offset:61568
    v_mfma_f32_16x16x32_bf16 v[76:79], v[52:55], v[136:139], v[76:79]
    v_cvt_pk_bf16_f32 v106, v108, v109
    v_add_f32 v6, v6, v110
    v_mfma_f32_16x16x32_bf16 v[84:87], v[52:55], v[152:155], v[84:87]
    v_add_f32 v6, v6, v111
    v_cvt_pk_bf16_f32 v107, v110, v111
    v_mfma_f32_16x16x32_bf16 v[68:71], v[56:59], v[124:127], v[68:71]
    v_max3_f32 v7, v4, v5, v6
    ds_read_b64_tr_b16 v[48:49], v10 offset:61088
    ds_read_b64_tr_b16 v[50:51], v10 offset:61600
    v_mfma_f32_16x16x32_bf16 v[76:79], v[56:59], v[140:143], v[76:79]
    v_cmp_lt_f32 vcc, s35, v7
    v_mfma_f32_16x16x32_bf16 v[84:87], v[56:59], v[156:159], v[84:87]
    s_cbranch_vccnz L_slow1
L_back1:
    s_waitcnt lgkmcnt(8)
    v_mfma_f32_16x16x32_bf16 v[160:163], v[28:31], v[88:91], v[160:163]
    v_exp_f32 v64, v64
    ds_read_b64_tr_b16 v[52:53], v10 offset:61120
    ds_read_b64_tr_b16 v[54:55], v10 offset:61632
    v_mfma_f32_16x16x32_bf16 v[192:195], v[28:31], v[96:99], v[192:195]
    v_exp_f32 v65, v65
    v_mfma_f32_16x16x32_bf16 v[224:227], v[28:31], v[104:107], v[224:227]
    v_exp_f32 v66, v66
    v_mfma_f32_16x16x32_bf16 v[164:167], v[32:35], v[88:91], v[164:167]
    v_exp_f32 v67, v67
    ds_read_b64_tr_b16 v[56:57], v10 offset:61152
    ds_read_b64_tr_b16 v[58:59], v10 offset:61664
    v_mfma_f32_16x16x32_bf16 v[196:199], v[32:35], v[96:99], v[196:199]
    v_add_f32 v1, v1, v4
    v_add_f32 v4, v64, v65
    v_mfma_f32_16x16x32_bf16 v[228:231], v[32:35], v[104:107], v[228:231]
    v_cvt_pk_bf16_f32 v64, v64, v65
    v_add_f32 v4, v4, v66
    s_waitcnt lgkmcnt(8)
    v_mfma_f32_16x16x32_bf16 v[168:171], v[36:39], v[88:91], v[168:171]
    v_add_f32 v4, v4, v67
    v_cvt_pk_bf16_f32 v65, v66, v67
    v_mfma_f32_16x16x32_bf16 v[200:203], v[36:39], v[96:99], v[200:203]
    v_exp_f32 v72, v72
    v_mfma_f32_16x16x32_bf16 v[232:235], v[36:39], v[104:107], v[232:235]
    v_exp_f32 v73, v73
    v_mfma_f32_16x16x32_bf16 v[172:175], v[40:43], v[88:91], v[172:175]
    v_exp_f32 v74, v74
    v_mfma_f32_16x16x32_bf16 v[204:207], v[40:43], v[96:99], v[204:207]
    v_exp_f32 v75, v75
    v_mfma_f32_16x16x32_bf16 v[236:239], v[40:43], v[104:107], v[236:239]
    v_add_f32 v2, v2, v5
    v_add_f32 v5, v72, v73
    s_waitcnt vmcnt(8) lgkmcnt(0)
    s_barrier
    v_mfma_f32_16x16x32_bf16 v[176:179], v[44:47], v[88:91], v[176:179]
    v_cvt_pk_bf16_f32 v72, v72, v73
    v_add_f32 v5, v5, v74
    ds_read_b128 v[28:31], v9 offset:0
    s_add_u32 m0, s33, 69632
    v_mfma_f32_16x16x32_bf16 v[208:211], v[44:47], v[96:99], v[208:211]
    v_add_f32 v5, v5, v75
    v_cvt_pk_bf16_f32 v73, v74, v75
    buffer_load_dwordx4 v11, s[12:15], s30 offen nt lds
    ds_read_b128 v[32:35], v9 offset:64
    v_mfma_f32_16x16x32_bf16 v[240:243], v[44:47], v[104:107], v[240:243]
    v_exp_f32 v80, v80
    ds_read_b128 v[36:39], v9 offset:128
    v_mfma_f32_16x16x32_bf16 v[180:183], v[48:51], v[88:91], v[180:183]
    v_exp_f32 v81, v81
    ds_read_b128 v[40:43], v9 offset:192
    s_add_u32 m0, s33, 69696
    v_mfma_f32_16x16x32_bf16 v[212:215], v[48:51], v[96:99], v[212:215]
    v_exp_f32 v82, v82
    buffer_load_dwordx4 v11, s[12:15], s30 offen offset:1024 nt lds
    ds_read_b128 v[44:47], v9 offset:4352
    v_mfma_f32_16x16x32_bf16 v[244:247], v[48:51], v[104:107], v[244:247]
    v_exp_f32 v83, v83
    v_mfma_f32_16x16x32_bf16 v[184:187], v[52:55], v[88:91], v[184:187]
    v_add_f32 v3, v3, v6
    v_add_f32 v6, v80, v81
    ds_read_b128 v[48:51], v9 offset:4416
    s_add_u32 m0, s34, 60928
    v_mfma_f32_16x16x32_bf16 v[216:219], v[52:55], v[96:99], v[216:219]
    v_cvt_pk_bf16_f32 v80, v80, v81
    v_add_f32 v6, v6, v82
    buffer_load_dwordx4 v12, s[16:19], s31 offen nt lds
    v_mfma_f32_16x16x32_bf16 v[248:251], v[52:55], v[104:107], v[248:251]
    v_add_f32 v6, v6, v83
    v_cvt_pk_bf16_f32 v81, v82, v83
    v_mfma_f32_16x16x32_bf16 v[188:191], v[56:59], v[88:91], v[188:191]
    ds_read_b128 v[52:55], v9 offset:4480
    s_add_u32 m0, s34, 61728
    v_mfma_f32_16x16x32_bf16 v[220:223], v[56:59], v[96:99], v[220:223]
    buffer_load_dwordx4 v12, s[16:19], s31 offen offset:256 nt lds
    v_mfma_f32_16x16x32_bf16 v[252:255], v[56:59], v[104:107], v[252:255]
    s_mov_b32 s31, s30
    s_add_u32 s39, s39, 0x2000
    s_and_b32 s37, s39, 0xc0000
    s_add_u32 s30, s39, s70
    s_lshl_b32 s37, s37, 4
    s_and_b32 s30, s30, 0x3ffff
    s_or_b32 s30, s30, s37
    s_waitcnt lgkmcnt(5)
    v_mfma_f32_16x16x32_bf16 v[88:91], v[28:31], v[112:115], v[16:19]
    v_exp_f32 v68, v68
    v_mfma_f32_16x16x32_bf16 v[96:99], v[28:31], v[128:131], v[20:23]
    v_exp_f32 v69, v69
    v_mfma_f32_16x16x32_bf16 v[104:107], v[28:31], v[144:147], v[24:27]
    v_exp_f32 v70, v70
    v_mfma_f32_16x16x32_bf16 v[88:91], v[32:35], v[116:119], v[88:91]
    v_exp_f32 v71, v71
    ds_read_b128 v[56:59], v9 offset:4544
    v_mfma_f32_16x16x32_bf16 v[96:99], v[32:35], v[132:135], v[96:99]
    v_add_f32 v4, v4, v68
    v_add_f32 v4, v4, v69
    v_mfma_f32_16x16x32_bf16 v[104:107], v[32:35], v[148:151], v[104:107]
    v_cvt_pk_bf16_f32 v66, v68, v69
    v_add_f32 v4, v4, v70
    s_waitcnt lgkmcnt(4)
    v_mfma_f32_16x16x32_bf16 v[88:91], v[36:39], v[120:123], v[88:91]
    v_add_f32 v4, v4, v71
    v_cvt_pk_bf16_f32 v67, v70, v71
    ds_read_b64_tr_b16 v[28:29], v10 offset:0
    ds_read_b64_tr_b16 v[30:31], v10 offset:512
    v_mfma_f32_16x16x32_bf16 v[96:99], v[36:39], v[136:139], v[96:99]
    v_exp_f32 v76, v76
    v_mfma_f32_16x16x32_bf16 v[104:107], v[36:39], v[152:155], v[104:107]
    v_exp_f32 v77, v77
    v_mfma_f32_16x16x32_bf16 v[88:91], v[40:43], v[124:127], v[88:91]
    v_exp_f32 v78, v78
    ds_read_b64_tr_b16 v[32:33], v10 offset:32
    ds_read_b64_tr_b16 v[34:35], v10 offset:544
    v_mfma_f32_16x16x32_bf16 v[96:99], v[40:43], v[140:143], v[96:99]
    v_exp_f32 v79, v79
    v_mfma_f32_16x16x32_bf16 v[104:107], v[40:43], v[156:159], v[104:107]
    v_add_f32 v5, v5, v76
    v_add_f32 v5, v5, v77
    s_waitcnt lgkmcnt(6)
    v_mfma_f32_16x16x32_bf16 v[92:95], v[44:47], v[112:115], v[16:19]
    v_cvt_pk_bf16_f32 v74, v76, v77
    v_add_f32 v5, v5, v78
    ds_read_b64_tr_b16 v[36:37], v10 offset:64
    ds_read_b64_tr_b16 v[38:39], v10 offset:576
    v_mfma_f32_16x16x32_bf16 v[100:103], v[44:47], v[128:131], v[20:23]
    v_add_f32 v5, v5, v79
    v_cvt_pk_bf16_f32 v75, v78, v79
    v_mfma_f32_16x16x32_bf16 v[108:111], v[44:47], v[144:147], v[24:27]
    v_exp_f32 v84, v84
    v_mfma_f32_16x16x32_bf16 v[92:95], v[48:51], v[116:119], v[92:95]
    v_exp_f32 v85, v85
    ds_read_b64_tr_b16 v[40:41], v10 offset:96
    ds_read_b64_tr_b16 v[42:43], v10 offset:608
    v_mfma_f32_16x16x32_bf16 v[100:103], v[48:51], v[132:135], v[100:103]
    v_exp_f32 v86, v86
    v_mfma_f32_16x16x32_bf16 v[108:111], v[48:51], v[148:151], v[108:111]
    v_exp_f32 v87, v87
    s_waitcnt lgkmcnt(8)
    v_mfma_f32_16x16x32_bf16 v[92:95], v[52:55], v[120:123], v[92:95]
    v_add_f32 v6, v6, v84
    v_add_f32 v6, v6, v85
    ds_read_b64_tr_b16 v[44:45], v10 offset:128
    ds_read_b64_tr_b16 v[46:47], v10 offset:640
    v_mfma_f32_16x16x32_bf16 v[100:103], v[52:55], v[136:139], v[100:103]
    v_cvt_pk_bf16_f32 v82, v84, v85
    v_add_f32 v6, v6, v86
    v_mfma_f32_16x16x32_bf16 v[108:111], v[52:55], v[152:155], v[108:111]
    v_add_f32 v6, v6, v87
    v_cvt_pk_bf16_f32 v83, v86, v87
    v_mfma_f32_16x16x32_bf16 v[92:95], v[56:59], v[124:127], v[92:95]
    v_max3_f32 v7, v4, v5, v6
    ds_read_b64_tr_b16 v[48:49], v10 offset:160
    ds_read_b64_tr_b16 v[50:51], v10 offset:672
    v_mfma_f32_16x16x32_bf16 v[100:103], v[56:59], v[140:143], v[100:103]
    v_cmp_lt_f32 vcc, s35, v7
    v_mfma_f32_16x16x32_bf16 v[108:111], v[56:59], v[156:159], v[108:111]
    s_cbranch_vccnz L_slow2
L_back2:
    s_waitcnt lgkmcnt(8)
    v_mfma_f32_16x16x32_bf16 v[160:163], v[28:31], v[64:67], v[160:163]
    v_exp_f32 v88, v88
    ds_read_b64_tr_b16 v[52:53], v10 offset:192
    ds_read_b64_tr_b16 v[54:55], v10 offset:704
    v_mfma_f32_16x16x32_bf16 v[192:195], v[28:31], v[72:75], v[192:195]
    v_exp_f32 v89, v89
    v_mfma_f32_16x16x32_bf16 v[224:227], v[28:31], v[80:83], v[224:227]
    v_exp_f32 v90, v90
    v_mfma_f32_16x16x32_bf16 v[164:167], v[32:35], v[64:67], v[164:167]
    v_exp_f32 v91, v91
    ds_read_b64_tr_b16 v[56:57], v10 offset:224
    ds_read_b64_tr_b16 v[58:59], v10 offset:736
    v_mfma_f32_16x16x32_bf16 v[196:199], v[32:35], v[72:75], v[196:199]
    v_add_f32 v1, v1, v4
    v_add_f32 v4, v88, v89
    v_mfma_f32_16x16x32_bf16 v[228:231], v[32:35], v[80:83], v[228:231]
    v_cvt_pk_bf16_f32 v88, v88, v89
    v_add_f32 v4, v4, v90
    s_waitcnt lgkmcnt(8)
    v_mfma_f32_16x16x32_bf16 v[168:171], v[36:39], v[64:67], v[168:171]
    v_add_f32 v4, v4, v91
    v_cvt_pk_bf16_f32 v89, v90, v91
    v_mfma_f32_16x16x32_bf16 v[200:203], v[36:39], v[72:75], v[200:203]
    v_exp_f32 v96, v96
    v_mfma_f32_16x16x32_bf16 v[232:235], v[36:39], v[80:83], v[232:235]
    v_exp_f32 v97, v97
    v_mfma_f32_16x16x32_bf16 v[172:175], v[40:43], v[64:67], v[172:175]
    v_exp_f32 v98, v98
    v_mfma_f32_16x16x32_bf16 v[204:207], v[40:43], v[72:75], v[204:207]
    v_exp_f32 v99, v99
    v_mfma_f32_16x16x32_bf16 v[236:239], v[40:43], v[80:83], v[236:239]
    v_add_f32 v2, v2, v5
    v_add_f32 v5, v96, v97
    s_waitcnt vmcnt(8) lgkmcnt(0)
    s_barrier
    v_mfma_f32_16x16x32_bf16 v[176:179], v[44:47], v[64:67], v[176:179]
    v_cvt_pk_bf16_f32 v96, v96, v97
    v_add_f32 v5, v5, v98
    ds_read_b128 v[28:31], v9 offset:26112
    s_add_u32 m0, s33, 8704
    v_mfma_f32_16x16x32_bf16 v[208:211], v[44:47], v[72:75], v[208:211]
    v_add_f32 v5, v5, v99
    v_cvt_pk_bf16_f32 v97, v98, v99
    buffer_load_dwordx4 v11, s[12:15], s30 offen nt lds
    ds_read_b128 v[32:35], v9 offset:26176
    v_mfma_f32_16x16x32_bf16 v[240:243], v[44:47], v[80:83], v[240:243]
    v_exp_f32 v104, v104
    ds_read_b128 v[36:39], v9 offset:26240
    v_mfma_f32_16x16x32_bf16 v[180:183], v[48:51], v[64:67], v[180:183]
    v_exp_f32 v105, v105
    ds_read_b128 v[40:43], v9 offset:26304
    s_add_u32 m0, s33, 8768
    v_mfma_f32_16x16x32_bf16 v[212:215], v[48:51], v[72:75], v[212:215]
    v_exp_f32 v106, v106
    buffer_load_dwordx4 v11, s[12:15], s30 offen offset:1024 nt lds
    ds_read_b128 v[44:47], v9 offset:30464
    v_mfma_f32_16x16x32_bf16 v[244:247], v[48:51], v[80:83], v[244:247]
    v_exp_f32 v107, v107
    v_mfma_f32_16x16x32_bf16 v[184:187], v[52:55], v[64:67], v[184:187]
    v_add_f32 v3, v3, v6
    v_add_f32 v6, v104, v105
    ds_read_b128 v[48:51], v9 offset:30528
    s_add_u32 m0, s34, 0
    v_mfma_f32_16x16x32_bf16 v[216:219], v[52:55], v[72:75], v[216:219]
    v_cvt_pk_bf16_f32 v104, v104, v105
    v_add_f32 v6, v6, v106
    buffer_load_dwordx4 v12, s[16:19], s31 offen nt lds
    v_mfma_f32_16x16x32_bf16 v[248:251], v[52:55], v[80:83], v[248:251]
    v_add_f32 v6, v6, v107
    v_cvt_pk_bf16_f32 v105, v106, v107
    v_mfma_f32_16x16x32_bf16 v[188:191], v[56:59], v[64:67], v[188:191]
    ds_read_b128 v[52:55], v9 offset:30592
    s_add_u32 m0, s34, 800
    v_mfma_f32_16x16x32_bf16 v[220:223], v[56:59], v[72:75], v[220:223]
    buffer_load_dwordx4 v12, s[16:19], s31 offen offset:256 nt lds
    v_mfma_f32_16x16x32_bf16 v[252:255], v[56:59], v[80:83], v[252:255]
    s_mov_b32 s31, s30
    s_add_u32 s39, s39, 0x2000
    s_and_b32 s37, s39, 0xc0000
    s_add_u32 s30, s39, s70
    s_lshl_b32 s37, s37, 4
    s_and_b32 s30, s30, 0x3ffff
    s_or_b32 s30, s30, s37
    s_waitcnt lgkmcnt(5)
    v_mfma_f32_16x16x32_bf16 v[64:67], v[28:31], v[112:115], v[16:19]
    v_exp_f32 v92, v92
    v_mfma_f32_16x16x32_bf16 v[72:75], v[28:31], v[128:131], v[20:23]
    v_exp_f32 v93, v93
    v_mfma_f32_16x16x32_bf16 v[80:83], v[28:31], v[144:147], v[24:27]
    v_exp_f32 v94, v94
    v_mfma_f32_16x16x32_bf16 v[64:67], v[32:35], v[116:119], v[64:67]
    v_exp_f32 v95, v95
    ds_read_b128 v[56:59], v9 offset:30656
    v_mfma_f32_16x16x32_bf16 v[72:75], v[32:35], v[132:135], v[72:75]
    v_add_f32 v4, v4, v92
    v_add_f32 v4, v4, v93
    v_mfma_f32_16x16x32_bf16 v[80:83], v[32:35], v[148:151], v[80:83]
    v_cvt_pk_bf16_f32 v90, v92, v93
    v_add_f32 v4, v4, v94
    s_waitcnt lgkmcnt(4)
    v_mfma_f32_16x16x32_bf16 v[64:67], v[36:39], v[120:123], v[64:67]
    v_add_f32 v4, v4, v95
    v_cvt_pk_bf16_f32 v91, v94, v95
    ds_read_b64_tr_b16 v[28:29], v10 offset:17408
    ds_read_b64_tr_b16 v[30:31], v10 offset:17920
    v_mfma_f32_16x16x32_bf16 v[72:75], v[36:39], v[136:139], v[72:75]
    v_exp_f32 v100, v100
    v_mfma_f32_16x16x32_bf16 v[80:83], v[36:39], v[152:155], v[80:83]
    v_exp_f32 v101, v101
    v_mfma_f32_16x16x32_bf16 v[64:67], v[40:43], v[124:127], v[64:67]
    v_exp_f32 v102, v102
    ds_read_b64_tr_b16 v[32:33], v10 offset:17440
    ds_read_b64_tr_b16 v[34:35], v10 offset:17952
    v_mfma_f32_16x16x32_bf16 v[72:75], v[40:43], v[140:143], v[72:75]
    v_exp_f32 v103, v103
    v_mfma_f32_16x16x32_bf16 v[80:83], v[40:43], v[156:159], v[80:83]
    v_add_f32 v5, v5, v100
    v_add_f32 v5, v5, v101
    s_waitcnt lgkmcnt(6)
    v_mfma_f32_16x16x32_bf16 v[68:71], v[44:47], v[112:115], v[16:19]
    v_cvt_pk_bf16_f32 v98, v100, v101
    v_add_f32 v5, v5, v102
    ds_read_b64_tr_b16 v[36:37], v10 offset:17472
    ds_read_b64_tr_b16 v[38:39], v10 offset:17984
    v_mfma_f32_16x16x32_bf16 v[76:79], v[44:47], v[128:131], v[20:23]
    v_add_f32 v5, v5, v103
    v_cvt_pk_bf16_f32 v99, v102, v103
    v_mfma_f32_16x16x32_bf16 v[84:87], v[44:47], v[144:147], v[24:27]
    v_exp_f32 v108, v108
    v_mfma_f32_16x16x32_bf16 v[68:71], v[48:51], v[116:119], v[68:71]
    v_exp_f32 v109, v109
    ds_read_b64_tr_b16 v[40:41], v10 offset:17504
    ds_read_b64_tr_b16 v[42:43], v10 offset:18016
    v_mfma_f32_16x16x32_bf16 v[76:79], v[48:51], v[132:135], v[76:79]
    v_exp_f32 v110, v110
    v_mfma_f32_16x16x32_bf16 v[84:87], v[48:51], v[148:151], v[84:87]
    v_exp_f32 v111, v111
    s_waitcnt lgkmcnt(8)
    v_mfma_f32_16x16x32_bf16 v[68:71], v[52:55], v[120:123], v[68:71]
    v_add_f32 v6, v6, v108
    v_add_f32 v6, v6, v109
    ds_read_b64_tr_b16 v[44:45], v10 offset:17536
    ds_read_b64_tr_b16 v[46:47], v10 offset:18048
    v_mfma_f32_16x16x32_bf16 v[76:79], v[52:55], v[136:139], v[76:79]
    v_cvt_pk_bf16_f32 v106, v108, v109
    v_add_f32 v6, v6, v110
    v_mfma_f32_16x16x32_bf16 v[84:87], v[52:55], v[152:155], v[84:87]
    v_add_f32 v6, v6, v111
    v_cvt_pk_bf16_f32 v107, v110, v111
    v_mfma_f32_16x16x32_bf16 v[68:71], v[56:59], v[124:127], v[68:71]
    v_max3_f32 v7, v4, v5, v6
    ds_read_b64_tr_b16 v[48:49], v10 offset:17568
    ds_read_b64_tr_b16 v[50:51], v10 offset:18080
    v_mfma_f32_16x16x32_bf16 v[76:79], v[56:59], v[140:143], v[76:79]
    v_cmp_lt_f32 vcc, s35, v7
    v_mfma_f32_16x16x32_bf16 v[84:87], v[56:59], v[156:159], v[84:87]
    s_cbranch_vccnz L_slow3
L_back3:
    s_waitcnt lgkmcnt(8)
    v_mfma_f32_16x16x32_bf16 v[160:163], v[28:31], v[88:91], v[160:163]
    v_exp_f32 v64, v64
    ds_read_b64_tr_b16 v[52:53], v10 offset:17600
    ds_read_b64_tr_b16 v[54:55], v10 offset:18112
    v_mfma_f32_16x16x32_bf16 v[192:195], v[28:31], v[96:99], v[192:195]
    v_exp_f32 v65, v65
    v_mfma_f32_16x16x32_bf16 v[224:227], v[28:31], v[104:107], v[224:227]
    v_exp_f32 v66, v66
    v_mfma_f32_16x16x32_bf16 v[164:167], v[32:35], v[88:91], v[164:167]
    v_exp_f32 v67, v67
    ds_read_b64_tr_b16 v[56:57], v10 offset:17632
    ds_read_b64_tr_b16 v[58:59], v10 offset:18144
    v_mfma_f32_16x16x32_bf16 v[196:199], v[32:35], v[96:99], v[196:199]
    v_add_f32 v1, v1, v4
    v_add_f32 v4, v64, v65
    v_mfma_f32_16x16x32_bf16 v[228:231], v[32:35], v[104:107], v[228:231]
    v_cvt_pk_bf16_f32 v64, v64, v65
    v_add_f32 v4, v4, v66
    s_waitcnt lgkmcnt(8)
    v_mfma_f32_16x16x32_bf16 v[168:171], v[36:39], v[88:91], v[168:171]
    v_add_f32 v4, v4, v67
    v_cvt_pk_bf16_f32 v65, v66, v67
    v_mfma_f32_16x16x32_bf16 v[200:203], v[36:39], v[96:99], v[200:203]
    v_exp_f32 v72, v72
    v_mfma_f32_16x16x32_bf16 v[232:235], v[36:39], v[104:107], v[232:235]
    v_exp_f32 v73, v73
    v_mfma_f32_16x16x32_bf16 v[172:175], v[40:43], v[88:91], v[172:175]
    v_exp_f32 v74, v74
    v_mfma_f32_16x16x32_bf16 v[204:207], v[40:43], v[96:99], v[204:207]
    v_exp_f32 v75, v75
    v_mfma_f32_16x16x32_bf16 v[236:239], v[40:43], v[104:107], v[236:239]
    v_add_f32 v2, v2, v5
    v_add_f32 v5, v72, v73
    s_waitcnt vmcnt(8) lgkmcnt(0)
    s_barrier
    v_mfma_f32_16x16x32_bf16 v[176:179], v[44:47], v[88:91], v[176:179]
    v_cvt_pk_bf16_f32 v72, v72, v73
    v_add_f32 v5, v5, v74
    ds_read_b128 v[28:31], v9 offset:43520
    s_add_u32 m0, s33, 34816
    v_mfma_f32_16x16x32_bf16 v[208:211], v[44:47], v[96:99], v[208:211]
    v_add_f32 v5, v5, v75
    v_cvt_pk_bf16_f32 v73, v74, v75
    buffer_load_dwordx4 v11, s[12:15], s30 offen nt lds
    ds_read_b128 v[32:35], v9 offset:43584
    v_mfma_f32_16x16x32_bf16 v[240:243], v[44:47], v[104:107], v[240:243]
    v_exp_f32 v80, v80
    ds_read_b128 v[36:39], v9 offset:43648
    v_mfma_f32_16x16x32_bf16 v[180:183], v[48:51], v[88:91], v[180:183]
    v_exp_f32 v81, v81
    ds_read_b128 v[40:43], v9 offset:43712
    s_add_u32 m0, s33, 34880
    v_mfma_f32_16x16x32_bf16 v[212:215], v[48:51], v[96:99], v[212:215]
    v_exp_f32 v82, v82
    buffer_load_dwordx4 v11, s[12:15], s30 offen offset:1024 nt lds
    ds_read_b128 v[44:47], v9 offset:47872
    v_mfma_f32_16x16x32_bf16 v[244:247], v[48:51], v[104:107], v[244:247]
    v_exp_f32 v83, v83
    v_mfma_f32_16x16x32_bf16 v[184:187], v[52:55], v[88:91], v[184:187]
    v_add_f32 v3, v3, v6
    v_add_f32 v6, v80, v81
    ds_read_b128 v[48:51], v9 offset:47936
    s_add_u32 m0, s34, 17408
    v_mfma_f32_16x16x32_bf16 v[216:219], v[52:55], v[96:99], v[216:219]
    v_cvt_pk_bf16_f32 v80, v80, v81
    v_add_f32 v6, v6, v82
    buffer_load_dwordx4 v12, s[16:19], s31 offen nt lds
    v_mfma_f32_16x16x32_bf16 v[248:251], v[52:55], v[104:107], v[248:251]
    v_add_f32 v6, v6, v83
    v_cvt_pk_bf16_f32 v81, v82, v83
    v_mfma_f32_16x16x32_bf16 v[188:191], v[56:59], v[88:91], v[188:191]
    ds_read_b128 v[52:55], v9 offset:48000
    s_add_u32 m0, s34, 18208
    v_mfma_f32_16x16x32_bf16 v[220:223], v[56:59], v[96:99], v[220:223]
    buffer_load_dwordx4 v12, s[16:19], s31 offen offset:256 nt lds
    v_mfma_f32_16x16x32_bf16 v[252:255], v[56:59], v[104:107], v[252:255]
    s_mov_b32 s31, s30
    s_add_u32 s39, s39, 0x2000
    s_and_b32 s37, s39, 0xc0000
    s_add_u32 s30, s39, s70
    s_lshl_b32 s37, s37, 4
    s_and_b32 s30, s30, 0x3ffff
    s_or_b32 s30, s30, s37
    s_sub_u32 s32, s32, 1
    s_cmp_lg_u32 s32, 0
    s_cbranch_scc1 L_aloop
    s_waitcnt lgkmcnt(5)
    v_mfma_f32_16x16x32_bf16 v[88:91], v[28:31], v[112:115], v[16:19]
    v_exp_f32 v68, v68
    v_mfma_f32_16x16x32_bf16 v[96:99], v[28:31], v[128:131], v[20:23]
    v_exp_f32 v69, v69
    v_mfma_f32_16x16x32_bf16 v[104:107], v[28:31], v[144:147], v[24:27]
    v_exp_f32 v70, v70
    v_mfma_f32_16x16x32_bf16 v[88:91], v[32:35], v[116:119], v[88:91]
    v_exp_f32 v71, v71
    ds_read_b128 v[56:59], v9 offset:48064
    v_mfma_f32_16x16x32_bf16 v[96:99], v[32:35], v[132:135], v[96:99]
    v_add_f32 v4, v4, v68
    v_add_f32 v4, v4, v69
    v_mfma_f32_16x16x32_bf16 v[104:107], v[32:35], v[148:151], v[104:107]
    v_cvt_pk_bf16_f32 v66, v68, v69
    v_add_f32 v4, v4, v70
    s_waitcnt lgkmcnt(4)
    v_mfma_f32_16x16x32_bf16 v[88:91], v[36:39], v[120:123], v[88:91]
    v_add_f32 v4, v4, v71
    v_cvt_pk_bf16_f32 v67, v70, v71
    ds_read_b64_tr_b16 v[28:29], v10 offset:43520
    ds_read_b64_tr_b16 v[30:31], v10 offset:44032
    v_mfma_f32_16x16x32_bf16 v[96:99], v[36:39], v[136:139], v[96:99]
    v_exp_f32 v76, v76
    v_mfma_f32_16x16x32_bf16 v[104:107], v[36:39], v[152:155], v[104:107]
    v_exp_f32 v77, v77
    v_mfma_f32_16x16x32_bf16 v[88:91], v[40:43], v[124:127], v[88:91]
    v_exp_f32 v78, v78
    ds_read_b64_tr_b16 v[32:33], v10 offset:43552
    ds_read_b64_tr_b16 v[34:35], v10 offset:44064
    v_mfma_f32_16x16x32_bf16 v[96:99], v[40:43], v[140:143], v[96:99]
    v_exp_f32 v79, v79
    v_mfma_f32_16x16x32_bf16 v[104:107], v[40:43], v[156:159], v[104:107]
    v_add_f32 v5, v5, v76
    v_add_f32 v5, v5, v77
    s_waitcnt lgkmcnt(6)
    v_mfma_f32_16x16x32_bf16 v[92:95], v[44:47], v[112:115], v[16:19]
    v_cvt_pk_bf16_f32 v74, v76, v77
    v_add_f32 v5, v5, v78
    ds_read_b64_tr_b16 v[36:37], v10 offset:43584
    ds_read_b64_tr_b16 v[38:39], v10 offset:44096
    v_mfma_f32_16x16x32_bf16 v[100:103], v[44:47], v[128:131], v[20:23]
    v_add_f32 v5, v5, v79
    v_cvt_pk_bf16_f32 v75, v78, v79
    v_mfma_f32_16x16x32_bf16 v[108:111], v[44:47], v[144:147], v[24:27]
    v_exp_f32 v84, v84
    v_mfma_f32_16x16x32_bf16 v[92:95], v[48:51], v[116:119], v[92:95]
    v_exp_f32 v85, v85
    ds_read_b64_tr_b16 v[40:41], v10 offset:43616
    ds_read_b64_tr_b16 v[42:43], v10 offset:44128
    v_mfma_f32_16x16x32_bf16 v[100:103], v[48:51], v[132:135], v[100:103]
    v_exp_f32 v86, v86
    v_mfma_f32_16x16x32_bf16 v[108:111], v[48:51], v[148:151], v[108:111]
    v_exp_f32 v87, v87
    s_waitcnt lgkmcnt(8)
    v_mfma_f32_16x16x32_bf16 v[92:95], v[52:55], v[120:123], v[92:95]
    v_add_f32 v6, v6, v84
    v_add_f32 v6, v6, v85
    ds_read_b64_tr_b16 v[44:45], v10 offset:43648
    ds_read_b64_tr_b16 v[46:47], v10 offset:44160
    v_mfma_f32_16x16x32_bf16 v[100:103], v[52:55], v[136:139], v[100:103]
    v_cvt_pk_bf16_f32 v82, v84, v85
    v_add_f32 v6, v6, v86
    v_mfma_f32_16x16x32_bf16 v[108:111], v[52:55], v[152:155], v[108:111]
    v_add_f32 v6, v6, v87
    v_cvt_pk_bf16_f32 v83, v86, v87
    v_mfma_f32_16x16x32_bf16 v[92:95], v[56:59], v[124:127], v[92:95]
    v_max3_f32 v7, v4, v5, v6
    ds_read_b64_tr_b16 v[48:49], v10 offset:43680
    ds_read_b64_tr_b16 v[50:51], v10 offset:44192
    v_mfma_f32_16x16x32_bf16 v[100:103], v[56:59], v[140:143], v[100:103]
    v_cmp_lt_f32 vcc, s35, v7
    v_mfma_f32_16x16x32_bf16 v[108:111], v[56:59], v[156:159], v[108:111]
    s_cbranch_vccnz L_slow4
L_back4:
    s_waitcnt lgkmcnt(8)
    v_mfma_f32_16x16x32_bf16 v[160:163], v[28:31], v[64:67], v[160:163]
    v_exp_f32 v88, v88
    ds_read_b64_tr_b16 v[52:53], v10 offset:43712
    ds_read_b64_tr_b16 v[54:55], v10 offset:44224
    v_mfma_f32_16x16x32_bf16 v[192:195], v[28:31], v[72:75], v[192:195]
    v_exp_f32 v89, v89
    v_mfma_f32_16x16x32_bf16 v[224:227], v[28:31], v[80:83], v[224:227]
    v_exp_f32 v90, v90
    v_mfma_f32_16x16x32_bf16 v[164:167], v[32:35], v[64:67], v[164:167]
    v_exp_f32 v91, v91
    ds_read_b64_tr_b16 v[56:57], v10 offset:43744
    ds_read_b64_tr_b16 v[58:59], v10 offset:44256
    v_mfma_f32_16x16x32_bf16 v[196:199], v[32:35], v[72:75], v[196:199]
    v_add_f32 v1, v1, v4
    v_add_f32 v4, v88, v89
    v_mfma_f32_16x16x32_bf16 v[228:231], v[32:35], v[80:83], v[228:231]
    v_cvt_pk_bf16_f32 v88, v88, v89
    v_add_f32 v4, v4, v90
    s_waitcnt lgkmcnt(8)
    v_mfma_f32_16x16x32_bf16 v[168:171], v[36:39], v[64:67], v[168:171]
    v_add_f32 v4, v4, v91
    v_cvt_pk_bf16_f32 v89, v90, v91
    v_mfma_f32_16x16x32_bf16 v[200:203], v[36:39], v[72:75], v[200:203]
    v_exp_f32 v96, v96
    v_mfma_f32_16x16x32_bf16 v[232:235], v[36:39], v[80:83], v[232:235]
    v_exp_f32 v97, v97
    v_mfma_f32_16x16x32_bf16 v[172:175], v[40:43], v[64:67], v[172:175]
    v_exp_f32 v98, v98
    v_mfma_f32_16x16x32_bf16 v[204:207], v[40:43], v[72:75], v[204:207]
    v_exp_f32 v99, v99
    v_mfma_f32_16x16x32_bf16 v[236:239], v[40:43], v[80:83], v[236:239]
    v_add_f32 v2, v2, v5
    v_add_f32 v5, v96, v97
    s_waitcnt vmcnt(8) lgkmcnt(0)
    s_barrier
    v_mfma_f32_16x16x32_bf16 v[176:179], v[44:47], v[64:67], v[176:179]
    v_cvt_pk_bf16_f32 v96, v96, v97
    v_add_f32 v5, v5, v98
    ds_read_b128 v[28:31], v9 offset:60928
    v_mfma_f32_16x16x32_bf16 v[208:211], v[44:47], v[72:75], v[208:211]
    v_add_f32 v5, v5, v99
    v_cvt_pk_bf16_f32 v97, v98, v99
    ds_read_b128 v[32:35], v9 offset:60992
    v_mfma_f32_16x16x32_bf16 v[240:243], v[44:47], v[80:83], v[240:243]
    v_exp_f32 v104, v104
    s_cmp_eq_u32 s32, s66
    s_cbranch_scc1 L_sigt
L_sigbackt:
    ds_read_b128 v[36:39], v9 offset:61056
    v_mfma_f32_16x16x32_bf16 v[180:183], v[48:51], v[64:67], v[180:183]
    v_exp_f32 v105, v105
    ds_read_b128 v[40:43], v9 offset:61120
    v_mfma_f32_16x16x32_bf16 v[212:215], v[48:51], v[72:75], v[212:215]
    v_exp_f32 v106, v106
    ds_read_b128 v[44:47], v9 offset:65280
    v_mfma_f32_16x16x32_bf16 v[244:247], v[48:51], v[80:83], v[244:247]
    v_exp_f32 v107, v107
    v_mfma_f32_16x16x32_bf16 v[184:187], v[52:55], v[64:67], v[184:187]
    v_add_f32 v3, v3, v6
    v_add_f32 v6, v104, v105
    ds_read_b128 v[48:51], v9 offset:65344
    v_mfma_f32_16x16x32_bf16 v[216:219], v[52:55], v[72:75], v[216:219]
    v_cvt_pk_bf16_f32 v104, v104, v105
    v_add_f32 v6, v6, v106
    v_mfma_f32_16x16x32_bf16 v[248:251], v[52:55], v[80:83], v[248:251]
    v_add_f32 v6, v6, v107
    v_cvt_pk_bf16_f32 v105, v106, v107
    v_mfma_f32_16x16x32_bf16 v[188:191], v[56:59], v[64:67], v[188:191]
    ds_read_b128 v[52:55], v9 offset:65408
    v_mfma_f32_16x16x32_bf16 v[220:223], v[56:59], v[72:75], v[220:223]
    v_mfma_f32_16x16x32_bf16 v[252:255], v[56:59], v[80:83], v[252:255]
    s_mov_b32 s31, s30
    s_add_u32 s39, s39, 0x2000
    s_and_b32 s37, s39, 0xc0000
    s_add_u32 s30, s39, s70
    s_lshl_b32 s37, s37, 4
    s_and_b32 s30, s30, 0x3ffff
    s_or_b32 s30, s30, s37
    s_waitcnt lgkmcnt(5)
    v_mfma_f32_16x16x32_bf16 v[64:67], v[28:31], v[112:115], v[16:19]
    v_exp_f32 v92, v92
    v_mfma_f32_16x16x32_bf16 v[72:75], v[28:31], v[128:131], v[20:23]
    v_exp_f32 v93, v93
    v_mfma_f32_16x16x32_bf16 v[80:83], v[28:31], v[144:147], v[24:27]
    v_exp_f32 v94, v94
    v_mfma_f32_16x16x32_bf16 v[64:67], v[32:35], v[116:119], v[64:67]
    v_exp_f32 v95, v95
    ds_read_b128 v[56:59], v9 offset:65472
    v_mfma_f32_16x16x32_bf16 v[72:75], v[32:35], v[132:135], v[72:75]
    v_add_f32 v4, v4, v92
    v_add_f32 v4, v4, v93
    v_mfma_f32_16x16x32_bf16 v[80:83], v[32:35], v[148:151], v[80:83]
    v_cvt_pk_bf16_f32 v90, v92, v93
    v_add_f32 v4, v4, v94
    s_waitcnt lgkmcnt(4)
    v_mfma_f32_16x16x32_bf16 v[64:67], v[36:39], v[120:123], v[64:67]
    v_add_f32 v4, v4, v95
    v_cvt_pk_bf16_f32 v91, v94, v95
    ds_read_b64_tr_b16 v[28:29], v10 offset:60928
    ds_read_b64_tr_b16 v[30:31], v10 offset:61440
    v_mfma_f32_16x16x32_bf16 v[72:75], v[36:39], v[136:139], v[72:75]
    v_exp_f32 v100, v100
    v_mfma_f32_16x16x32_bf16 v[80:83], v[36:39], v[152:155], v[80:83]
    v_exp_f32 v101, v101
    v_mfma_f32_16x16x32_bf16 v[64:67], v[40:43], v[124:127], v[64:67]
    v_exp_f32 v102, v102
    ds_read_b64_tr_b16 v[32:33], v10 offset:60960
    ds_read_b64_tr_b16 v[34:35], v10 offset:61472
    v_mfma_f32_16x16x32_bf16 v[72:75], v[40:43], v[140:143], v[72:75]
    v_exp_f32 v103, v103
    v_mfma_f32_16x16x32_bf16 v[80:83], v[40:43], v[156:159], v[80:83]
    v_add_f32 v5, v5, v100
    v_add_f32 v5, v5, v101
    s_waitcnt lgkmcnt(6)
    v_mfma_f32_16x16x32_bf16 v[68:71], v[44:47], v[112:115], v[16:19]
    v_cvt_pk_bf16_f32 v98, v100, v101
    v_add_f32 v5, v5, v102
    ds_read_b64_tr_b16 v[36:37], v10 offset:60992
    ds_read_b64_tr_b16 v[38:39], v10 offset:61504
    v_mfma_f32_16x16x32_bf16 v[76:79], v[44:47], v[128:131], v[20:23]
    v_add_f32 v5, v5, v103
    v_cvt_pk_bf16_f32 v99, v102, v103
    v_mfma_f32_16x16x32_bf16 v[84:87], v[44:47], v[144:147], v[24:27]
    v_exp_f32 v108, v108
    v_mfma_f32_16x16x32_bf16 v[68:71], v[48:51], v[116:119], v[68:71]
    v_exp_f32 v109, v109
    ds_read_b64_tr_b16 v[40:41], v10 offset:61024
    ds_read_b64_tr_b16 v[42:43], v10 offset:61536
    v_mfma_f32_16x16x32_bf16 v[76:79], v[48:51], v[132:135], v[76:79]
    v_exp_f32 v110, v110
    v_mfma_f32_16x16x32_bf16 v[84:87], v[48:51], v[148:151], v[84:87]
    v_exp_f32 v111, v111
    s_waitcnt lgkmcnt(8)
    v_mfma_f32_16x16x32_bf16 v[68:71], v[52:55], v[120:123], v[68:71]
    v_add_f32 v6, v6, v108
    v_add_f32 v6, v6, v109
    ds_read_b64_tr_b16 v[44:45], v10 offset:61056
    ds_read_b64_tr_b16 v[46:47], v10 offset:61568
    v_mfma_f32_16x16x32_bf16 v[76:79], v[52:55], v[136:139], v[76:79]
    v_cvt_pk_bf16_f32 v106, v108, v109
    v_add_f32 v6, v6, v110
    v_mfma_f32_16x16x32_bf16 v[84:87], v[52:55], v[152:155], v[84:87]
    v_add_f32 v6, v6, v111
    v_cvt_pk_bf16_f32 v107, v110, v111
    v_mfma_f32_16x16x32_bf16 v[68:71], v[56:59], v[124:127], v[68:71]
    v_max3_f32 v7, v4, v5, v6
    ds_read_b64_tr_b16 v[48:49], v10 offset:61088
    ds_read_b64_tr_b16 v[50:51], v10 offset:61600
    v_mfma_f32_16x16x32_bf16 v[76:79], v[56:59], v[140:143], v[76:79]
    v_cmp_lt_f32 vcc, s35, v7
    v_mfma_f32_16x16x32_bf16 v[84:87], v[56:59], v[156:159], v[84:87]
    s_cbranch_vccnz L_slow5
L_back5:
    s_waitcnt lgkmcnt(8)
    v_mfma_f32_16x16x32_bf16 v[160:163], v[28:31], v[88:91], v[160:163]
    v_exp_f32 v64, v64
    ds_read_b64_tr_b16 v[52:53], v10 offset:61120
    ds_read_b64_tr_b16 v[54:55], v10 offset:61632
    v_mfma_f32_16x16x32_bf16 v[192:195], v[28:31], v[96:99], v[192:195]
    v_exp_f32 v65, v65
    v_mfma_f32_16x16x32_bf16 v[224:227], v[28:31], v[104:107], v[224:227]
    v_exp_f32 v66, v66
    v_mfma_f32_16x16x32_bf16 v[164:167], v[32:35], v[88:91], v[164:167]
    v_exp_f32 v67, v67
    ds_read_b64_tr_b16 v[56:57], v10 offset:61152
    ds_read_b64_tr_b16 v[58:59], v10 offset:61664
    v_mfma_f32_16x16x32_bf16 v[196:199], v[32:35], v[96:99], v[196:199]
    v_add_f32 v1, v1, v4
    v_add_f32 v4, v64, v65
    v_mfma_f32_16x16x32_bf16 v[228:231], v[32:35], v[104:107], v[228:231]
    v_cvt_pk_bf16_f32 v64, v64, v65
    v_add_f32 v4, v4, v66
    s_waitcnt lgkmcnt(8)
    v_mfma_f32_16x16x32_bf16 v[168:171], v[36:39], v[88:91], v[168:171]
    v_add_f32 v4, v4, v67
    v_cvt_pk_bf16_f32 v65, v66, v67
    v_mfma_f32_16x16x32_bf16 v[200:203], v[36:39], v[96:99], v[200:203]
    v_exp_f32 v72, v72
    v_mfma_f32_16x16x32_bf16 v[232:235], v[36:39], v[104:107], v[232:235]
    v_exp_f32 v73, v73
    v_mfma_f32_16x16x32_bf16 v[172:175], v[40:43], v[88:91], v[172:175]
    v_exp_f32 v74, v74
    v_mfma_f32_16x16x32_bf16 v[204:207], v[40:43], v[96:99], v[204:207]
    v_exp_f32 v75, v75
    v_mfma_f32_16x16x32_bf16 v[236:239], v[40:43], v[104:107], v[236:239]
    v_add_f32 v2, v2, v5
    v_add_f32 v5, v72, v73
    s_waitcnt vmcnt(4) lgkmcnt(0)
    s_barrier
    v_mfma_f32_16x16x32_bf16 v[176:179], v[44:47], v[88:91], v[176:179]
    v_cvt_pk_bf16_f32 v72, v72, v73
    v_add_f32 v5, v5, v74
    ds_read_b128 v[28:31], v9 offset:0
    v_mfma_f32_16x16x32_bf16 v[208:211], v[44:47], v[96:99], v[208:211]
    v_add_f32 v5, v5, v75
    v_cvt_pk_bf16_f32 v73, v74, v75
    ds_read_b128 v[32:35], v9 offset:64
    v_mfma_f32_16x16x32_bf16 v[240:243], v[44:47], v[104:107], v[240:243]
    v_exp_f32 v80, v80
    ds_read_b128 v[36:39], v9 offset:128
    v_mfma_f32_16x16x32_bf16 v[180:183], v[48:51], v[88:91], v[180:183]
    v_exp_f32 v81, v81
    ds_read_b128 v[40:43], v9 offset:192
    v_mfma_f32_16x16x32_bf16 v[212:215], v[48:51], v[96:99], v[212:215]
    v_exp_f32 v82, v82
    ds_read_b128 v[44:47], v9 offset:4352
    v_mfma_f32_16x16x32_bf16 v[244:247], v[48:51], v[104:107], v[244:247]
    v_exp_f32 v83, v83
    v_mfma_f32_16x16x32_bf16 v[184:187], v[52:55], v[88:91], v[184:187]
    v_add_f32 v3, v3, v6
    v_add_f32 v6, v80, v81
    ds_read_b128 v[48:51], v9 offset:4416
    v_mfma_f32_16x16x32_bf16 v[216:219], v[52:55], v[96:99], v[216:219]
    v_cvt_pk_bf16_f32 v80, v80, v81
    v_add_f32 v6, v6, v82
    v_mfma_f32_16x16x32_bf16 v[248:251], v[52:55], v[104:107], v[248:251]
    v_add_f32 v6, v6, v83
    v_cvt_pk_bf16_f32 v81, v82, v83
    v_mfma_f32_16x16x32_bf16 v[188:191], v[56:59], v[88:91], v[188:191]
    ds_read_b128 v[52:55], v9 offset:4480
    v_mfma_f32_16x16x32_bf16 v[220:223], v[56:59], v[96:99], v[220:223]
    v_mfma_f32_16x16x32_bf16 v[252:255], v[56:59], v[104:107], v[252:255]
    s_mov_b32 s31, s30
    s_add_u32 s39, s39, 0x2000
    s_and_b32 s37, s39, 0xc0000
    s_add_u32 s30, s39, s70
    s_lshl_b32 s37, s37, 4
    s_and_b32 s30, s30, 0x3ffff
    s_or_b32 s30, s30, s37
    s_waitcnt lgkmcnt(5)
    v_mfma_f32_16x16x32_bf16 v[88:91], v[28:31], v[112:115], v[16:19]
    v_exp_f32 v68, v68
    v_mfma_f32_16x16x32_bf16 v[96:99], v[28:31], v[128:131], v[20:23]
    v_exp_f32 v69, v69
    v_mfma_f32_16x16x32_bf16 v[104:107], v[28:31], v[144:147], v[24:27]
    v_exp_f32 v70, v70
    v_mfma_f32_16x16x32_bf16 v[88:91], v[32:35], v[116:119], v[88:91]
    v_exp_f32 v71, v71
    ds_read_b128 v[56:59], v9 offset:4544
    v_mfma_f32_16x16x32_bf16 v[96:99], v[32:35], v[132:135], v[96:99]
    v_add_f32 v4, v4, v68
    v_add_f32 v4, v4, v69
    v_mfma_f32_16x16x32_bf16 v[104:107], v[32:35], v[148:151], v[104:107]
    v_cvt_pk_bf16_f32 v66, v68, v69
    v_add_f32 v4, v4, v70
    s_waitcnt lgkmcnt(4)
    v_mfma_f32_16x16x32_bf16 v[88:91], v[36:39], v[120:123], v[88:91]
    v_add_f32 v4, v4, v71
    v_cvt_pk_bf16_f32 v67, v70, v71
    ds_read_b64_tr_b16 v[28:29], v10 offset:0
    ds_read_b64_tr_b16 v[30:31], v10 offset:512
    v_mfma_f32_16x16x32_bf16 v[96:99], v[36:39], v[136:139], v[96:99]
    v_exp_f32 v76, v76
    v_mfma_f32_16x16x32_bf16 v[104:107], v[36:39], v[152:155], v[104:107]
    v_exp_f32 v77, v77
    v_mfma_f32_16x16x32_bf16 v[88:91], v[40:43], v[124:127], v[88:91]
    v_exp_f32 v78, v78
    ds_read_b64_tr_b16 v[32:33], v10 offset:32
    ds_read_b64_tr_b16 v[34:35], v10 offset:544
    v_mfma_f32_16x16x32_bf16 v[96:99], v[40:43], v[140:143], v[96:99]
    v_exp_f32 v79, v79
    v_mfma_f32_16x16x32_bf16 v[104:107], v[40:43], v[156:159], v[104:107]
    v_add_f32 v5, v5, v76
    v_add_f32 v5, v5, v77
    s_waitcnt lgkmcnt(6)
    v_mfma_f32_16x16x32_bf16 v[92:95], v[44:47], v[112:115], v[16:19]
    v_cvt_pk_bf16_f32 v74, v76, v77
    v_add_f32 v5, v5, v78
    ds_read_b64_tr_b16 v[36:37], v10 offset:64
    ds_read_b64_tr_b16 v[38:39], v10 offset:576
    v_mfma_f32_16x16x32_bf16 v[100:103], v[44:47], v[128:131], v[20:23]
    v_add_f32 v5, v5, v79
    v_cvt_pk_bf16_f32 v75, v78, v79
    v_mfma_f32_16x16x32_bf16 v[108:111], v[44:47], v[144:147], v[24:27]
    v_exp_f32 v84, v84
    v_mfma_f32_16x16x32_bf16 v[92:95], v[48:51], v[116:119], v[92:95]
    v_exp_f32 v85, v85
    ds_read_b64_tr_b16 v[40:41], v10 offset:96
    ds_read_b64_tr_b16 v[42:43], v10 offset:608
    v_mfma_f32_16x16x32_bf16 v[100:103], v[48:51], v[132:135], v[100:103]
    v_exp_f32 v86, v86
    v_mfma_f32_16x16x32_bf16 v[108:111], v[48:51], v[148:151], v[108:111]
    v_exp_f32 v87, v87
    s_waitcnt lgkmcnt(8)
    v_mfma_f32_16x16x32_bf16 v[92:95], v[52:55], v[120:123], v[92:95]
    v_add_f32 v6, v6, v84
    v_add_f32 v6, v6, v85
    ds_read_b64_tr_b16 v[44:45], v10 offset:128
    ds_read_b64_tr_b16 v[46:47], v10 offset:640
    v_mfma_f32_16x16x32_bf16 v[100:103], v[52:55], v[136:139], v[100:103]
    v_cvt_pk_bf16_f32 v82, v84, v85
    v_add_f32 v6, v6, v86
    v_mfma_f32_16x16x32_bf16 v[108:111], v[52:55], v[152:155], v[108:111]
    v_add_f32 v6, v6, v87
    v_cvt_pk_bf16_f32 v83, v86, v87
    v_mfma_f32_16x16x32_bf16 v[92:95], v[56:59], v[124:127], v[92:95]
    v_max3_f32 v7, v4, v5, v6
    ds_read_b64_tr_b16 v[48:49], v10 offset:160
    ds_read_b64_tr_b16 v[50:51], v10 offset:672
    v_mfma_f32_16x16x32_bf16 v[100:103], v[56:59], v[140:143], v[100:103]
    v_cmp_lt_f32 vcc, s35, v7
    v_mfma_f32_16x16x32_bf16 v[108:111], v[56:59], v[156:159], v[108:111]
    s_cbranch_vccnz L_slow6
L_back6:
    s_waitcnt lgkmcnt(8)
    v_mfma_f32_16x16x32_bf16 v[160:163], v[28:31], v[64:67], v[160:163]
    v_exp_f32 v88, v88
    ds_read_b64_tr_b16 v[52:53], v10 offset:192
    ds_read_b64_tr_b16 v[54:55], v10 offset:704
    v_mfma_f32_16x16x32_bf16 v[192:195], v[28:31], v[72:75], v[192:195]
    v_exp_f32 v89, v89
    v_mfma_f32_16x16x32_bf16 v[224:227], v[28:31], v[80:83], v[224:227]
    v_exp_f32 v90, v90
    v_mfma_f32_16x16x32_bf16 v[164:167], v[32:35], v[64:67], v[164:167]
    v_exp_f32 v91, v91
    ds_read_b64_tr_b16 v[56:57], v10 offset:224
    ds_read_b64_tr_b16 v[58:59], v10 offset:736
    v_mfma_f32_16x16x32_bf16 v[196:199], v[32:35], v[72:75], v[196:199]
    v_add_f32 v1, v1, v4
    v_add_f32 v4, v88, v89
    v_mfma_f32_16x16x32_bf16 v[228:231], v[32:35], v[80:83], v[228:231]
    v_cvt_pk_bf16_f32 v88, v88, v89
    v_add_f32 v4, v4, v90
    s_waitcnt lgkmcnt(8)
    v_mfma_f32_16x16x32_bf16 v[168:171], v[36:39], v[64:67], v[168:171]
    v_add_f32 v4, v4, v91
    v_cvt_pk_bf16_f32 v89, v90, v91
    v_mfma_f32_16x16x32_bf16 v[200:203], v[36:39], v[72:75], v[200:203]
    v_exp_f32 v96, v96
    v_mfma_f32_16x16x32_bf16 v[232:235], v[36:39], v[80:83], v[232:235]
    v_exp_f32 v97, v97
    v_mfma_f32_16x16x32_bf16 v[172:175], v[40:43], v[64:67], v[172:175]
    v_exp_f32 v98, v98
    v_mfma_f32_16x16x32_bf16 v[204:207], v[40:43], v[72:75], v[204:207]
    v_exp_f32 v99, v99
    v_mfma_f32_16x16x32_bf16 v[236:239], v[40:43], v[80:83], v[236:239]
    v_add_f32 v2, v2, v5
    v_add_f32 v5, v96, v97
    s_waitcnt vmcnt(0) lgkmcnt(0)
    s_barrier
    v_mfma_f32_16x16x32_bf16 v[176:179], v[44:47], v[64:67], v[176:179]
    v_cvt_pk_bf16_f32 v96, v96, v97
    v_add_f32 v5, v5, v98
    v_mfma_f32_16x16x32_bf16 v[208:211], v[44:47], v[72:75], v[208:211]
    v_add_f32 v5, v5, v99
    v_cvt_pk_bf16_f32 v97, v98, v99
    v_mfma_f32_16x16x32_bf16 v[240:243], v[44:47], v[80:83], v[240:243]
    v_exp_f32 v104, v104
    v_mfma_f32_16x16x32_bf16 v[180:183], v[48:51], v[64:67], v[180:183]
    v_exp_f32 v105, v105
    v_mfma_f32_16x16x32_bf16 v[212:215], v[48:51], v[72:75], v[212:215]
    v_exp_f32 v106, v106
    v_mfma_f32_16x16x32_bf16 v[244:247], v[48:51], v[80:83], v[244:247]
    v_exp_f32 v107, v107
    v_mfma_f32_16x16x32_bf16 v[184:187], v[52:55], v[64:67], v[184:187]
    v_add_f32 v3, v3, v6
    v_add_f32 v6, v104, v105
    v_mfma_f32_16x16x32_bf16 v[216:219], v[52:55], v[72:75], v[216:219]
    v_cvt_pk_bf16_f32 v104, v104, v105
    v_add_f32 v6, v6, v106
    v_mfma_f32_16x16x32_bf16 v[248:251], v[52:55], v[80:83], v[248:251]
    v_add_f32 v6, v6, v107
    v_cvt_pk_bf16_f32 v105, v106, v107
    v_mfma_f32_16x16x32_bf16 v[188:191], v[56:59], v[64:67], v[188:191]
    v_mfma_f32_16x16x32_bf16 v[220:223], v[56:59], v[72:75], v[220:223]
    v_mfma_f32_16x16x32_bf16 v[252:255], v[56:59], v[80:83], v[252:255]
    s_mov_b32 s31, s30
    s_add_u32 s39, s39, 0x2000
    s_and_b32 s37, s39, 0xc0000
    s_add_u32 s30, s39, s70
    s_lshl_b32 s37, s37, 4
    s_and_b32 s30, s30, 0x3ffff
    s_or_b32 s30, s30, s37
    v_exp_f32 v92, v92
    v_exp_f32 v93, v93
    v_exp_f32 v94, v94
    v_exp_f32 v95, v95
    v_add_f32 v4, v4, v92
    v_add_f32 v4, v4, v93
    v_cvt_pk_bf16_f32 v90, v92, v93
    v_add_f32 v4, v4, v94
    v_add_f32 v4, v4, v95
    v_cvt_pk_bf16_f32 v91, v94, v95
    ds_read_b64_tr_b16 v[28:29], v10 offset:17408
    ds_read_b64_tr_b16 v[30:31], v10 offset:17920
    v_exp_f32 v100, v100
    v_exp_f32 v101, v101
    v_exp_f32 v102, v102
    ds_read_b64_tr_b16 v[32:33], v10 offset:17440
    ds_read_b64_tr_b16 v[34:35], v10 offset:17952
    v_exp_f32 v103, v103
    v_add_f32 v5, v5, v100
    v_add_f32 v5, v5, v101
    v_cvt_pk_bf16_f32 v98, v100, v101
    v_add_f32 v5, v5, v102
    ds_read_b64_tr_b16 v[36:37], v10 offset:17472
    ds_read_b64_tr_b16 v[38:39], v10 offset:17984
    v_add_f32 v5, v5, v103
    v_cvt_pk_bf16_f32 v99, v102, v103
    v_exp_f32 v108, v108
    v_exp_f32 v109, v109
    ds_read_b64_tr_b16 v[40:41], v10 offset:17504
    ds_read_b64_tr_b16 v[42:43], v10 offset:18016
    v_exp_f32 v110, v110
    v_exp_f32 v111, v111
    v_add_f32 v6, v6, v108
    v_add_f32 v6, v6, v109
    ds_read_b64_tr_b16 v[44:45], v10 offset:17536
    ds_read_b64_tr_b16 v[46:47], v10 offset:18048
    v_cvt_pk_bf16_f32 v106, v108, v109
    v_add_f32 v6, v6, v110
    v_add_f32 v6, v6, v111
    v_cvt_pk_bf16_f32 v107, v110, v111
    v_max3_f32 v7, v4, v5, v6
    ds_read_b64_tr_b16 v[48:49], v10 offset:17568
    ds_read_b64_tr_b16 v[50:51], v10 offset:18080
    v_cmp_lt_f32 vcc, s35, v7
    s_nop 3
    s_cbranch_vccnz L_slow7
L_back7:
    s_nop 1
    s_waitcnt lgkmcnt(8)
    v_mfma_f32_16x16x32_bf16 v[160:163], v[28:31], v[88:91], v[160:163]
    v_add_f32 v1, v1, v4
    ds_read_b64_tr_b16 v[52:53], v10 offset:17600
    ds_read_b64_tr_b16 v[54:55], v10 offset:18112
    v_mfma_f32_16x16x32_bf16 v[192:195], v[28:31], v[96:99], v[192:195]
    v_add_f32 v2, v2, v5
    v_mfma_f32_16x16x32_bf16 v[224:227], v[28:31], v[104:107], v[224:227]
    v_add_f32 v3, v3, v6
    v_mfma_f32_16x16x32_bf16 v[164:167], v[32:35], v[88:91], v[164:167]
    ds_read_b64_tr_b16 v[56:57], v10 offset:17632
    ds_read_b64_tr_b16 v[58:59], v10 offset:18144
    v_mfma_f32_16x16x32_bf16 v[196:199], v[32:35], v[96:99], v[196:199]
    v_mfma_f32_16x16x32_bf16 v[228:231], v[32:35], v[104:107], v[228:231]
    s_waitcnt lgkmcnt(8)
    v_mfma_f32_16x16x32_bf16 v[168:171], v[36:39], v[88:91], v[168:171]
    v_mfma_f32_16x16x32_bf16 v[200:203], v[36:39], v[96:99], v[200:203]
    v_mfma_f32_16x16x32_bf16 v[232:235], v[36:39], v[104:107], v[232:235]
    v_mfma_f32_16x16x32_bf16 v[172:175], v[40:43], v[88:91], v[172:175]
    v_mfma_f32_16x16x32_bf16 v[204:207], v[40:43], v[96:99], v[204:207]
    v_mfma_f32_16x16x32_bf16 v[236:239], v[40:43], v[104:107], v[236:239]
    s_waitcnt lgkmcnt(0)
    s_barrier
    v_mfma_f32_16x16x32_bf16 v[176:179], v[44:47], v[88:91], v[176:179]
    v_mfma_f32_16x16x32_bf16 v[208:211], v[44:47], v[96:99], v[208:211]
    v_lshlrev_b32 v14, 4, v13
    v_mfma_f32_16x16x32_bf16 v[240:243], v[44:47], v[104:107], v[240:243]
    v_mfma_f32_16x16x32_bf16 v[180:183], v[48:51], v[88:91], v[180:183]
    v_mfma_f32_16x16x32_bf16 v[212:215], v[48:51], v[96:99], v[212:215]
    v_mfma_f32_16x16x32_bf16 v[244:247], v[48:51], v[104:107], v[244:247]
    v_mfma_f32_16x16x32_bf16 v[184:187], v[52:55], v[88:91], v[184:187]
    v_mfma_f32_16x16x32_bf16 v[216:219], v[52:55], v[96:99], v[216:219]
    v_mfma_f32_16x16x32_bf16 v[248:251], v[52:55], v[104:107], v[248:251]
    v_mfma_f32_16x16x32_bf16 v[188:191], v[56:59], v[88:91], v[188:191]
    v_mfma_f32_16x16x32_bf16 v[220:223], v[56:59], v[96:99], v[220:223]
    v_mfma_f32_16x16x32_bf16 v[252:255], v[56:59], v[104:107], v[252:255]
    s_cmp_eq_u32 s71, 0
    s_cbranch_scc1 L_B
    s_nop 7
    s_nop 1
    s_mul_i32 s37, s25, 12
    s_mul_i32 s38, s24, 3
    s_add_u32 s37, s37, s38
    s_mul_i32 s37, s37, 131072
    s_lshl_b32 s38, s26, 12
    s_add_u32 s37, s37, s38
    v_mov_b32 v7, v1
    s_nop 1
    v_permlane16_swap_b32 v1, v7
    s_nop 1
    v_add_f32 v1, v1, v7
    v_mov_b32 v7, v1
    s_nop 1
    v_permlane32_swap_b32 v1, v7
    s_nop 1
    v_add_f32 v1, v1, v7
    v_rcp_f32 v1, v1
    s_nop 0
    v_mul_f32 v160, v160, v1
    v_mul_f32 v161, v161, v1
    v_mul_f32 v162, v162, v1
    v_mul_f32 v163, v163, v1
    v_mul_f32 v164, v164, v1
    v_mul_f32 v165, v165, v1
    v_mul_f32 v166, v166, v1
    v_mul_f32 v167, v167, v1
    v_cvt_pk_bf16_f32 v64, v160, v161
    v_cvt_pk_bf16_f32 v65, v162, v163
    v_cvt_pk_bf16_f32 v66, v164, v165
    v_cvt_pk_bf16_f32 v67, v166, v167
    buffer_store_dwordx4 v[64:67], v14, s[20:23], s37 offen sc1
    v_mul_f32 v168, v168, v1
    v_mul_f32 v169, v169, v1
    v_mul_f32 v170, v170, v1
    v_mul_f32 v171, v171, v1
    v_mul_f32 v172, v172, v1
    v_mul_f32 v173, v173, v1
    v_mul_f32 v174, v174, v1
    v_mul_f32 v175, v175, v1
    v_cvt_pk_bf16_f32 v68, v168, v169
    v_cvt_pk_bf16_f32 v69, v170, v171
    v_cvt_pk_bf16_f32 v70, v172, v173
    v_cvt_pk_bf16_f32 v71, v174, v175
    buffer_store_dwordx4 v[68:71], v14, s[20:23], s37 offen offset:1024 sc1
    v_mul_f32 v176, v176, v1
    v_mul_f32 v177, v177, v1
    v_mul_f32 v178, v178, v1
    v_mul_f32 v179, v179, v1
    v_mul_f32 v180, v180, v1
    v_mul_f32 v181, v181, v1
    v_mul_f32 v182, v182, v1
    v_mul_f32 v183, v183, v1
    v_cvt_pk_bf16_f32 v72, v176, v177
    v_cvt_pk_bf16_f32 v73, v178, v179
    v_cvt_pk_bf16_f32 v74, v180, v181
    v_cvt_pk_bf16_f32 v75, v182, v183
    buffer_store_dwordx4 v[72:75], v14, s[20:23], s37 offen offset:2048 sc1
    v_mul_f32 v184, v184, v1
    v_mul_f32 v185, v185, v1
    v_mul_f32 v186, v186, v1
    v_mul_f32 v187, v187, v1
    v_mul_f32 v188, v188, v1
    v_mul_f32 v189, v189, v1
    v_mul_f32 v190, v190, v1
    v_mul_f32 v191, v191, v1
    v_cvt_pk_bf16_f32 v76, v184, v185
    v_cvt_pk_bf16_f32 v77, v186, v187
    v_cvt_pk_bf16_f32 v78, v188, v189
    v_cvt_pk_bf16_f32 v79, v190, v191
    buffer_store_dwordx4 v[76:79], v14, s[20:23], s37 offen offset:3072 sc1
    s_add_u32 s37, s37, 131072
    v_mov_b32 v7, v2
    s_nop 1
    v_permlane16_swap_b32 v2, v7
    s_nop 1
    v_add_f32 v2, v2, v7
    v_mov_b32 v7, v2
    s_nop 1
    v_permlane32_swap_b32 v2, v7
    s_nop 1
    v_add_f32 v2, v2, v7
    v_rcp_f32 v2, v2
    s_nop 0
    v_mul_f32 v192, v192, v2
    v_mul_f32 v193, v193, v2
    v_mul_f32 v194, v194, v2
    v_mul_f32 v195, v195, v2
    v_mul_f32 v196, v196, v2
    v_mul_f32 v197, v197, v2
    v_mul_f32 v198, v198, v2
    v_mul_f32 v199, v199, v2
    v_cvt_pk_bf16_f32 v80, v192, v193
    v_cvt_pk_bf16_f32 v81, v194, v195
    v_cvt_pk_bf16_f32 v82, v196, v197
    v_cvt_pk_bf16_f32 v83, v198, v199
    buffer_store_dwordx4 v[80:83], v14, s[20:23], s37 offen sc1
    v_mul_f32 v200, v200, v2
    v_mul_f32 v201, v201, v2
    v_mul_f32 v202, v202, v2
    v_mul_f32 v203, v203, v2
    v_mul_f32 v204, v204, v2
    v_mul_f32 v205, v205, v2
    v_mul_f32 v206, v206, v2
    v_mul_f32 v207, v207, v2
    v_cvt_pk_bf16_f32 v84, v200, v201
    v_cvt_pk_bf16_f32 v85, v202, v203
    v_cvt_pk_bf16_f32 v86, v204, v205
    v_cvt_pk_bf16_f32 v87, v206, v207
    buffer_store_dwordx4 v[84:87], v14, s[20:23], s37 offen offset:1024 sc1
    v_mul_f32 v208, v208, v2
    v_mul_f32 v209, v209, v2
    v_mul_f32 v210, v210, v2
    v_mul_f32 v211, v211, v2
    v_mul_f32 v212, v212, v2
    v_mul_f32 v213, v213, v2
    v_mul_f32 v214, v214, v2
    v_mul_f32 v215, v215, v2
    v_cvt_pk_bf16_f32 v88, v208, v209
    v_cvt_pk_bf16_f32 v89, v210, v211
    v_cvt_pk_bf16_f32 v90, v212, v213
    v_cvt_pk_bf16_f32 v91, v214, v215
    buffer_store_dwordx4 v[88:91], v14, s[20:23], s37 offen offset:2048 sc1
    v_mul_f32 v216, v216, v2
    v_mul_f32 v217, v217, v2
    v_mul_f32 v218, v218, v2
    v_mul_f32 v219, v219, v2
    v_mul_f32 v220, v220, v2
    v_mul_f32 v221, v221, v2
    v_mul_f32 v222, v222, v2
    v_mul_f32 v223, v223, v2
    v_cvt_pk_bf16_f32 v92, v216, v217
    v_cvt_pk_bf16_f32 v93, v218, v219
    v_cvt_pk_bf16_f32 v94, v220, v221
    v_cvt_pk_bf16_f32 v95, v222, v223
    buffer_store_dwordx4 v[92:95], v14, s[20:23], s37 offen offset:3072 sc1
    s_add_u32 s37, s37, 131072
    v_mov_b32 v7, v3
    s_nop 1
    v_permlane16_swap_b32 v3, v7
    s_nop 1
    v_add_f32 v3, v3, v7
    v_mov_b32 v7, v3
    s_nop 1
    v_permlane32_swap_b32 v3, v7
    s_nop 1
    v_add_f32 v3, v3, v7
    v_rcp_f32 v3, v3
    s_nop 0
    v_mul_f32 v224, v224, v3
    v_mul_f32 v225, v225, v3
    v_mul_f32 v226, v226, v3
    v_mul_f32 v227, v227, v3
    v_mul_f32 v228, v228, v3
    v_mul_f32 v229, v229, v3
    v_mul_f32 v230, v230, v3
    v_mul_f32 v231, v231, v3
    v_cvt_pk_bf16_f32 v96, v224, v225
    v_cvt_pk_bf16_f32 v97, v226, v227
    v_cvt_pk_bf16_f32 v98, v228, v229
    v_cvt_pk_bf16_f32 v99, v230, v231
    buffer_store_dwordx4 v[96:99], v14, s[20:23], s37 offen sc1
    v_mul_f32 v232, v232, v3
    v_mul_f32 v233, v233, v3
    v_mul_f32 v234, v234, v3
    v_mul_f32 v235, v235, v3
    v_mul_f32 v236, v236, v3
    v_mul_f32 v237, v237, v3
    v_mul_f32 v238, v238, v3
    v_mul_f32 v239, v239, v3
    v_cvt_pk_bf16_f32 v100, v232, v233
    v_cvt_pk_bf16_f32 v101, v234, v235
    v_cvt_pk_bf16_f32 v102, v236, v237
    v_cvt_pk_bf16_f32 v103, v238, v239
    buffer_store_dwordx4 v[100:103], v14, s[20:23], s37 offen offset:1024 sc1
    v_mul_f32 v240, v240, v3
    v_mul_f32 v241, v241, v3
    v_mul_f32 v242, v242, v3
    v_mul_f32 v243, v243, v3
    v_mul_f32 v244, v244, v3
    v_mul_f32 v245, v245, v3
    v_mul_f32 v246, v246, v3
    v_mul_f32 v247, v247, v3
    v_cvt_pk_bf16_f32 v104, v240, v241
    v_cvt_pk_bf16_f32 v105, v242, v243
    v_cvt_pk_bf16_f32 v106, v244, v245
    v_cvt_pk_bf16_f32 v107, v246, v247
    buffer_store_dwordx4 v[104:107], v14, s[20:23], s37 offen offset:2048 sc1
    v_mul_f32 v248, v248, v3
    v_mul_f32 v249, v249, v3
    v_mul_f32 v250, v250, v3
    v_mul_f32 v251, v251, v3
    v_mul_f32 v252, v252, v3
    v_mul_f32 v253, v253, v3
    v_mul_f32 v254, v254, v3
    v_mul_f32 v255, v255, v3
    v_cvt_pk_bf16_f32 v108, v248, v249
    v_cvt_pk_bf16_f32 v109, v250, v251
    v_cvt_pk_bf16_f32 v110, v252, v253
    v_cvt_pk_bf16_f32 v111, v254, v255
    buffer_store_dwordx4 v[108:111], v14, s[20:23], s37 offen offset:3072 sc1
    s_waitcnt vmcnt(0)
    s_barrier
    s_cmp_lg_u32 s24, 0
    s_cbranch_scc1 L_finpub
    s_and_b32 s37, s26, 16
    s_add_u32 s37, s37, s25
    s_lshl_b32 s37, s37, 8
    s_and_b32 s38, s26, 15
    s_lshl_b32 s38, s38, 2
    s_add_u32 s37, s37, s38
    s_add_u32 s37, s37, 46202880
    v_mov_b32 v62, 0
    v_mov_b32 v63, s3
    s_mov_b64 exec, 1
    s_nop 0
    buffer_store_dword v63, v62, s[20:23], s37 offen sc1
    s_mov_b64 exec, -1
L_finpub:
    s_endpgm
L_sig:
    s_cmp_lg_u32 s24, 0
    s_cbranch_scc1 L_sigback
    s_xor_b32 s37, s2, 256
    s_lshl_b32 s37, s37, 7
    s_add_u32 s37, s37, 46243840
    v_mov_b32 v62, 0
    v_mov_b32 v63, s3
    s_mov_b64 exec, 1
    s_nop 0
    buffer_store_dword v63, v62, s[20:23], s37 offen sc1
    s_mov_b64 exec, -1
    s_branch L_sigback
L_sigt:
    s_cmp_lg_u32 s24, 0
    s_cbranch_scc1 L_sigbackt
    s_xor_b32 s37, s2, 256
    s_lshl_b32 s37, s37, 7
    s_add_u32 s37, s37, 46243840
    v_mov_b32 v62, 0
    v_mov_b32 v63, s3
    s_mov_b64 exec, 1
    s_nop 0
    buffer_store_dword v63, v62, s[20:23], s37 offen sc1
    s_mov_b64 exec, -1
    s_branch L_sigbackt
L_aw:
    s_setprio 1
    s_waitcnt vmcnt(0) lgkmcnt(0)
    s_barrier
    s_mov_b32 s14, 0x40000
    s_mov_b32 s18, 0x40000
    s_mov_b32 s30, s70
    s_mov_b32 s31, s70
    s_add_u32 m0, s33, 34816
    s_nop 0
    buffer_load_dwordx4 v11, s[12:15], s30 offen nt lds
    s_add_u32 m0, s33, 34880
    s_nop 0
    buffer_load_dwordx4 v11, s[12:15], s30 offen offset:1024 nt lds
    s_add_u32 s30, s30, 0x2000
    s_and_b32 s30, s30, 0x3ffff
    s_cmp_lg_u32 s24, 0
    s_cbranch_scc1 L_awd
    v_mov_b32 v62, 0
    s_mov_b32 s32, 0
    s_lshl_b32 s38, s2, 7
    s_add_u32 s38, s38, 46243840
L_awl:
    buffer_load_dword v63, v62, s[20:23], s38 offen sc1
    s_waitcnt vmcnt(0)
    v_readfirstlane_b32 s37, v63
    s_add_u32 s32, s32, 1
    s_nop 2
    s_cmp_eq_u32 s37, s3
    s_cbranch_scc1 L_awd
    s_cmp_ge_u32 s32, 48
    s_cbranch_scc1 L_awd
    s_sleep 8
    s_branch L_awl
L_awd:
    s_barrier
    s_add_u32 m0, s34, 43520
    s_nop 0
    buffer_load_dwordx4 v12, s[16:19], s31 offen nt lds
    s_add_u32 m0, s34, 44320
    s_nop 0
    buffer_load_dwordx4 v12, s[16:19], s31 offen offset:256 nt lds
    s_add_u32 s31, s31, 0x2000
    s_and_b32 s31, s31, 0x3ffff
    s_add_u32 m0, s33, 52224
    s_nop 0
    buffer_load_dwordx4 v11, s[12:15], s30 offen nt lds
    s_add_u32 m0, s33, 52288
    s_nop 0
    buffer_load_dwordx4 v11, s[12:15], s30 offen offset:1024 nt lds
    s_add_u32 s30, s30, 0x2000
    s_and_b32 s30, s30, 0x3ffff
    s_add_u32 m0, s34, 60928
    s_nop 0
    buffer_load_dwordx4 v12, s[16:19], s31 offen nt lds
    s_add_u32 m0, s34, 61728
    s_nop 0
    buffer_load_dwordx4 v12, s[16:19], s31 offen offset:256 nt lds
    s_add_u32 s31, s31, 0x2000
    s_and_b32 s31, s31, 0x3ffff
    s_add_u32 m0, s33, 69632
    s_nop 0
    buffer_load_dwordx4 v11, s[12:15], s30 offen nt lds
    s_add_u32 m0, s33, 69696
    s_nop 0
    buffer_load_dwordx4 v11, s[12:15], s30 offen offset:1024 nt lds
    s_add_u32 s30, s30, 0x2000
    s_and_b32 s30, s30, 0x3ffff
    s_add_u32 m0, s34, 0
    s_nop 0
    buffer_load_dwordx4 v12, s[16:19], s31 offen nt lds
    s_add_u32 m0, s34, 800
    s_nop 0
    buffer_load_dwordx4 v12, s[16:19], s31 offen offset:256 nt lds
    s_add_u32 s31, s31, 0x2000
    s_and_b32 s31, s31, 0x3ffff
    s_add_u32 m0, s33, 8704
    s_nop 0
    buffer_load_dwordx4 v11, s[12:15], s30 offen nt lds
    s_add_u32 m0, s33, 8768
    s_nop 0
    buffer_load_dwordx4 v11, s[12:15], s30 offen offset:1024 nt lds
    s_add_u32 s30, s30, 0x2000
    s_and_b32 s30, s30, 0x3ffff
    s_add_u32 m0, s34, 17408
    s_nop 0
    buffer_load_dwordx4 v12, s[16:19], s31 offen nt lds
    s_add_u32 m0, s34, 18208
    s_nop 0
    buffer_load_dwordx4 v12, s[16:19], s31 offen offset:256 nt lds
    s_add_u32 s31, s31, 0x2000
    s_and_b32 s31, s31, 0x3ffff
    s_waitcnt vmcnt(14)
    s_barrier
    ds_read_b128 v[28:31], v9 offset:26112
    ds_read_b128 v[32:35], v9 offset:26176
    ds_read_b128 v[36:39], v9 offset:26240
    ds_read_b128 v[40:43], v9 offset:26304
    ds_read_b128 v[44:47], v9 offset:30464
    ds_read_b128 v[48:51], v9 offset:30528
    ds_read_b128 v[52:55], v9 offset:30592
    s_branch L_awback
L_tokslow:
    s_sleep 8
    buffer_load_dword v63, v62, s[96:99], 0 offen sc1
    s_waitcnt vmcnt(0)
    s_branch L_tok
L_B:
    s_setprio 0
    s_nop 7
    s_nop 1
    s_mul_i32 s37, s25, 12
    s_mul_i32 s38, s24, 3
    s_add_u32 s37, s37, s38
    s_mul_i32 s37, s37, 131072
    s_lshl_b32 s38, s26, 12
    s_add_u32 s37, s37, s38
    v_mov_b32 v7, v1
    s_nop 1
    v_permlane16_swap_b32 v1, v7
    s_nop 1
    v_add_f32 v1, v1, v7
    v_mov_b32 v7, v1
    s_nop 1
    v_permlane32_swap_b32 v1, v7
    s_nop 1
    v_add_f32 v1, v1, v7
    v_rcp_f32 v1, v1
    s_nop 0
    v_mul_f32 v160, v160, v1
    v_mul_f32 v161, v161, v1
    v_mul_f32 v162, v162, v1
    v_mul_f32 v163, v163, v1
    v_mul_f32 v164, v164, v1
    v_mul_f32 v165, v165, v1
    v_mul_f32 v166, v166, v1
    v_mul_f32 v167, v167, v1
    v_cvt_pk_bf16_f32 v64, v160, v161
    v_cvt_pk_bf16_f32 v65, v162, v163
    v_cvt_pk_bf16_f32 v66, v164, v165
    v_cvt_pk_bf16_f32 v67, v166, v167
    buffer_store_dwordx4 v[64:67], v14, s[20:23], s37 offen sc1 nt
    v_mul_f32 v168, v168, v1
    v_mul_f32 v169, v169, v1
    v_mul_f32 v170, v170, v1
    v_mul_f32 v171, v171, v1
    v_mul_f32 v172, v172, v1
    v_mul_f32 v173, v173, v1
    v_mul_f32 v174, v174, v1
    v_mul_f32 v175, v175, v1
    v_cvt_pk_bf16_f32 v68, v168, v169
    v_cvt_pk_bf16_f32 v69, v170, v171
    v_cvt_pk_bf16_f32 v70, v172, v173
    v_cvt_pk_bf16_f32 v71, v174, v175
    buffer_store_dwordx4 v[68:71], v14, s[20:23], s37 offen offset:1024 sc1 nt
    v_mul_f32 v176, v176, v1
    v_mul_f32 v177, v177, v1
    v_mul_f32 v178, v178, v1
    v_mul_f32 v179, v179, v1
    v_mul_f32 v180, v180, v1
    v_mul_f32 v181, v181, v1
    v_mul_f32 v182, v182, v1
    v_mul_f32 v183, v183, v1
    v_cvt_pk_bf16_f32 v72, v176, v177
    v_cvt_pk_bf16_f32 v73, v178, v179
    v_cvt_pk_bf16_f32 v74, v180, v181
    v_cvt_pk_bf16_f32 v75, v182, v183
    buffer_store_dwordx4 v[72:75], v14, s[20:23], s37 offen offset:2048 sc1 nt
    v_mul_f32 v184, v184, v1
    v_mul_f32 v185, v185, v1
    v_mul_f32 v186, v186, v1
    v_mul_f32 v187, v187, v1
    v_mul_f32 v188, v188, v1
    v_mul_f32 v189, v189, v1
    v_mul_f32 v190, v190, v1
    v_mul_f32 v191, v191, v1
    v_cvt_pk_bf16_f32 v76, v184, v185
    v_cvt_pk_bf16_f32 v77, v186, v187
    v_cvt_pk_bf16_f32 v78, v188, v189
    v_cvt_pk_bf16_f32 v79, v190, v191
    buffer_store_dwordx4 v[76:79], v14, s[20:23], s37 offen offset:3072 sc1 nt
    s_add_u32 s37, s37, 131072
    v_mov_b32 v7, v2
    s_nop 1
    v_permlane16_swap_b32 v2, v7
    s_nop 1
    v_add_f32 v2, v2, v7
    v_mov_b32 v7, v2
    s_nop 1
    v_permlane32_swap_b32 v2, v7
    s_nop 1
    v_add_f32 v2, v2, v7
    v_rcp_f32 v2, v2
    s_nop 0
    v_mul_f32 v192, v192, v2
    v_mul_f32 v193, v193, v2
    v_mul_f32 v194, v194, v2
    v_mul_f32 v195, v195, v2
    v_mul_f32 v196, v196, v2
    v_mul_f32 v197, v197, v2
    v_mul_f32 v198, v198, v2
    v_mul_f32 v199, v199, v2
    v_cvt_pk_bf16_f32 v80, v192, v193
    v_cvt_pk_bf16_f32 v81, v194, v195
    v_cvt_pk_bf16_f32 v82, v196, v197
    v_cvt_pk_bf16_f32 v83, v198, v199
    buffer_store_dwordx4 v[80:83], v14, s[20:23], s37 offen sc1 nt
    v_mul_f32 v200, v200, v2
    v_mul_f32 v201, v201, v2
    v_mul_f32 v202, v202, v2
    v_mul_f32 v203, v203, v2
    v_mul_f32 v204, v204, v2
    v_mul_f32 v205, v205, v2
    v_mul_f32 v206, v206, v2
    v_mul_f32 v207, v207, v2
    v_cvt_pk_bf16_f32 v84, v200, v201
    v_cvt_pk_bf16_f32 v85, v202, v203
    v_cvt_pk_bf16_f32 v86, v204, v205
    v_cvt_pk_bf16_f32 v87, v206, v207
    buffer_store_dwordx4 v[84:87], v14, s[20:23], s37 offen offset:1024 sc1 nt
    v_mul_f32 v208, v208, v2
    v_mul_f32 v209, v209, v2
    v_mul_f32 v210, v210, v2
    v_mul_f32 v211, v211, v2
    v_mul_f32 v212, v212, v2
    v_mul_f32 v213, v213, v2
    v_mul_f32 v214, v214, v2
    v_mul_f32 v215, v215, v2
    v_cvt_pk_bf16_f32 v88, v208, v209
    v_cvt_pk_bf16_f32 v89, v210, v211
    v_cvt_pk_bf16_f32 v90, v212, v213
    v_cvt_pk_bf16_f32 v91, v214, v215
    buffer_store_dwordx4 v[88:91], v14, s[20:23], s37 offen offset:2048 sc1 nt
    v_mul_f32 v216, v216, v2
    v_mul_f32 v217, v217, v2
    v_mul_f32 v218, v218, v2
    v_mul_f32 v219, v219, v2
    v_mul_f32 v220, v220, v2
    v_mul_f32 v221, v221, v2
    v_mul_f32 v222, v222, v2
    v_mul_f32 v223, v223, v2
    v_cvt_pk_bf16_f32 v92, v216, v217
    v_cvt_pk_bf16_f32 v93, v218, v219
    v_cvt_pk_bf16_f32 v94, v220, v221
    v_cvt_pk_bf16_f32 v95, v222, v223
    buffer_store_dwordx4 v[92:95], v14, s[20:23], s37 offen offset:3072 sc1 nt
    s_add_u32 s37, s37, 131072
    v_mov_b32 v7, v3
    s_nop 1
    v_permlane16_swap_b32 v3, v7
    s_nop 1
    v_add_f32 v3, v3, v7
    v_mov_b32 v7, v3
    s_nop 1
    v_permlane32_swap_b32 v3, v7
    s_nop 1
    v_add_f32 v3, v3, v7
    v_rcp_f32 v3, v3
    s_nop 0
    v_mul_f32 v224, v224, v3
    v_mul_f32 v225, v225, v3
    v_mul_f32 v226, v226, v3
    v_mul_f32 v227, v227, v3
    v_mul_f32 v228, v228, v3
    v_mul_f32 v229, v229, v3
    v_mul_f32 v230, v230, v3
    v_mul_f32 v231, v231, v3
    v_cvt_pk_bf16_f32 v96, v224, v225
    v_cvt_pk_bf16_f32 v97, v226, v227
    v_cvt_pk_bf16_f32 v98, v228, v229
    v_cvt_pk_bf16_f32 v99, v230, v231
    buffer_store_dwordx4 v[96:99], v14, s[20:23], s37 offen sc1 nt
    v_mul_f32 v232, v232, v3
    v_mul_f32 v233, v233, v3
    v_mul_f32 v234, v234, v3
    v_mul_f32 v235, v235, v3
    v_mul_f32 v236, v236, v3
    v_mul_f32 v237, v237, v3
    v_mul_f32 v238, v238, v3
    v_mul_f32 v239, v239, v3
    v_cvt_pk_bf16_f32 v100, v232, v233
    v_cvt_pk_bf16_f32 v101, v234, v235
    v_cvt_pk_bf16_f32 v102, v236, v237
    v_cvt_pk_bf16_f32 v103, v238, v239
    buffer_store_dwordx4 v[100:103], v14, s[20:23], s37 offen offset:1024 sc1 nt
    v_mul_f32 v240, v240, v3
    v_mul_f32 v241, v241, v3
    v_mul_f32 v242, v242, v3
    v_mul_f32 v243, v243, v3
    v_mul_f32 v244, v244, v3
    v_mul_f32 v245, v245, v3
    v_mul_f32 v246, v246, v3
    v_mul_f32 v247, v247, v3
    v_cvt_pk_bf16_f32 v104, v240, v241
    v_cvt_pk_bf16_f32 v105, v242, v243
    v_cvt_pk_bf16_f32 v106, v244, v245
    v_cvt_pk_bf16_f32 v107, v246, v247
    buffer_store_dwordx4 v[104:107], v14, s[20:23], s37 offen offset:2048 sc1 nt
    v_mul_f32 v248, v248, v3
    v_mul_f32 v249, v249, v3
    v_mul_f32 v250, v250, v3
    v_mul_f32 v251, v251, v3
    v_mul_f32 v252, v252, v3
    v_mul_f32 v253, v253, v3
    v_mul_f32 v254, v254, v3
    v_mul_f32 v255, v255, v3
    v_cvt_pk_bf16_f32 v108, v248, v249
    v_cvt_pk_bf16_f32 v109, v250, v251
    v_cvt_pk_bf16_f32 v110, v252, v253
    v_cvt_pk_bf16_f32 v111, v254, v255
    buffer_store_dwordx4 v[108:111], v14, s[20:23], s37 offen offset:3072 sc1 nt
    s_mov_b32 s4, s56
    s_and_b32 s5, s57, 0xffff
    s_mov_b32 s6, 8388608
    s_mov_b32 s7, 0x00020000
    s_mov_b32 s12, s58
    s_and_b32 s13, s59, 0xffff
    s_mov_b32 s14, 6291456
    s_mov_b32 s15, 0x00020000
    s_and_b32 s37, s46, 3
    s_lshl_b32 s37, s37, 3
    s_and_b32 s44, s47, 7
    s_add_u32 s44, s44, s37
    s_lshr_b32 s37, s46, 2
    s_lshl_b32 s37, s37, 2
    s_lshr_b32 s45, s47, 3
    s_add_u32 s45, s45, s37
    s_and_b32 s33, s24, 1
    s_lshr_b32 s34, s24, 1
    s_mov_b32 s29, 0
    s_mul_i32 s67, s34, 33792
    s_mul_i32 s37, s33, 4224
    s_add_u32 s67, s67, s37
    s_lshl_b32 s28, s34, 21
    s_mul_i32 s27, s44, 6
    s_mul_i32 s37, s33, 3
    s_add_u32 s27, s27, s37
    s_mul_i32 s27, s27, 131072
    s_lshl_b32 s37, s34, 15
    s_add_u32 s27, s27, s37
    v_and_b32 v2, 15, v13
    v_lshrrev_b32 v3, 4, v13
    v_lshlrev_b32 v20, 4, v13
    v_add_u32 v21, 131072, v20
    v_add_u32 v22, 262144, v20
    v_lshlrev_b32 v4, 14, v3
    v_lshl_add_u32 v4, v2, 4, v4
    s_lshl_b32 s37, s33, 13
    s_lshl_b32 s38, s45, 8
    s_add_u32 s37, s37, s38
    v_add_u32 v16, s37, v4
    v_add_u32 v17, 0x800, v16
    v_add_u32 v18, 0x1000, v16
    v_add_u32 v19, 0x1800, v16
    v_and_b32 v4, 1, v3
    v_lshlrev_b32 v4, 2, v4
    v_lshrrev_b32 v5, 2, v2
    v_add_u32 v4, v4, v5
    v_mul_u32_u24 v4, 1056, v4
    v_lshrrev_b32 v5, 1, v3
    v_lshl_add_u32 v4, v5, 8, v4
    v_and_b32 v5, 3, v2
    v_lshl_add_u32 v4, v5, 4, v4
    s_mul_i32 s37, s34, 33792
    v_add_u32 v4, s37, v4
    v_lshrrev_b32 v5, 1, v5
    v_lshl_add_u32 v23, v5, 3, v4
    v_xor_b32 v5, 1, v5
    v_lshl_add_u32 v24, v5, 3, v4
    s_add_u32 m0, s67, 0
    s_nop 0
    buffer_load_dwordx4 v16, s[4:7], s28 offen lds
    s_add_u32 m0, s67, 1056
    s_nop 0
    buffer_load_dwordx4 v17, s[4:7], s28 offen lds
    s_add_u32 m0, s67, 2112
    s_nop 0
    buffer_load_dwordx4 v18, s[4:7], s28 offen lds
    s_add_u32 m0, s67, 3168
    s_nop 0
    buffer_load_dwordx4 v19, s[4:7], s28 offen lds
    s_add_u32 s28, s28, 0x10000
    s_add_u32 m0, s67, 8448
    s_nop 0
    buffer_load_dwordx4 v16, s[4:7], s28 offen lds
    s_add_u32 m0, s67, 9504
    s_nop 0
    buffer_load_dwordx4 v17, s[4:7], s28 offen lds
    s_add_u32 m0, s67, 10560
    s_nop 0
    buffer_load_dwordx4 v18, s[4:7], s28 offen lds
    s_add_u32 m0, s67, 11616
    s_nop 0
    buffer_load_dwordx4 v19, s[4:7], s28 offen lds
    s_add_u32 s28, s28, 0x10000
    s_add_u32 m0, s67, 16896
    s_nop 0
    buffer_load_dwordx4 v16, s[4:7], s28 offen lds
    s_add_u32 m0, s67, 17952
    s_nop 0
    buffer_load_dwordx4 v17, s[4:7], s28 offen lds
    s_add_u32 m0, s67, 19008
    s_nop 0
    buffer_load_dwordx4 v18, s[4:7], s28 offen lds
    s_add_u32 m0, s67, 20064
    s_nop 0
    buffer_load_dwordx4 v19, s[4:7], s28 offen lds
    s_add_u32 s28, s28, 0x10000
    s_add_u32 m0, s67, 25344
    s_nop 0
    buffer_load_dwordx4 v16, s[4:7], s28 offen lds
    s_add_u32 m0, s67, 26400
    s_nop 0
    buffer_load_dwordx4 v17, s[4:7], s28 offen lds
    s_add_u32 m0, s67, 27456
    s_nop 0
    buffer_load_dwordx4 v18, s[4:7], s28 offen lds
    s_add_u32 m0, s67, 28512
    s_nop 0
    buffer_load_dwordx4 v19, s[4:7], s28 offen lds
    s_add_u32 s28, s28, 0x10000
    v_mov_b32 v160, 0
    v_mov_b32 v161, 0
    v_mov_b32 v162, 0
    v_mov_b32 v163, 0
    v_mov_b32 v164, 0
    v_mov_b32 v165, 0
    v_mov_b32 v166, 0
    v_mov_b32 v167, 0
    v_mov_b32 v168, 0
    v_mov_b32 v169, 0
    v_mov_b32 v170, 0
    v_mov_b32 v171, 0
    v_mov_b32 v172, 0
    v_mov_b32 v173, 0
    v_mov_b32 v174, 0
    v_mov_b32 v175, 0
    v_mov_b32 v176, 0
    v_mov_b32 v177, 0
    v_mov_b32 v178, 0
    v_mov_b32 v179, 0
    v_mov_b32 v180, 0
    v_mov_b32 v181, 0
    v_mov_b32 v182, 0
    v_mov_b32 v183, 0
    v_mov_b32 v184, 0
    v_mov_b32 v185, 0
    v_mov_b32 v186, 0
    v_mov_b32 v187, 0
    v_mov_b32 v188, 0
    v_mov_b32 v189, 0
    v_mov_b32 v190, 0
    v_mov_b32 v191, 0
    v_mov_b32 v192, 0
    v_mov_b32 v193, 0
    v_mov_b32 v194, 0
    v_mov_b32 v195, 0
    v_mov_b32 v196, 0
    v_mov_b32 v197, 0
    v_mov_b32 v198, 0
    v_mov_b32 v199, 0
    v_mov_b32 v200, 0
    v_mov_b32 v201, 0
    v_mov_b32 v202, 0
    v_mov_b32 v203, 0
    v_mov_b32 v204, 0
    v_mov_b32 v205, 0
    v_mov_b32 v206, 0
    v_mov_b32 v207, 0
    v_mov_b32 v208, 0
    v_mov_b32 v209, 0
    v_mov_b32 v210, 0
    v_mov_b32 v211, 0
    v_mov_b32 v212, 0
    v_mov_b32 v213, 0
    v_mov_b32 v214, 0
    v_mov_b32 v215, 0
    v_mov_b32 v216, 0
    v_mov_b32 v217, 0
    v_mov_b32 v218, 0
    v_mov_b32 v219, 0
    v_mov_b32 v220, 0
    v_mov_b32 v221, 0
    v_mov_b32 v222, 0
    v_mov_b32 v223, 0
    v_mov_b32 v224, 0
    v_mov_b32 v225, 0
    v_mov_b32 v226, 0
    v_mov_b32 v227, 0
    v_mov_b32 v228, 0
    v_mov_b32 v229, 0
    v_mov_b32 v230, 0
    v_mov_b32 v231, 0
    v_mov_b32 v232, 0
    v_mov_b32 v233, 0
    v_mov_b32 v234, 0
    v_mov_b32 v235, 0
    v_mov_b32 v236, 0
    v_mov_b32 v237, 0
    v_mov_b32 v238, 0
    v_mov_b32 v239, 0
    v_mov_b32 v240, 0
    v_mov_b32 v241, 0
    v_mov_b32 v242, 0
    v_mov_b32 v243, 0
    v_mov_b32 v244, 0
    v_mov_b32 v245, 0
    v_mov_b32 v246, 0
    v_mov_b32 v247, 0
    v_mov_b32 v248, 0
    v_mov_b32 v249, 0
    v_mov_b32 v250, 0
    v_mov_b32 v251, 0
    v_mov_b32 v252, 0
    v_mov_b32 v253, 0
    v_mov_b32 v254, 0
    v_mov_b32 v255, 0
    s_waitcnt vmcnt(16)
    s_barrier
    s_cmp_lg_u32 s24, 0
    s_cbranch_scc1 L_pub0
    s_and_b32 s37, s26, 16
    s_add_u32 s37, s37, s25
    s_lshl_b32 s37, s37, 8
    s_and_b32 s38, s26, 15
    s_lshl_b32 s38, s38, 2
    s_add_u32 s37, s37, s38
    s_add_u32 s37, s37, 46202880
    v_mov_b32 v62, 0
    v_mov_b32 v63, s3
    s_mov_b64 exec, 1
    s_nop 0
    buffer_store_dword v63, v62, s[20:23], s37 offen sc1
    s_mov_b64 exec, -1
L_pub0:
    s_setprio 0
    s_lshl_b32 s37, s29, 4
    s_lshl_b32 s38, s34, 3
    s_add_u32 s37, s37, s38
    s_and_b32 s38, s47, 7
    s_add_u32 s37, s37, s38
    s_lshl_b32 s37, s37, 1
    s_add_u32 s37, s37, s33
    s_lshl_b32 s37, s37, 17
    s_lshl_b32 s38, s45, 8
    s_add_u32 s37, s37, s38
    v_lshlrev_b32 v14, 11, v13
    buffer_load_dword v7, v14, s[4:7], s37 offen
    buffer_load_dword v8, v14, s[4:7], s37 offen offset:128
    s_waitcnt vmcnt(12)
    s_barrier
    ds_read_b64_tr_b16 v[28:29], v23 offset:0
    ds_read_b64_tr_b16 v[30:31], v23 offset:512
    ds_read_b64_tr_b16 v[32:33], v24 offset:0
    ds_read_b64_tr_b16 v[34:35], v24 offset:512
    ds_read_b64_tr_b16 v[36:37], v23 offset:64
    ds_read_b64_tr_b16 v[38:39], v23 offset:576
    ds_read_b64_tr_b16 v[40:41], v24 offset:64
    ds_read_b64_tr_b16 v[42:43], v24 offset:576
    ds_read_b64_tr_b16 v[44:45], v23 offset:128
    ds_read_b64_tr_b16 v[46:47], v23 offset:640
    ds_read_b64_tr_b16 v[48:49], v24 offset:128
    ds_read_b64_tr_b16 v[50:51], v24 offset:640
    ds_read_b64_tr_b16 v[52:53], v23 offset:192
    ds_read_b64_tr_b16 v[54:55], v23 offset:704
L_phase:
    s_cmp_eq_u32 s29, 0
    s_cbranch_scc1 L_nowt
    s_lshl_b32 s37, s29, 4
    s_lshl_b32 s38, s34, 3
    s_add_u32 s37, s37, s38
    s_and_b32 s38, s47, 7
    s_add_u32 s37, s37, s38
    s_lshl_b32 s37, s37, 1
    s_add_u32 s37, s37, s33
    s_lshl_b32 s37, s37, 17
    s_lshl_b32 s38, s45, 8
    s_add_u32 s37, s37, s38
    v_lshlrev_b32 v14, 11, v13
    buffer_load_dword v7, v14, s[4:7], s37 offen
    buffer_load_dword v8, v14, s[4:7], s37 offen offset:128
L_nowt:
    s_cmp_lg_u32 s24, 0
    s_cbranch_scc1 L_bpd
    s_lshr_b32 s37, s44, 1
    s_lshl_b32 s38, s29, 4
    s_add_u32 s37, s37, s38
    s_lshl_b32 s37, s37, 8
    s_add_u32 s37, s37, 46202880
    v_and_b32 v62, 15, v13
    v_lshlrev_b32 v62, 2, v62
    s_mov_b32 s32, 0
L_bpl:
    buffer_load_dword v63, v62, s[20:23], s37 offen sc1
    s_waitcnt vmcnt(0)
    v_cmp_ne_u32 vcc, s3, v63
    s_nop 3
    s_cbranch_vccz L_bpd
    s_add_u32 s32, s32, 1
    s_cmp_ge_u32 s32, 131072
    s_cbranch_scc1 L_bpd
    s_sleep 24
    s_branch L_bpl
L_bpd:
    s_barrier
    buffer_load_dwordx4 v[64:67], v20, s[20:23], s27 offen sc1
    buffer_load_dwordx4 v[68:71], v21, s[20:23], s27 offen sc1
    buffer_load_dwordx4 v[72:75], v22, s[20:23], s27 offen sc1
    buffer_load_dwordx4 v[76:79], v20, s[20:23], s27 offen offset:1024 sc1
    buffer_load_dwordx4 v[80:83], v21, s[20:23], s27 offen offset:1024 sc1
    buffer_load_dwordx4 v[84:87], v22, s[20:23], s27 offen offset:1024 sc1
    s_add_u32 s27, s27, 2048
    buffer_load_dwordx4 v[88:91], v20, s[20:23], s27 offen sc1
    buffer_load_dwordx4 v[92:95], v21, s[20:23], s27 offen sc1
    buffer_load_dwordx4 v[96:99], v22, s[20:23], s27 offen sc1
    buffer_load_dwordx4 v[100:103], v20, s[20:23], s27 offen offset:1024 sc1
    buffer_load_dwordx4 v[104:107], v21, s[20:23], s27 offen offset:1024 sc1
    buffer_load_dwordx4 v[108:111], v22, s[20:23], s27 offen offset:1024 sc1
    s_add_u32 s27, s27, 2048
    buffer_load_dwordx4 v[112:115], v20, s[20:23], s27 offen sc1
    buffer_load_dwordx4 v[116:119], v21, s[20:23], s27 offen sc1
    buffer_load_dwordx4 v[120:123], v22, s[20:23], s27 offen sc1
    buffer_load_dwordx4 v[124:127], v20, s[20:23], s27 offen offset:1024 sc1
    buffer_load_dwordx4 v[128:131], v21, s[20:23], s27 offen offset:1024 sc1
    buffer_load_dwordx4 v[132:135], v22, s[20:23], s27 offen offset:1024 sc1
    s_add_u32 s27, s27, 2048
    s_mov_b32 s32, 3
L_oloop:
    s_waitcnt vmcnt(15)
    s_waitcnt lgkmcnt(10)
    v_mfma_f32_16x16x32_bf16 v[160:163], v[28:31], v[64:67], v[160:163]
    v_mfma_f32_16x16x32_bf16 v[192:195], v[28:31], v[68:71], v[192:195]
    buffer_load_dwordx4 v[136:139], v20, s[20:23], s27 offen sc1
    v_mfma_f32_16x16x32_bf16 v[224:227], v[28:31], v[72:75], v[224:227]
    v_mfma_f32_16x16x32_bf16 v[164:167], v[32:35], v[64:67], v[164:167]
    ds_read_b64_tr_b16 v[56:57], v24 offset:192
    ds_read_b64_tr_b16 v[58:59], v24 offset:704
    v_mfma_f32_16x16x32_bf16 v[196:199], v[32:35], v[68:71], v[196:199]
    buffer_load_dwordx4 v[140:143], v21, s[20:23], s27 offen sc1
    v_mfma_f32_16x16x32_bf16 v[228:231], v[32:35], v[72:75], v[228:231]
    s_waitcnt lgkmcnt(8)
    v_mfma_f32_16x16x32_bf16 v[168:171], v[36:39], v[64:67], v[168:171]
    v_mfma_f32_16x16x32_bf16 v[200:203], v[36:39], v[68:71], v[200:203]
    buffer_load_dwordx4 v[144:147], v22, s[20:23], s27 offen sc1
    v_mfma_f32_16x16x32_bf16 v[232:235], v[36:39], v[72:75], v[232:235]
    v_mfma_f32_16x16x32_bf16 v[172:175], v[40:43], v[64:67], v[172:175]
    v_mfma_f32_16x16x32_bf16 v[204:207], v[40:43], v[68:71], v[204:207]
    v_mfma_f32_16x16x32_bf16 v[236:239], v[40:43], v[72:75], v[236:239]
    s_waitcnt vmcnt(17) lgkmcnt(0)
    s_barrier
    v_mfma_f32_16x16x32_bf16 v[176:179], v[44:47], v[64:67], v[176:179]
    ds_read_b64_tr_b16 v[28:29], v23 offset:8448
    ds_read_b64_tr_b16 v[30:31], v23 offset:8960
    s_add_u32 m0, s67, 0
    v_mfma_f32_16x16x32_bf16 v[208:211], v[44:47], v[68:71], v[208:211]
    buffer_load_dwordx4 v16, s[4:7], s28 offen lds
    ds_read_b64_tr_b16 v[32:33], v24 offset:8448
    ds_read_b64_tr_b16 v[34:35], v24 offset:8960
    v_mfma_f32_16x16x32_bf16 v[240:243], v[44:47], v[72:75], v[240:243]
    ds_read_b64_tr_b16 v[36:37], v23 offset:8512
    ds_read_b64_tr_b16 v[38:39], v23 offset:9024
    s_add_u32 m0, s67, 1056
    v_mfma_f32_16x16x32_bf16 v[180:183], v[48:51], v[64:67], v[180:183]
    buffer_load_dwordx4 v17, s[4:7], s28 offen lds
    ds_read_b64_tr_b16 v[40:41], v24 offset:8512
    ds_read_b64_tr_b16 v[42:43], v24 offset:9024
    v_mfma_f32_16x16x32_bf16 v[212:215], v[48:51], v[68:71], v[212:215]
    ds_read_b64_tr_b16 v[44:45], v23 offset:8576
    ds_read_b64_tr_b16 v[46:47], v23 offset:9088
    s_add_u32 m0, s67, 2112
    v_mfma_f32_16x16x32_bf16 v[244:247], v[48:51], v[72:75], v[244:247]
    buffer_load_dwordx4 v18, s[4:7], s28 offen lds
    v_mfma_f32_16x16x32_bf16 v[184:187], v[52:55], v[64:67], v[184:187]
    ds_read_b64_tr_b16 v[48:49], v24 offset:8576
    ds_read_b64_tr_b16 v[50:51], v24 offset:9088
    s_add_u32 m0, s67, 3168
    v_mfma_f32_16x16x32_bf16 v[216:219], v[52:55], v[68:71], v[216:219]
    buffer_load_dwordx4 v19, s[4:7], s28 offen lds
    v_mfma_f32_16x16x32_bf16 v[248:251], v[52:55], v[72:75], v[248:251]
    v_mfma_f32_16x16x32_bf16 v[188:191], v[56:59], v[64:67], v[188:191]
    ds_read_b64_tr_b16 v[52:53], v23 offset:8640
    ds_read_b64_tr_b16 v[54:55], v23 offset:9152
    v_mfma_f32_16x16x32_bf16 v[220:223], v[56:59], v[68:71], v[220:223]
    s_add_u32 s28, s28, 65536
    v_mfma_f32_16x16x32_bf16 v[252:255], v[56:59], v[72:75], v[252:255]
    s_waitcnt vmcnt(19)
    s_waitcnt lgkmcnt(10)
    v_mfma_f32_16x16x32_bf16 v[160:163], v[28:31], v[76:79], v[160:163]
    v_mfma_f32_16x16x32_bf16 v[192:195], v[28:31], v[80:83], v[192:195]
    buffer_load_dwordx4 v[148:151], v20, s[20:23], s27 offen offset:1024 sc1
    v_mfma_f32_16x16x32_bf16 v[224:227], v[28:31], v[84:87], v[224:227]
    v_mfma_f32_16x16x32_bf16 v[164:167], v[32:35], v[76:79], v[164:167]
    ds_read_b64_tr_b16 v[56:57], v24 offset:8640
    ds_read_b64_tr_b16 v[58:59], v24 offset:9152
    v_mfma_f32_16x16x32_bf16 v[196:199], v[32:35], v[80:83], v[196:199]
    buffer_load_dwordx4 v[152:155], v21, s[20:23], s27 offen offset:1024 sc1
    v_mfma_f32_16x16x32_bf16 v[228:231], v[32:35], v[84:87], v[228:231]
    s_waitcnt lgkmcnt(8)
    v_mfma_f32_16x16x32_bf16 v[168:171], v[36:39], v[76:79], v[168:171]
    v_mfma_f32_16x16x32_bf16 v[200:203], v[36:39], v[80:83], v[200:203]
    buffer_load_dwordx4 v[156:159], v22, s[20:23], s27 offen offset:1024 sc1
    v_mfma_f32_16x16x32_bf16 v[232:235], v[36:39], v[84:87], v[232:235]
    v_mfma_f32_16x16x32_bf16 v[172:175], v[40:43], v[76:79], v[172:175]
    s_add_u32 s27, s27, 2048
    v_mfma_f32_16x16x32_bf16 v[204:207], v[40:43], v[80:83], v[204:207]
    v_mfma_f32_16x16x32_bf16 v[236:239], v[40:43], v[84:87], v[236:239]
    s_waitcnt vmcnt(17) lgkmcnt(0)
    s_barrier
    v_mfma_f32_16x16x32_bf16 v[176:179], v[44:47], v[76:79], v[176:179]
    ds_read_b64_tr_b16 v[28:29], v23 offset:16896
    ds_read_b64_tr_b16 v[30:31], v23 offset:17408
    s_add_u32 m0, s67, 8448
    v_mfma_f32_16x16x32_bf16 v[208:211], v[44:47], v[80:83], v[208:211]
    buffer_load_dwordx4 v16, s[4:7], s28 offen lds
    ds_read_b64_tr_b16 v[32:33], v24 offset:16896
    ds_read_b64_tr_b16 v[34:35], v24 offset:17408
    v_mfma_f32_16x16x32_bf16 v[240:243], v[44:47], v[84:87], v[240:243]
    ds_read_b64_tr_b16 v[36:37], v23 offset:16960
    ds_read_b64_tr_b16 v[38:39], v23 offset:17472
    s_add_u32 m0, s67, 9504
    v_mfma_f32_16x16x32_bf16 v[180:183], v[48:51], v[76:79], v[180:183]
    buffer_load_dwordx4 v17, s[4:7], s28 offen lds
    ds_read_b64_tr_b16 v[40:41], v24 offset:16960
    ds_read_b64_tr_b16 v[42:43], v24 offset:17472
    v_mfma_f32_16x16x32_bf16 v[212:215], v[48:51], v[80:83], v[212:215]
    ds_read_b64_tr_b16 v[44:45], v23 offset:17024
    ds_read_b64_tr_b16 v[46:47], v23 offset:17536
    s_add_u32 m0, s67, 10560
    v_mfma_f32_16x16x32_bf16 v[244:247], v[48:51], v[84:87], v[244:247]
    buffer_load_dwordx4 v18, s[4:7], s28 offen lds
    v_mfma_f32_16x16x32_bf16 v[184:187], v[52:55], v[76:79], v[184:187]
    ds_read_b64_tr_b16 v[48:49], v24 offset:17024
    ds_read_b64_tr_b16 v[50:51], v24 offset:17536
    s_add_u32 m0, s67, 11616
    v_mfma_f32_16x16x32_bf16 v[216:219], v[52:55], v[80:83], v[216:219]
    buffer_load_dwordx4 v19, s[4:7], s28 offen lds
    v_mfma_f32_16x16x32_bf16 v[248:251], v[52:55], v[84:87], v[248:251]
    v_mfma_f32_16x16x32_bf16 v[188:191], v[56:59], v[76:79], v[188:191]
    ds_read_b64_tr_b16 v[52:53], v23 offset:17088
    ds_read_b64_tr_b16 v[54:55], v23 offset:17600
    v_mfma_f32_16x16x32_bf16 v[220:223], v[56:59], v[80:83], v[220:223]
    s_add_u32 s28, s28, 65536
    v_mfma_f32_16x16x32_bf16 v[252:255], v[56:59], v[84:87], v[252:255]
    s_waitcnt vmcnt(23)
    s_waitcnt lgkmcnt(10)
    v_mfma_f32_16x16x32_bf16 v[160:163], v[28:31], v[88:91], v[160:163]
    v_mfma_f32_16x16x32_bf16 v[192:195], v[28:31], v[92:95], v[192:195]
    buffer_load_dwordx4 v[64:67], v20, s[20:23], s27 offen sc1
    v_mfma_f32_16x16x32_bf16 v[224:227], v[28:31], v[96:99], v[224:227]
    v_mfma_f32_16x16x32_bf16 v[164:167], v[32:35], v[88:91], v[164:167]
    ds_read_b64_tr_b16 v[56:57], v24 offset:17088
    ds_read_b64_tr_b16 v[58:59], v24 offset:17600
    v_mfma_f32_16x16x32_bf16 v[196:199], v[32:35], v[92:95], v[196:199]
    buffer_load_dwordx4 v[68:71], v21, s[20:23], s27 offen sc1
    v_mfma_f32_16x16x32_bf16 v[228:231], v[32:35], v[96:99], v[228:231]
    s_waitcnt lgkmcnt(8)
    v_mfma_f32_16x16x32_bf16 v[168:171], v[36:39], v[88:91], v[168:171]
    v_mfma_f32_16x16x32_bf16 v[200:203], v[36:39], v[92:95], v[200:203]
    buffer_load_dwordx4 v[72:75], v22, s[20:23], s27 offen sc1
    v_mfma_f32_16x16x32_bf16 v[232:235], v[36:39], v[96:99], v[232:235]
    v_mfma_f32_16x16x32_bf16 v[172:175], v[40:43], v[88:91], v[172:175]
    v_mfma_f32_16x16x32_bf16 v[204:207], v[40:43], v[92:95], v[204:207]
    v_mfma_f32_16x16x32_bf16 v[236:239], v[40:43], v[96:99], v[236:239]
    s_waitcnt vmcnt(17) lgkmcnt(0)
    s_barrier
    v_mfma_f32_16x16x32_bf16 v[176:179], v[44:47], v[88:91], v[176:179]
    ds_read_b64_tr_b16 v[28:29], v23 offset:25344
    ds_read_b64_tr_b16 v[30:31], v23 offset:25856
    s_add_u32 m0, s67, 16896
    v_mfma_f32_16x16x32_bf16 v[208:211], v[44:47], v[92:95], v[208:211]
    buffer_load_dwordx4 v16, s[4:7], s28 offen lds
    ds_read_b64_tr_b16 v[32:33], v24 offset:25344
    ds_read_b64_tr_b16 v[34:35], v24 offset:25856
    v_mfma_f32_16x16x32_bf16 v[240:243], v[44:47], v[96:99], v[240:243]
    ds_read_b64_tr_b16 v[36:37], v23 offset:25408
    ds_read_b64_tr_b16 v[38:39], v23 offset:25920
    s_add_u32 m0, s67, 17952
    v_mfma_f32_16x16x32_bf16 v[180:183], v[48:51], v[88:91], v[180:183]
    buffer_load_dwordx4 v17, s[4:7], s28 offen lds
    ds_read_b64_tr_b16 v[40:41], v24 offset:25408
    ds_read_b64_tr_b16 v[42:43], v24 offset:25920
    v_mfma_f32_16x16x32_bf16 v[212:215], v[48:51], v[92:95], v[212:215]
    ds_read_b64_tr_b16 v[44:45], v23 offset:25472
    ds_read_b64_tr_b16 v[46:47], v23 offset:25984
    s_add_u32 m0, s67, 19008
    v_mfma_f32_16x16x32_bf16 v[244:247], v[48:51], v[96:99], v[244:247]
    buffer_load_dwordx4 v18, s[4:7], s28 offen lds
    v_mfma_f32_16x16x32_bf16 v[184:187], v[52:55], v[88:91], v[184:187]
    ds_read_b64_tr_b16 v[48:49], v24 offset:25472
    ds_read_b64_tr_b16 v[50:51], v24 offset:25984
    s_add_u32 m0, s67, 20064
    v_mfma_f32_16x16x32_bf16 v[216:219], v[52:55], v[92:95], v[216:219]
    buffer_load_dwordx4 v19, s[4:7], s28 offen lds
    v_mfma_f32_16x16x32_bf16 v[248:251], v[52:55], v[96:99], v[248:251]
    v_mfma_f32_16x16x32_bf16 v[188:191], v[56:59], v[88:91], v[188:191]
    ds_read_b64_tr_b16 v[52:53], v23 offset:25536
    ds_read_b64_tr_b16 v[54:55], v23 offset:26048
    v_mfma_f32_16x16x32_bf16 v[220:223], v[56:59], v[92:95], v[220:223]
    s_add_u32 s28, s28, 65536
    v_mfma_f32_16x16x32_bf16 v[252:255], v[56:59], v[96:99], v[252:255]
    s_waitcnt vmcnt(27)
    s_waitcnt lgkmcnt(10)
    v_mfma_f32_16x16x32_bf16 v[160:163], v[28:31], v[100:103], v[160:163]
    v_mfma_f32_16x16x32_bf16 v[192:195], v[28:31], v[104:107], v[192:195]
    buffer_load_dwordx4 v[76:79], v20, s[20:23], s27 offen offset:1024 sc1
    v_mfma_f32_16x16x32_bf16 v[224:227], v[28:31], v[108:111], v[224:227]
    v_mfma_f32_16x16x32_bf16 v[164:167], v[32:35], v[100:103], v[164:167]
    ds_read_b64_tr_b16 v[56:57], v24 offset:25536
    ds_read_b64_tr_b16 v[58:59], v24 offset:26048
    v_mfma_f32_16x16x32_bf16 v[196:199], v[32:35], v[104:107], v[196:199]
    buffer_load_dwordx4 v[80:83], v21, s[20:23], s27 offen offset:1024 sc1
    v_mfma_f32_16x16x32_bf16 v[228:231], v[32:35], v[108:111], v[228:231]
    s_waitcnt lgkmcnt(8)
    v_mfma_f32_16x16x32_bf16 v[168:171], v[36:39], v[100:103], v[168:171]
    v_mfma_f32_16x16x32_bf16 v[200:203], v[36:39], v[104:107], v[200:203]
    buffer_load_dwordx4 v[84:87], v22, s[20:23], s27 offen offset:1024 sc1
    v_mfma_f32_16x16x32_bf16 v[232:235], v[36:39], v[108:111], v[232:235]
    v_mfma_f32_16x16x32_bf16 v[172:175], v[40:43], v[100:103], v[172:175]
    s_add_u32 s27, s27, 2048
    v_mfma_f32_16x16x32_bf16 v[204:207], v[40:43], v[104:107], v[204:207]
    v_mfma_f32_16x16x32_bf16 v[236:239], v[40:43], v[108:111], v[236:239]
    s_waitcnt vmcnt(17) lgkmcnt(0)
    s_barrier
    v_mfma_f32_16x16x32_bf16 v[176:179], v[44:47], v[100:103], v[176:179]
    ds_read_b64_tr_b16 v[28:29], v23 offset:0
    ds_read_b64_tr_b16 v[30:31], v23 offset:512
    s_add_u32 m0, s67, 25344
    v_mfma_f32_16x16x32_bf16 v[208:211], v[44:47], v[104:107], v[208:211]
    buffer_load_dwordx4 v16, s[4:7], s28 offen lds
    ds_read_b64_tr_b16 v[32:33], v24 offset:0
    ds_read_b64_tr_b16 v[34:35], v24 offset:512
    v_mfma_f32_16x16x32_bf16 v[240:243], v[44:47], v[108:111], v[240:243]
    ds_read_b64_tr_b16 v[36:37], v23 offset:64
    ds_read_b64_tr_b16 v[38:39], v23 offset:576
    s_add_u32 m0, s67, 26400
    v_mfma_f32_16x16x32_bf16 v[180:183], v[48:51], v[100:103], v[180:183]
    buffer_load_dwordx4 v17, s[4:7], s28 offen lds
    ds_read_b64_tr_b16 v[40:41], v24 offset:64
    ds_read_b64_tr_b16 v[42:43], v24 offset:576
    v_mfma_f32_16x16x32_bf16 v[212:215], v[48:51], v[104:107], v[212:215]
    ds_read_b64_tr_b16 v[44:45], v23 offset:128
    ds_read_b64_tr_b16 v[46:47], v23 offset:640
    s_add_u32 m0, s67, 27456
    v_mfma_f32_16x16x32_bf16 v[244:247], v[48:51], v[108:111], v[244:247]
    buffer_load_dwordx4 v18, s[4:7], s28 offen lds
    v_mfma_f32_16x16x32_bf16 v[184:187], v[52:55], v[100:103], v[184:187]
    ds_read_b64_tr_b16 v[48:49], v24 offset:128
    ds_read_b64_tr_b16 v[50:51], v24 offset:640
    s_add_u32 m0, s67, 28512
    v_mfma_f32_16x16x32_bf16 v[216:219], v[52:55], v[104:107], v[216:219]
    buffer_load_dwordx4 v19, s[4:7], s28 offen lds
    v_mfma_f32_16x16x32_bf16 v[248:251], v[52:55], v[108:111], v[248:251]
    v_mfma_f32_16x16x32_bf16 v[188:191], v[56:59], v[100:103], v[188:191]
    ds_read_b64_tr_b16 v[52:53], v23 offset:192
    ds_read_b64_tr_b16 v[54:55], v23 offset:704
    v_mfma_f32_16x16x32_bf16 v[220:223], v[56:59], v[104:107], v[220:223]
    s_add_u32 s28, s28, 65536
    v_mfma_f32_16x16x32_bf16 v[252:255], v[56:59], v[108:111], v[252:255]
    s_waitcnt lgkmcnt(10)
    v_mfma_f32_16x16x32_bf16 v[160:163], v[28:31], v[112:115], v[160:163]
    v_mfma_f32_16x16x32_bf16 v[192:195], v[28:31], v[116:119], v[192:195]
    buffer_load_dwordx4 v[88:91], v20, s[20:23], s27 offen sc1
    v_mfma_f32_16x16x32_bf16 v[224:227], v[28:31], v[120:123], v[224:227]
    v_mfma_f32_16x16x32_bf16 v[164:167], v[32:35], v[112:115], v[164:167]
    ds_read_b64_tr_b16 v[56:57], v24 offset:192
    ds_read_b64_tr_b16 v[58:59], v24 offset:704
    v_mfma_f32_16x16x32_bf16 v[196:199], v[32:35], v[116:119], v[196:199]
    buffer_load_dwordx4 v[92:95], v21, s[20:23], s27 offen sc1
    v_mfma_f32_16x16x32_bf16 v[228:231], v[32:35], v[120:123], v[228:231]
    s_waitcnt lgkmcnt(8)
    v_mfma_f32_16x16x32_bf16 v[168:171], v[36:39], v[112:115], v[168:171]
    v_mfma_f32_16x16x32_bf16 v[200:203], v[36:39], v[116:119], v[200:203]
    buffer_load_dwordx4 v[96:99], v22, s[20:23], s27 offen sc1
    v_mfma_f32_16x16x32_bf16 v[232:235], v[36:39], v[120:123], v[232:235]
    v_mfma_f32_16x16x32_bf16 v[172:175], v[40:43], v[112:115], v[172:175]
    v_mfma_f32_16x16x32_bf16 v[204:207], v[40:43], v[116:119], v[204:207]
    v_mfma_f32_16x16x32_bf16 v[236:239], v[40:43], v[120:123], v[236:239]
    s_waitcnt vmcnt(17) lgkmcnt(0)
    s_barrier
    v_mfma_f32_16x16x32_bf16 v[176:179], v[44:47], v[112:115], v[176:179]
    ds_read_b64_tr_b16 v[28:29], v23 offset:8448
    ds_read_b64_tr_b16 v[30:31], v23 offset:8960
    s_add_u32 m0, s67, 0
    v_mfma_f32_16x16x32_bf16 v[208:211], v[44:47], v[116:119], v[208:211]
    buffer_load_dwordx4 v16, s[4:7], s28 offen lds
    ds_read_b64_tr_b16 v[32:33], v24 offset:8448
    ds_read_b64_tr_b16 v[34:35], v24 offset:8960
    v_mfma_f32_16x16x32_bf16 v[240:243], v[44:47], v[120:123], v[240:243]
    ds_read_b64_tr_b16 v[36:37], v23 offset:8512
    ds_read_b64_tr_b16 v[38:39], v23 offset:9024
    s_add_u32 m0, s67, 1056
    v_mfma_f32_16x16x32_bf16 v[180:183], v[48:51], v[112:115], v[180:183]
    buffer_load_dwordx4 v17, s[4:7], s28 offen lds
    ds_read_b64_tr_b16 v[40:41], v24 offset:8512
    ds_read_b64_tr_b16 v[42:43], v24 offset:9024
    v_mfma_f32_16x16x32_bf16 v[212:215], v[48:51], v[116:119], v[212:215]
    ds_read_b64_tr_b16 v[44:45], v23 offset:8576
    ds_read_b64_tr_b16 v[46:47], v23 offset:9088
    s_add_u32 m0, s67, 2112
    v_mfma_f32_16x16x32_bf16 v[244:247], v[48:51], v[120:123], v[244:247]
    buffer_load_dwordx4 v18, s[4:7], s28 offen lds
    v_mfma_f32_16x16x32_bf16 v[184:187], v[52:55], v[112:115], v[184:187]
    ds_read_b64_tr_b16 v[48:49], v24 offset:8576
    ds_read_b64_tr_b16 v[50:51], v24 offset:9088
    s_add_u32 m0, s67, 3168
    v_mfma_f32_16x16x32_bf16 v[216:219], v[52:55], v[116:119], v[216:219]
    buffer_load_dwordx4 v19, s[4:7], s28 offen lds
    v_mfma_f32_16x16x32_bf16 v[248:251], v[52:55], v[120:123], v[248:251]
    v_mfma_f32_16x16x32_bf16 v[188:191], v[56:59], v[112:115], v[188:191]
    ds_read_b64_tr_b16 v[52:53], v23 offset:8640
    ds_read_b64_tr_b16 v[54:55], v23 offset:9152
    v_mfma_f32_16x16x32_bf16 v[220:223], v[56:59], v[116:119], v[220:223]
    s_add_u32 s28, s28, 65536
    v_mfma_f32_16x16x32_bf16 v[252:255], v[56:59], v[120:123], v[252:255]
    s_waitcnt lgkmcnt(10)
    v_mfma_f32_16x16x32_bf16 v[160:163], v[28:31], v[124:127], v[160:163]
    v_mfma_f32_16x16x32_bf16 v[192:195], v[28:31], v[128:131], v[192:195]
    buffer_load_dwordx4 v[100:103], v20, s[20:23], s27 offen offset:1024 sc1
    v_mfma_f32_16x16x32_bf16 v[224:227], v[28:31], v[132:135], v[224:227]
    v_mfma_f32_16x16x32_bf16 v[164:167], v[32:35], v[124:127], v[164:167]
    ds_read_b64_tr_b16 v[56:57], v24 offset:8640
    ds_read_b64_tr_b16 v[58:59], v24 offset:9152
    v_mfma_f32_16x16x32_bf16 v[196:199], v[32:35], v[128:131], v[196:199]
    buffer_load_dwordx4 v[104:107], v21, s[20:23], s27 offen offset:1024 sc1
    v_mfma_f32_16x16x32_bf16 v[228:231], v[32:35], v[132:135], v[228:231]
    s_waitcnt lgkmcnt(8)
    v_mfma_f32_16x16x32_bf16 v[168:171], v[36:39], v[124:127], v[168:171]
    v_mfma_f32_16x16x32_bf16 v[200:203], v[36:39], v[128:131], v[200:203]
    buffer_load_dwordx4 v[108:111], v22, s[20:23], s27 offen offset:1024 sc1
    v_mfma_f32_16x16x32_bf16 v[232:235], v[36:39], v[132:135], v[232:235]
    v_mfma_f32_16x16x32_bf16 v[172:175], v[40:43], v[124:127], v[172:175]
    s_add_u32 s27, s27, 2048
    v_mfma_f32_16x16x32_bf16 v[204:207], v[40:43], v[128:131], v[204:207]
    v_mfma_f32_16x16x32_bf16 v[236:239], v[40:43], v[132:135], v[236:239]
    s_waitcnt vmcnt(17) lgkmcnt(0)
    s_barrier
    v_mfma_f32_16x16x32_bf16 v[176:179], v[44:47], v[124:127], v[176:179]
    ds_read_b64_tr_b16 v[28:29], v23 offset:16896
    ds_read_b64_tr_b16 v[30:31], v23 offset:17408
    s_add_u32 m0, s67, 8448
    v_mfma_f32_16x16x32_bf16 v[208:211], v[44:47], v[128:131], v[208:211]
    buffer_load_dwordx4 v16, s[4:7], s28 offen lds
    ds_read_b64_tr_b16 v[32:33], v24 offset:16896
    ds_read_b64_tr_b16 v[34:35], v24 offset:17408
    v_mfma_f32_16x16x32_bf16 v[240:243], v[44:47], v[132:135], v[240:243]
    ds_read_b64_tr_b16 v[36:37], v23 offset:16960
    ds_read_b64_tr_b16 v[38:39], v23 offset:17472
    s_add_u32 m0, s67, 9504
    v_mfma_f32_16x16x32_bf16 v[180:183], v[48:51], v[124:127], v[180:183]
    buffer_load_dwordx4 v17, s[4:7], s28 offen lds
    ds_read_b64_tr_b16 v[40:41], v24 offset:16960
    ds_read_b64_tr_b16 v[42:43], v24 offset:17472
    v_mfma_f32_16x16x32_bf16 v[212:215], v[48:51], v[128:131], v[212:215]
    ds_read_b64_tr_b16 v[44:45], v23 offset:17024
    ds_read_b64_tr_b16 v[46:47], v23 offset:17536
    s_add_u32 m0, s67, 10560
    v_mfma_f32_16x16x32_bf16 v[244:247], v[48:51], v[132:135], v[244:247]
    buffer_load_dwordx4 v18, s[4:7], s28 offen lds
    v_mfma_f32_16x16x32_bf16 v[184:187], v[52:55], v[124:127], v[184:187]
    ds_read_b64_tr_b16 v[48:49], v24 offset:17024
    ds_read_b64_tr_b16 v[50:51], v24 offset:17536
    s_add_u32 m0, s67, 11616
    v_mfma_f32_16x16x32_bf16 v[216:219], v[52:55], v[128:131], v[216:219]
    buffer_load_dwordx4 v19, s[4:7], s28 offen lds
    v_mfma_f32_16x16x32_bf16 v[248:251], v[52:55], v[132:135], v[248:251]
    v_mfma_f32_16x16x32_bf16 v[188:191], v[56:59], v[124:127], v[188:191]
    ds_read_b64_tr_b16 v[52:53], v23 offset:17088
    ds_read_b64_tr_b16 v[54:55], v23 offset:17600
    v_mfma_f32_16x16x32_bf16 v[220:223], v[56:59], v[128:131], v[220:223]
    s_add_u32 s28, s28, 65536
    v_mfma_f32_16x16x32_bf16 v[252:255], v[56:59], v[132:135], v[252:255]
    s_waitcnt lgkmcnt(10)
    v_mfma_f32_16x16x32_bf16 v[160:163], v[28:31], v[136:139], v[160:163]
    v_mfma_f32_16x16x32_bf16 v[192:195], v[28:31], v[140:143], v[192:195]
    buffer_load_dwordx4 v[112:115], v20, s[20:23], s27 offen sc1
    v_mfma_f32_16x16x32_bf16 v[224:227], v[28:31], v[144:147], v[224:227]
    v_mfma_f32_16x16x32_bf16 v[164:167], v[32:35], v[136:139], v[164:167]
    ds_read_b64_tr_b16 v[56:57], v24 offset:17088
    ds_read_b64_tr_b16 v[58:59], v24 offset:17600
    v_mfma_f32_16x16x32_bf16 v[196:199], v[32:35], v[140:143], v[196:199]
    buffer_load_dwordx4 v[116:119], v21, s[20:23], s27 offen sc1
    v_mfma_f32_16x16x32_bf16 v[228:231], v[32:35], v[144:147], v[228:231]
    s_waitcnt lgkmcnt(8)
    v_mfma_f32_16x16x32_bf16 v[168:171], v[36:39], v[136:139], v[168:171]
    v_mfma_f32_16x16x32_bf16 v[200:203], v[36:39], v[140:143], v[200:203]
    buffer_load_dwordx4 v[120:123], v22, s[20:23], s27 offen sc1
    v_mfma_f32_16x16x32_bf16 v[232:235], v[36:39], v[144:147], v[232:235]
    v_mfma_f32_16x16x32_bf16 v[172:175], v[40:43], v[136:139], v[172:175]
    v_mfma_f32_16x16x32_bf16 v[204:207], v[40:43], v[140:143], v[204:207]
    v_mfma_f32_16x16x32_bf16 v[236:239], v[40:43], v[144:147], v[236:239]
    s_waitcnt vmcnt(17) lgkmcnt(0)
    s_barrier
    v_mfma_f32_16x16x32_bf16 v[176:179], v[44:47], v[136:139], v[176:179]
    ds_read_b64_tr_b16 v[28:29], v23 offset:25344
    ds_read_b64_tr_b16 v[30:31], v23 offset:25856
    s_add_u32 m0, s67, 16896
    v_mfma_f32_16x16x32_bf16 v[208:211], v[44:47], v[140:143], v[208:211]
    buffer_load_dwordx4 v16, s[4:7], s28 offen lds
    ds_read_b64_tr_b16 v[32:33], v24 offset:25344
    ds_read_b64_tr_b16 v[34:35], v24 offset:25856
    v_mfma_f32_16x16x32_bf16 v[240:243], v[44:47], v[144:147], v[240:243]
    ds_read_b64_tr_b16 v[36:37], v23 offset:25408
    ds_read_b64_tr_b16 v[38:39], v23 offset:25920
    s_add_u32 m0, s67, 17952
    v_mfma_f32_16x16x32_bf16 v[180:183], v[48:51], v[136:139], v[180:183]
    buffer_load_dwordx4 v17, s[4:7], s28 offen lds
    ds_read_b64_tr_b16 v[40:41], v24 offset:25408
    ds_read_b64_tr_b16 v[42:43], v24 offset:25920
    v_mfma_f32_16x16x32_bf16 v[212:215], v[48:51], v[140:143], v[212:215]
    ds_read_b64_tr_b16 v[44:45], v23 offset:25472
    ds_read_b64_tr_b16 v[46:47], v23 offset:25984
    s_add_u32 m0, s67, 19008
    v_mfma_f32_16x16x32_bf16 v[244:247], v[48:51], v[144:147], v[244:247]
    buffer_load_dwordx4 v18, s[4:7], s28 offen lds
    v_mfma_f32_16x16x32_bf16 v[184:187], v[52:55], v[136:139], v[184:187]
    ds_read_b64_tr_b16 v[48:49], v24 offset:25472
    ds_read_b64_tr_b16 v[50:51], v24 offset:25984
    s_add_u32 m0, s67, 20064
    v_mfma_f32_16x16x32_bf16 v[216:219], v[52:55], v[140:143], v[216:219]
    buffer_load_dwordx4 v19, s[4:7], s28 offen lds
    v_mfma_f32_16x16x32_bf16 v[248:251], v[52:55], v[144:147], v[248:251]
    v_mfma_f32_16x16x32_bf16 v[188:191], v[56:59], v[136:139], v[188:191]
    ds_read_b64_tr_b16 v[52:53], v23 offset:25536
    ds_read_b64_tr_b16 v[54:55], v23 offset:26048
    v_mfma_f32_16x16x32_bf16 v[220:223], v[56:59], v[140:143], v[220:223]
    s_add_u32 s28, s28, 65536
    v_mfma_f32_16x16x32_bf16 v[252:255], v[56:59], v[144:147], v[252:255]
    s_waitcnt lgkmcnt(10)
    v_mfma_f32_16x16x32_bf16 v[160:163], v[28:31], v[148:151], v[160:163]
    v_mfma_f32_16x16x32_bf16 v[192:195], v[28:31], v[152:155], v[192:195]
    buffer_load_dwordx4 v[124:127], v20, s[20:23], s27 offen offset:1024 sc1
    v_mfma_f32_16x16x32_bf16 v[224:227], v[28:31], v[156:159], v[224:227]
    v_mfma_f32_16x16x32_bf16 v[164:167], v[32:35], v[148:151], v[164:167]
    ds_read_b64_tr_b16 v[56:57], v24 offset:25536
    ds_read_b64_tr_b16 v[58:59], v24 offset:26048
    v_mfma_f32_16x16x32_bf16 v[196:199], v[32:35], v[152:155], v[196:199]
    buffer_load_dwordx4 v[128:131], v21, s[20:23], s27 offen offset:1024 sc1
    v_mfma_f32_16x16x32_bf16 v[228:231], v[32:35], v[156:159], v[228:231]
    s_waitcnt lgkmcnt(8)
    v_mfma_f32_16x16x32_bf16 v[168:171], v[36:39], v[148:151], v[168:171]
    v_mfma_f32_16x16x32_bf16 v[200:203], v[36:39], v[152:155], v[200:203]
    buffer_load_dwordx4 v[132:135], v22, s[20:23], s27 offen offset:1024 sc1
    v_mfma_f32_16x16x32_bf16 v[232:235], v[36:39], v[156:159], v[232:235]
    v_mfma_f32_16x16x32_bf16 v[172:175], v[40:43], v[148:151], v[172:175]
    s_add_u32 s27, s27, 2048
    v_mfma_f32_16x16x32_bf16 v[204:207], v[40:43], v[152:155], v[204:207]
    v_mfma_f32_16x16x32_bf16 v[236:239], v[40:43], v[156:159], v[236:239]
    s_waitcnt vmcnt(17) lgkmcnt(0)
    s_barrier
    v_mfma_f32_16x16x32_bf16 v[176:179], v[44:47], v[148:151], v[176:179]
    ds_read_b64_tr_b16 v[28:29], v23 offset:0
    ds_read_b64_tr_b16 v[30:31], v23 offset:512
    s_add_u32 m0, s67, 25344
    v_mfma_f32_16x16x32_bf16 v[208:211], v[44:47], v[152:155], v[208:211]
    buffer_load_dwordx4 v16, s[4:7], s28 offen lds
    ds_read_b64_tr_b16 v[32:33], v24 offset:0
    ds_read_b64_tr_b16 v[34:35], v24 offset:512
    v_mfma_f32_16x16x32_bf16 v[240:243], v[44:47], v[156:159], v[240:243]
    ds_read_b64_tr_b16 v[36:37], v23 offset:64
    ds_read_b64_tr_b16 v[38:39], v23 offset:576
    s_add_u32 m0, s67, 26400
    v_mfma_f32_16x16x32_bf16 v[180:183], v[48:51], v[148:151], v[180:183]
    buffer_load_dwordx4 v17, s[4:7], s28 offen lds
    ds_read_b64_tr_b16 v[40:41], v24 offset:64
    ds_read_b64_tr_b16 v[42:43], v24 offset:576
    v_mfma_f32_16x16x32_bf16 v[212:215], v[48:51], v[152:155], v[212:215]
    ds_read_b64_tr_b16 v[44:45], v23 offset:128
    ds_read_b64_tr_b16 v[46:47], v23 offset:640
    s_add_u32 m0, s67, 27456
    v_mfma_f32_16x16x32_bf16 v[244:247], v[48:51], v[156:159], v[244:247]
    buffer_load_dwordx4 v18, s[4:7], s28 offen lds
    v_mfma_f32_16x16x32_bf16 v[184:187], v[52:55], v[148:151], v[184:187]
    ds_read_b64_tr_b16 v[48:49], v24 offset:128
    ds_read_b64_tr_b16 v[50:51], v24 offset:640
    s_add_u32 m0, s67, 28512
    v_mfma_f32_16x16x32_bf16 v[216:219], v[52:55], v[152:155], v[216:219]
    buffer_load_dwordx4 v19, s[4:7], s28 offen lds
    v_mfma_f32_16x16x32_bf16 v[248:251], v[52:55], v[156:159], v[248:251]
    v_mfma_f32_16x16x32_bf16 v[188:191], v[56:59], v[148:151], v[188:191]
    ds_read_b64_tr_b16 v[52:53], v23 offset:192
    ds_read_b64_tr_b16 v[54:55], v23 offset:704
    v_mfma_f32_16x16x32_bf16 v[220:223], v[56:59], v[152:155], v[220:223]
    s_add_u32 s28, s28, 65536
    v_mfma_f32_16x16x32_bf16 v[252:255], v[56:59], v[156:159], v[252:255]
    s_sub_u32 s32, s32, 1
    s_cmp_lg_u32 s32, 0
    s_cbranch_scc1 L_oloop
    s_waitcnt lgkmcnt(10)
    v_mfma_f32_16x16x32_bf16 v[160:163], v[28:31], v[64:67], v[160:163]
    v_mfma_f32_16x16x32_bf16 v[192:195], v[28:31], v[68:71], v[192:195]
    buffer_load_dwordx4 v[136:139], v20, s[20:23], s27 offen sc1
    v_mfma_f32_16x16x32_bf16 v[224:227], v[28:31], v[72:75], v[224:227]
    v_mfma_f32_16x16x32_bf16 v[164:167], v[32:35], v[64:67], v[164:167]
    ds_read_b64_tr_b16 v[56:57], v24 offset:192
    ds_read_b64_tr_b16 v[58:59], v24 offset:704
    v_mfma_f32_16x16x32_bf16 v[196:199], v[32:35], v[68:71], v[196:199]
    buffer_load_dwordx4 v[140:143], v21, s[20:23], s27 offen sc1
    v_mfma_f32_16x16x32_bf16 v[228:231], v[32:35], v[72:75], v[228:231]
    s_waitcnt lgkmcnt(8)
    v_mfma_f32_16x16x32_bf16 v[168:171], v[36:39], v[64:67], v[168:171]
    v_mfma_f32_16x16x32_bf16 v[200:203], v[36:39], v[68:71], v[200:203]
    buffer_load_dwordx4 v[144:147], v22, s[20:23], s27 offen sc1
    v_mfma_f32_16x16x32_bf16 v[232:235], v[36:39], v[72:75], v[232:235]
    v_mfma_f32_16x16x32_bf16 v[172:175], v[40:43], v[64:67], v[172:175]
    v_mfma_f32_16x16x32_bf16 v[204:207], v[40:43], v[68:71], v[204:207]
    v_mfma_f32_16x16x32_bf16 v[236:239], v[40:43], v[72:75], v[236:239]
    s_waitcnt vmcnt(17) lgkmcnt(0)
    s_barrier
    v_mfma_f32_16x16x32_bf16 v[176:179], v[44:47], v[64:67], v[176:179]
    ds_read_b64_tr_b16 v[28:29], v23 offset:8448
    ds_read_b64_tr_b16 v[30:31], v23 offset:8960
    s_add_u32 m0, s67, 0
    v_mfma_f32_16x16x32_bf16 v[208:211], v[44:47], v[68:71], v[208:211]
    buffer_load_dwordx4 v16, s[4:7], s28 offen lds
    ds_read_b64_tr_b16 v[32:33], v24 offset:8448
    ds_read_b64_tr_b16 v[34:35], v24 offset:8960
    v_mfma_f32_16x16x32_bf16 v[240:243], v[44:47], v[72:75], v[240:243]
    ds_read_b64_tr_b16 v[36:37], v23 offset:8512
    ds_read_b64_tr_b16 v[38:39], v23 offset:9024
    s_add_u32 m0, s67, 1056
    v_mfma_f32_16x16x32_bf16 v[180:183], v[48:51], v[64:67], v[180:183]
    buffer_load_dwordx4 v17, s[4:7], s28 offen lds
    ds_read_b64_tr_b16 v[40:41], v24 offset:8512
    ds_read_b64_tr_b16 v[42:43], v24 offset:9024
    v_mfma_f32_16x16x32_bf16 v[212:215], v[48:51], v[68:71], v[212:215]
    ds_read_b64_tr_b16 v[44:45], v23 offset:8576
    ds_read_b64_tr_b16 v[46:47], v23 offset:9088
    s_add_u32 m0, s67, 2112
    v_mfma_f32_16x16x32_bf16 v[244:247], v[48:51], v[72:75], v[244:247]
    buffer_load_dwordx4 v18, s[4:7], s28 offen lds
    v_mfma_f32_16x16x32_bf16 v[184:187], v[52:55], v[64:67], v[184:187]
    ds_read_b64_tr_b16 v[48:49], v24 offset:8576
    ds_read_b64_tr_b16 v[50:51], v24 offset:9088
    s_add_u32 m0, s67, 3168
    v_mfma_f32_16x16x32_bf16 v[216:219], v[52:55], v[68:71], v[216:219]
    buffer_load_dwordx4 v19, s[4:7], s28 offen lds
    v_mfma_f32_16x16x32_bf16 v[248:251], v[52:55], v[72:75], v[248:251]
    v_mfma_f32_16x16x32_bf16 v[188:191], v[56:59], v[64:67], v[188:191]
    ds_read_b64_tr_b16 v[52:53], v23 offset:8640
    ds_read_b64_tr_b16 v[54:55], v23 offset:9152
    v_mfma_f32_16x16x32_bf16 v[220:223], v[56:59], v[68:71], v[220:223]
    s_add_u32 s28, s28, 65536
    v_mfma_f32_16x16x32_bf16 v[252:255], v[56:59], v[72:75], v[252:255]
    s_waitcnt lgkmcnt(10)
    v_mfma_f32_16x16x32_bf16 v[160:163], v[28:31], v[76:79], v[160:163]
    v_mfma_f32_16x16x32_bf16 v[192:195], v[28:31], v[80:83], v[192:195]
    buffer_load_dwordx4 v[148:151], v20, s[20:23], s27 offen offset:1024 sc1
    v_mfma_f32_16x16x32_bf16 v[224:227], v[28:31], v[84:87], v[224:227]
    v_mfma_f32_16x16x32_bf16 v[164:167], v[32:35], v[76:79], v[164:167]
    ds_read_b64_tr_b16 v[56:57], v24 offset:8640
    ds_read_b64_tr_b16 v[58:59], v24 offset:9152
    v_mfma_f32_16x16x32_bf16 v[196:199], v[32:35], v[80:83], v[196:199]
    buffer_load_dwordx4 v[152:155], v21, s[20:23], s27 offen offset:1024 sc1
    v_mfma_f32_16x16x32_bf16 v[228:231], v[32:35], v[84:87], v[228:231]
    s_waitcnt lgkmcnt(8)
    v_mfma_f32_16x16x32_bf16 v[168:171], v[36:39], v[76:79], v[168:171]
    v_mfma_f32_16x16x32_bf16 v[200:203], v[36:39], v[80:83], v[200:203]
    buffer_load_dwordx4 v[156:159], v22, s[20:23], s27 offen offset:1024 sc1
    v_mfma_f32_16x16x32_bf16 v[232:235], v[36:39], v[84:87], v[232:235]
    v_mfma_f32_16x16x32_bf16 v[172:175], v[40:43], v[76:79], v[172:175]
    s_add_u32 s27, s27, 2048
    v_mfma_f32_16x16x32_bf16 v[204:207], v[40:43], v[80:83], v[204:207]
    v_mfma_f32_16x16x32_bf16 v[236:239], v[40:43], v[84:87], v[236:239]
    s_waitcnt vmcnt(17) lgkmcnt(0)
    s_barrier
    v_mfma_f32_16x16x32_bf16 v[176:179], v[44:47], v[76:79], v[176:179]
    ds_read_b64_tr_b16 v[28:29], v23 offset:16896
    ds_read_b64_tr_b16 v[30:31], v23 offset:17408
    s_add_u32 m0, s67, 8448
    v_mfma_f32_16x16x32_bf16 v[208:211], v[44:47], v[80:83], v[208:211]
    buffer_load_dwordx4 v16, s[4:7], s28 offen lds
    ds_read_b64_tr_b16 v[32:33], v24 offset:16896
    ds_read_b64_tr_b16 v[34:35], v24 offset:17408
    v_mfma_f32_16x16x32_bf16 v[240:243], v[44:47], v[84:87], v[240:243]
    ds_read_b64_tr_b16 v[36:37], v23 offset:16960
    ds_read_b64_tr_b16 v[38:39], v23 offset:17472
    s_add_u32 m0, s67, 9504
    v_mfma_f32_16x16x32_bf16 v[180:183], v[48:51], v[76:79], v[180:183]
    buffer_load_dwordx4 v17, s[4:7], s28 offen lds
    ds_read_b64_tr_b16 v[40:41], v24 offset:16960
    ds_read_b64_tr_b16 v[42:43], v24 offset:17472
    v_mfma_f32_16x16x32_bf16 v[212:215], v[48:51], v[80:83], v[212:215]
    ds_read_b64_tr_b16 v[44:45], v23 offset:17024
    ds_read_b64_tr_b16 v[46:47], v23 offset:17536
    s_add_u32 m0, s67, 10560
    v_mfma_f32_16x16x32_bf16 v[244:247], v[48:51], v[84:87], v[244:247]
    buffer_load_dwordx4 v18, s[4:7], s28 offen lds
    v_mfma_f32_16x16x32_bf16 v[184:187], v[52:55], v[76:79], v[184:187]
    ds_read_b64_tr_b16 v[48:49], v24 offset:17024
    ds_read_b64_tr_b16 v[50:51], v24 offset:17536
    s_add_u32 m0, s67, 11616
    v_mfma_f32_16x16x32_bf16 v[216:219], v[52:55], v[80:83], v[216:219]
    buffer_load_dwordx4 v19, s[4:7], s28 offen lds
    v_mfma_f32_16x16x32_bf16 v[248:251], v[52:55], v[84:87], v[248:251]
    v_mfma_f32_16x16x32_bf16 v[188:191], v[56:59], v[76:79], v[188:191]
    ds_read_b64_tr_b16 v[52:53], v23 offset:17088
    ds_read_b64_tr_b16 v[54:55], v23 offset:17600
    v_mfma_f32_16x16x32_bf16 v[220:223], v[56:59], v[80:83], v[220:223]
    s_add_u32 s28, s28, 65536
    v_mfma_f32_16x16x32_bf16 v[252:255], v[56:59], v[84:87], v[252:255]
    s_waitcnt lgkmcnt(10)
    v_mfma_f32_16x16x32_bf16 v[160:163], v[28:31], v[88:91], v[160:163]
    v_mfma_f32_16x16x32_bf16 v[192:195], v[28:31], v[92:95], v[192:195]
    v_mfma_f32_16x16x32_bf16 v[224:227], v[28:31], v[96:99], v[224:227]
    v_mfma_f32_16x16x32_bf16 v[164:167], v[32:35], v[88:91], v[164:167]
    ds_read_b64_tr_b16 v[56:57], v24 offset:17088
    ds_read_b64_tr_b16 v[58:59], v24 offset:17600
    v_mfma_f32_16x16x32_bf16 v[196:199], v[32:35], v[92:95], v[196:199]
    v_mfma_f32_16x16x32_bf16 v[228:231], v[32:35], v[96:99], v[228:231]
    s_waitcnt lgkmcnt(8)
    v_mfma_f32_16x16x32_bf16 v[168:171], v[36:39], v[88:91], v[168:171]
    v_mfma_f32_16x16x32_bf16 v[200:203], v[36:39], v[92:95], v[200:203]
    v_mfma_f32_16x16x32_bf16 v[232:235], v[36:39], v[96:99], v[232:235]
    v_mfma_f32_16x16x32_bf16 v[172:175], v[40:43], v[88:91], v[172:175]
    v_mfma_f32_16x16x32_bf16 v[204:207], v[40:43], v[92:95], v[204:207]
    v_mfma_f32_16x16x32_bf16 v[236:239], v[40:43], v[96:99], v[236:239]
    s_waitcnt vmcnt(14) lgkmcnt(0)
    s_barrier
    v_mfma_f32_16x16x32_bf16 v[176:179], v[44:47], v[88:91], v[176:179]
    ds_read_b64_tr_b16 v[28:29], v23 offset:25344
    ds_read_b64_tr_b16 v[30:31], v23 offset:25856
    s_add_u32 m0, s67, 16896
    v_mfma_f32_16x16x32_bf16 v[208:211], v[44:47], v[92:95], v[208:211]
    buffer_load_dwordx4 v16, s[4:7], s28 offen lds
    ds_read_b64_tr_b16 v[32:33], v24 offset:25344
    ds_read_b64_tr_b16 v[34:35], v24 offset:25856
    v_mfma_f32_16x16x32_bf16 v[240:243], v[44:47], v[96:99], v[240:243]
    ds_read_b64_tr_b16 v[36:37], v23 offset:25408
    ds_read_b64_tr_b16 v[38:39], v23 offset:25920
    s_add_u32 m0, s67, 17952
    v_mfma_f32_16x16x32_bf16 v[180:183], v[48:51], v[88:91], v[180:183]
    buffer_load_dwordx4 v17, s[4:7], s28 offen lds
    ds_read_b64_tr_b16 v[40:41], v24 offset:25408
    ds_read_b64_tr_b16 v[42:43], v24 offset:25920
    v_mfma_f32_16x16x32_bf16 v[212:215], v[48:51], v[92:95], v[212:215]
    ds_read_b64_tr_b16 v[44:45], v23 offset:25472
    ds_read_b64_tr_b16 v[46:47], v23 offset:25984
    s_add_u32 m0, s67, 19008
    v_mfma_f32_16x16x32_bf16 v[244:247], v[48:51], v[96:99], v[244:247]
    buffer_load_dwordx4 v18, s[4:7], s28 offen lds
    v_mfma_f32_16x16x32_bf16 v[184:187], v[52:55], v[88:91], v[184:187]
    ds_read_b64_tr_b16 v[48:49], v24 offset:25472
    ds_read_b64_tr_b16 v[50:51], v24 offset:25984
    s_add_u32 m0, s67, 20064
    v_mfma_f32_16x16x32_bf16 v[216:219], v[52:55], v[92:95], v[216:219]
    buffer_load_dwordx4 v19, s[4:7], s28 offen lds
    v_mfma_f32_16x16x32_bf16 v[248:251], v[52:55], v[96:99], v[248:251]
    v_mfma_f32_16x16x32_bf16 v[188:191], v[56:59], v[88:91], v[188:191]
    ds_read_b64_tr_b16 v[52:53], v23 offset:25536
    ds_read_b64_tr_b16 v[54:55], v23 offset:26048
    v_mfma_f32_16x16x32_bf16 v[220:223], v[56:59], v[92:95], v[220:223]
    s_add_u32 s28, s28, 65536
    v_mfma_f32_16x16x32_bf16 v[252:255], v[56:59], v[96:99], v[252:255]
    s_waitcnt lgkmcnt(10)
    v_mfma_f32_16x16x32_bf16 v[160:163], v[28:31], v[100:103], v[160:163]
    v_mfma_f32_16x16x32_bf16 v[192:195], v[28:31], v[104:107], v[192:195]
    v_mfma_f32_16x16x32_bf16 v[224:227], v[28:31], v[108:111], v[224:227]
    v_mfma_f32_16x16x32_bf16 v[164:167], v[32:35], v[100:103], v[164:167]
    ds_read_b64_tr_b16 v[56:57], v24 offset:25536
    ds_read_b64_tr_b16 v[58:59], v24 offset:26048
    v_mfma_f32_16x16x32_bf16 v[196:199], v[32:35], v[104:107], v[196:199]
    v_mfma_f32_16x16x32_bf16 v[228:231], v[32:35], v[108:111], v[228:231]
    s_waitcnt lgkmcnt(8)
    v_mfma_f32_16x16x32_bf16 v[168:171], v[36:39], v[100:103], v[168:171]
    v_mfma_f32_16x16x32_bf16 v[200:203], v[36:39], v[104:107], v[200:203]
    v_mfma_f32_16x16x32_bf16 v[232:235], v[36:39], v[108:111], v[232:235]
    v_mfma_f32_16x16x32_bf16 v[172:175], v[40:43], v[100:103], v[172:175]
    v_mfma_f32_16x16x32_bf16 v[204:207], v[40:43], v[104:107], v[204:207]
    v_mfma_f32_16x16x32_bf16 v[236:239], v[40:43], v[108:111], v[236:239]
    s_waitcnt vmcnt(11) lgkmcnt(0)
    s_barrier
    v_mfma_f32_16x16x32_bf16 v[176:179], v[44:47], v[100:103], v[176:179]
    ds_read_b64_tr_b16 v[28:29], v23 offset:0
    ds_read_b64_tr_b16 v[30:31], v23 offset:512
    s_add_u32 m0, s67, 25344
    v_mfma_f32_16x16x32_bf16 v[208:211], v[44:47], v[104:107], v[208:211]
    buffer_load_dwordx4 v16, s[4:7], s28 offen lds
    ds_read_b64_tr_b16 v[32:33], v24 offset:0
    ds_read_b64_tr_b16 v[34:35], v24 offset:512
    v_mfma_f32_16x16x32_bf16 v[240:243], v[44:47], v[108:111], v[240:243]
    ds_read_b64_tr_b16 v[36:37], v23 offset:64
    ds_read_b64_tr_b16 v[38:39], v23 offset:576
    s_add_u32 m0, s67, 26400
    v_mfma_f32_16x16x32_bf16 v[180:183], v[48:51], v[100:103], v[180:183]
    buffer_load_dwordx4 v17, s[4:7], s28 offen lds
    ds_read_b64_tr_b16 v[40:41], v24 offset:64
    ds_read_b64_tr_b16 v[42:43], v24 offset:576
    v_mfma_f32_16x16x32_bf16 v[212:215], v[48:51], v[104:107], v[212:215]
    ds_read_b64_tr_b16 v[44:45], v23 offset:128
    ds_read_b64_tr_b16 v[46:47], v23 offset:640
    s_add_u32 m0, s67, 27456
    v_mfma_f32_16x16x32_bf16 v[244:247], v[48:51], v[108:111], v[244:247]
    buffer_load_dwordx4 v18, s[4:7], s28 offen lds
    v_mfma_f32_16x16x32_bf16 v[184:187], v[52:55], v[100:103], v[184:187]
    ds_read_b64_tr_b16 v[48:49], v24 offset:128
    ds_read_b64_tr_b16 v[50:51], v24 offset:640
    s_add_u32 m0, s67, 28512
    v_mfma_f32_16x16x32_bf16 v[216:219], v[52:55], v[104:107], v[216:219]
    buffer_load_dwordx4 v19, s[4:7], s28 offen lds
    v_mfma_f32_16x16x32_bf16 v[248:251], v[52:55], v[108:111], v[248:251]
    v_mfma_f32_16x16x32_bf16 v[188:191], v[56:59], v[100:103], v[188:191]
    ds_read_b64_tr_b16 v[52:53], v23 offset:192
    ds_read_b64_tr_b16 v[54:55], v23 offset:704
    v_mfma_f32_16x16x32_bf16 v[220:223], v[56:59], v[104:107], v[220:223]
    s_add_u32 s28, s28, 2162688
    v_mfma_f32_16x16x32_bf16 v[252:255], v[56:59], v[108:111], v[252:255]
    s_waitcnt lgkmcnt(10)
    v_mfma_f32_16x16x32_bf16 v[160:163], v[28:31], v[112:115], v[160:163]
    v_mfma_f32_16x16x32_bf16 v[192:195], v[28:31], v[116:119], v[192:195]
    v_mfma_f32_16x16x32_bf16 v[224:227], v[28:31], v[120:123], v[224:227]
    v_mfma_f32_16x16x32_bf16 v[164:167], v[32:35], v[112:115], v[164:167]
    ds_read_b64_tr_b16 v[56:57], v24 offset:192
    ds_read_b64_tr_b16 v[58:59], v24 offset:704
    v_mfma_f32_16x16x32_bf16 v[196:199], v[32:35], v[116:119], v[196:199]
    v_mfma_f32_16x16x32_bf16 v[228:231], v[32:35], v[120:123], v[228:231]
    s_waitcnt lgkmcnt(8)
    v_mfma_f32_16x16x32_bf16 v[168:171], v[36:39], v[112:115], v[168:171]
    v_mfma_f32_16x16x32_bf16 v[200:203], v[36:39], v[116:119], v[200:203]
    v_mfma_f32_16x16x32_bf16 v[232:235], v[36:39], v[120:123], v[232:235]
    v_mfma_f32_16x16x32_bf16 v[172:175], v[40:43], v[112:115], v[172:175]
    v_mfma_f32_16x16x32_bf16 v[204:207], v[40:43], v[116:119], v[204:207]
    v_mfma_f32_16x16x32_bf16 v[236:239], v[40:43], v[120:123], v[236:239]
    s_waitcnt vmcnt(8) lgkmcnt(0)
    s_barrier
    v_mfma_f32_16x16x32_bf16 v[176:179], v[44:47], v[112:115], v[176:179]
    ds_read_b64_tr_b16 v[28:29], v23 offset:8448
    ds_read_b64_tr_b16 v[30:31], v23 offset:8960
    s_add_u32 m0, s67, 0
    v_mfma_f32_16x16x32_bf16 v[208:211], v[44:47], v[116:119], v[208:211]
    buffer_load_dwordx4 v16, s[4:7], s28 offen lds
    ds_read_b64_tr_b16 v[32:33], v24 offset:8448
    ds_read_b64_tr_b16 v[34:35], v24 offset:8960
    v_mfma_f32_16x16x32_bf16 v[240:243], v[44:47], v[120:123], v[240:243]
    ds_read_b64_tr_b16 v[36:37], v23 offset:8512
    ds_read_b64_tr_b16 v[38:39], v23 offset:9024
    s_add_u32 m0, s67, 1056
    v_mfma_f32_16x16x32_bf16 v[180:183], v[48:51], v[112:115], v[180:183]
    buffer_load_dwordx4 v17, s[4:7], s28 offen lds
    ds_read_b64_tr_b16 v[40:41], v24 offset:8512
    ds_read_b64_tr_b16 v[42:43], v24 offset:9024
    v_mfma_f32_16x16x32_bf16 v[212:215], v[48:51], v[116:119], v[212:215]
    ds_read_b64_tr_b16 v[44:45], v23 offset:8576
    ds_read_b64_tr_b16 v[46:47], v23 offset:9088
    s_add_u32 m0, s67, 2112
    v_mfma_f32_16x16x32_bf16 v[244:247], v[48:51], v[120:123], v[244:247]
    buffer_load_dwordx4 v18, s[4:7], s28 offen lds
    v_mfma_f32_16x16x32_bf16 v[184:187], v[52:55], v[112:115], v[184:187]
    ds_read_b64_tr_b16 v[48:49], v24 offset:8576
    ds_read_b64_tr_b16 v[50:51], v24 offset:9088
    s_add_u32 m0, s67, 3168
    v_mfma_f32_16x16x32_bf16 v[216:219], v[52:55], v[116:119], v[216:219]
    buffer_load_dwordx4 v19, s[4:7], s28 offen lds
    v_mfma_f32_16x16x32_bf16 v[248:251], v[52:55], v[120:123], v[248:251]
    v_mfma_f32_16x16x32_bf16 v[188:191], v[56:59], v[112:115], v[188:191]
    ds_read_b64_tr_b16 v[52:53], v23 offset:8640
    ds_read_b64_tr_b16 v[54:55], v23 offset:9152
    v_mfma_f32_16x16x32_bf16 v[220:223], v[56:59], v[116:119], v[220:223]
    s_add_u32 s28, s28, 65536
    v_mfma_f32_16x16x32_bf16 v[252:255], v[56:59], v[120:123], v[252:255]
    s_waitcnt lgkmcnt(10)
    v_mfma_f32_16x16x32_bf16 v[160:163], v[28:31], v[124:127], v[160:163]
    v_mfma_f32_16x16x32_bf16 v[192:195], v[28:31], v[128:131], v[192:195]
    v_mfma_f32_16x16x32_bf16 v[224:227], v[28:31], v[132:135], v[224:227]
    v_mfma_f32_16x16x32_bf16 v[164:167], v[32:35], v[124:127], v[164:167]
    ds_read_b64_tr_b16 v[56:57], v24 offset:8640
    ds_read_b64_tr_b16 v[58:59], v24 offset:9152
    v_mfma_f32_16x16x32_bf16 v[196:199], v[32:35], v[128:131], v[196:199]
    v_mfma_f32_16x16x32_bf16 v[228:231], v[32:35], v[132:135], v[228:231]
    s_waitcnt lgkmcnt(8)
    v_mfma_f32_16x16x32_bf16 v[168:171], v[36:39], v[124:127], v[168:171]
    v_mfma_f32_16x16x32_bf16 v[200:203], v[36:39], v[128:131], v[200:203]
    v_mfma_f32_16x16x32_bf16 v[232:235], v[36:39], v[132:135], v[232:235]
    v_mfma_f32_16x16x32_bf16 v[172:175], v[40:43], v[124:127], v[172:175]
    v_mfma_f32_16x16x32_bf16 v[204:207], v[40:43], v[128:131], v[204:207]
    v_mfma_f32_16x16x32_bf16 v[236:239], v[40:43], v[132:135], v[236:239]
    s_waitcnt vmcnt(8) lgkmcnt(0)
    s_barrier
    v_mfma_f32_16x16x32_bf16 v[176:179], v[44:47], v[124:127], v[176:179]
    ds_read_b64_tr_b16 v[28:29], v23 offset:16896
    ds_read_b64_tr_b16 v[30:31], v23 offset:17408
    s_add_u32 m0, s67, 8448
    v_mfma_f32_16x16x32_bf16 v[208:211], v[44:47], v[128:131], v[208:211]
    buffer_load_dwordx4 v16, s[4:7], s28 offen lds
    ds_read_b64_tr_b16 v[32:33], v24 offset:16896
    ds_read_b64_tr_b16 v[34:35], v24 offset:17408
    v_mfma_f32_16x16x32_bf16 v[240:243], v[44:47], v[132:135], v[240:243]
    ds_read_b64_tr_b16 v[36:37], v23 offset:16960
    ds_read_b64_tr_b16 v[38:39], v23 offset:17472
    s_add_u32 m0, s67, 9504
    v_mfma_f32_16x16x32_bf16 v[180:183], v[48:51], v[124:127], v[180:183]
    buffer_load_dwordx4 v17, s[4:7], s28 offen lds
    ds_read_b64_tr_b16 v[40:41], v24 offset:16960
    ds_read_b64_tr_b16 v[42:43], v24 offset:17472
    v_mfma_f32_16x16x32_bf16 v[212:215], v[48:51], v[128:131], v[212:215]
    ds_read_b64_tr_b16 v[44:45], v23 offset:17024
    ds_read_b64_tr_b16 v[46:47], v23 offset:17536
    s_add_u32 m0, s67, 10560
    v_mfma_f32_16x16x32_bf16 v[244:247], v[48:51], v[132:135], v[244:247]
    buffer_load_dwordx4 v18, s[4:7], s28 offen lds
    v_mfma_f32_16x16x32_bf16 v[184:187], v[52:55], v[124:127], v[184:187]
    ds_read_b64_tr_b16 v[48:49], v24 offset:17024
    ds_read_b64_tr_b16 v[50:51], v24 offset:17536
    s_add_u32 m0, s67, 11616
    v_mfma_f32_16x16x32_bf16 v[216:219], v[52:55], v[128:131], v[216:219]
    buffer_load_dwordx4 v19, s[4:7], s28 offen lds
    v_mfma_f32_16x16x32_bf16 v[248:251], v[52:55], v[132:135], v[248:251]
    v_mfma_f32_16x16x32_bf16 v[188:191], v[56:59], v[124:127], v[188:191]
    ds_read_b64_tr_b16 v[52:53], v23 offset:17088
    ds_read_b64_tr_b16 v[54:55], v23 offset:17600
    v_mfma_f32_16x16x32_bf16 v[220:223], v[56:59], v[128:131], v[220:223]
    s_add_u32 s28, s28, 65536
    v_mfma_f32_16x16x32_bf16 v[252:255], v[56:59], v[132:135], v[252:255]
    s_waitcnt lgkmcnt(10)
    v_mfma_f32_16x16x32_bf16 v[160:163], v[28:31], v[136:139], v[160:163]
    v_mfma_f32_16x16x32_bf16 v[192:195], v[28:31], v[140:143], v[192:195]
    v_mfma_f32_16x16x32_bf16 v[224:227], v[28:31], v[144:147], v[224:227]
    v_mfma_f32_16x16x32_bf16 v[164:167], v[32:35], v[136:139], v[164:167]
    ds_read_b64_tr_b16 v[56:57], v24 offset:17088
    ds_read_b64_tr_b16 v[58:59], v24 offset:17600
    v_mfma_f32_16x16x32_bf16 v[196:199], v[32:35], v[140:143], v[196:199]
    v_mfma_f32_16x16x32_bf16 v[228:231], v[32:35], v[144:147], v[228:231]
    s_waitcnt lgkmcnt(8)
    v_mfma_f32_16x16x32_bf16 v[168:171], v[36:39], v[136:139], v[168:171]
    v_mfma_f32_16x16x32_bf16 v[200:203], v[36:39], v[140:143], v[200:203]
    v_mfma_f32_16x16x32_bf16 v[232:235], v[36:39], v[144:147], v[232:235]
    v_mfma_f32_16x16x32_bf16 v[172:175], v[40:43], v[136:139], v[172:175]
    v_mfma_f32_16x16x32_bf16 v[204:207], v[40:43], v[140:143], v[204:207]
    v_mfma_f32_16x16x32_bf16 v[236:239], v[40:43], v[144:147], v[236:239]
    s_waitcnt vmcnt(8) lgkmcnt(0)
    s_barrier
    v_mfma_f32_16x16x32_bf16 v[176:179], v[44:47], v[136:139], v[176:179]
    ds_read_b64_tr_b16 v[28:29], v23 offset:25344
    ds_read_b64_tr_b16 v[30:31], v23 offset:25856
    s_add_u32 m0, s67, 16896
    v_mfma_f32_16x16x32_bf16 v[208:211], v[44:47], v[140:143], v[208:211]
    buffer_load_dwordx4 v16, s[4:7], s28 offen lds
    ds_read_b64_tr_b16 v[32:33], v24 offset:25344
    ds_read_b64_tr_b16 v[34:35], v24 offset:25856
    v_mfma_f32_16x16x32_bf16 v[240:243], v[44:47], v[144:147], v[240:243]
    ds_read_b64_tr_b16 v[36:37], v23 offset:25408
    ds_read_b64_tr_b16 v[38:39], v23 offset:25920
    s_add_u32 m0, s67, 17952
    v_mfma_f32_16x16x32_bf16 v[180:183], v[48:51], v[136:139], v[180:183]
    buffer_load_dwordx4 v17, s[4:7], s28 offen lds
    ds_read_b64_tr_b16 v[40:41], v24 offset:25408
    ds_read_b64_tr_b16 v[42:43], v24 offset:25920
    v_mfma_f32_16x16x32_bf16 v[212:215], v[48:51], v[140:143], v[212:215]
    ds_read_b64_tr_b16 v[44:45], v23 offset:25472
    ds_read_b64_tr_b16 v[46:47], v23 offset:25984
    s_add_u32 m0, s67, 19008
    v_mfma_f32_16x16x32_bf16 v[244:247], v[48:51], v[144:147], v[244:247]
    buffer_load_dwordx4 v18, s[4:7], s28 offen lds
    v_mfma_f32_16x16x32_bf16 v[184:187], v[52:55], v[136:139], v[184:187]
    ds_read_b64_tr_b16 v[48:49], v24 offset:25472
    ds_read_b64_tr_b16 v[50:51], v24 offset:25984
    s_add_u32 m0, s67, 20064
    v_mfma_f32_16x16x32_bf16 v[216:219], v[52:55], v[140:143], v[216:219]
    buffer_load_dwordx4 v19, s[4:7], s28 offen lds
    v_mfma_f32_16x16x32_bf16 v[248:251], v[52:55], v[144:147], v[248:251]
    v_mfma_f32_16x16x32_bf16 v[188:191], v[56:59], v[136:139], v[188:191]
    ds_read_b64_tr_b16 v[52:53], v23 offset:25536
    ds_read_b64_tr_b16 v[54:55], v23 offset:26048
    v_mfma_f32_16x16x32_bf16 v[220:223], v[56:59], v[140:143], v[220:223]
    s_add_u32 s28, s28, 65536
    v_mfma_f32_16x16x32_bf16 v[252:255], v[56:59], v[144:147], v[252:255]
    s_waitcnt lgkmcnt(10)
    v_mfma_f32_16x16x32_bf16 v[160:163], v[28:31], v[148:151], v[160:163]
    v_mfma_f32_16x16x32_bf16 v[192:195], v[28:31], v[152:155], v[192:195]
    v_mfma_f32_16x16x32_bf16 v[224:227], v[28:31], v[156:159], v[224:227]
    v_mfma_f32_16x16x32_bf16 v[164:167], v[32:35], v[148:151], v[164:167]
    ds_read_b64_tr_b16 v[56:57], v24 offset:25536
    ds_read_b64_tr_b16 v[58:59], v24 offset:26048
    v_mfma_f32_16x16x32_bf16 v[196:199], v[32:35], v[152:155], v[196:199]
    v_mfma_f32_16x16x32_bf16 v[228:231], v[32:35], v[156:159], v[228:231]
    s_waitcnt lgkmcnt(8)
    v_mfma_f32_16x16x32_bf16 v[168:171], v[36:39], v[148:151], v[168:171]
    v_mfma_f32_16x16x32_bf16 v[200:203], v[36:39], v[152:155], v[200:203]
    v_mfma_f32_16x16x32_bf16 v[232:235], v[36:39], v[156:159], v[232:235]
    v_mfma_f32_16x16x32_bf16 v[172:175], v[40:43], v[148:151], v[172:175]
    v_mfma_f32_16x16x32_bf16 v[204:207], v[40:43], v[152:155], v[204:207]
    v_mfma_f32_16x16x32_bf16 v[236:239], v[40:43], v[156:159], v[236:239]
    s_waitcnt vmcnt(8) lgkmcnt(0)
    s_barrier
    v_mfma_f32_16x16x32_bf16 v[176:179], v[44:47], v[148:151], v[176:179]
    ds_read_b64_tr_b16 v[28:29], v23 offset:0
    ds_read_b64_tr_b16 v[30:31], v23 offset:512
    s_add_u32 m0, s67, 25344
    v_mfma_f32_16x16x32_bf16 v[208:211], v[44:47], v[152:155], v[208:211]
    buffer_load_dwordx4 v16, s[4:7], s28 offen lds
    ds_read_b64_tr_b16 v[32:33], v24 offset:0
    ds_read_b64_tr_b16 v[34:35], v24 offset:512
    v_mfma_f32_16x16x32_bf16 v[240:243], v[44:47], v[156:159], v[240:243]
    ds_read_b64_tr_b16 v[36:37], v23 offset:64
    ds_read_b64_tr_b16 v[38:39], v23 offset:576
    s_add_u32 m0, s67, 26400
    v_mfma_f32_16x16x32_bf16 v[180:183], v[48:51], v[148:151], v[180:183]
    buffer_load_dwordx4 v17, s[4:7], s28 offen lds
    ds_read_b64_tr_b16 v[40:41], v24 offset:64
    ds_read_b64_tr_b16 v[42:43], v24 offset:576
    v_mfma_f32_16x16x32_bf16 v[212:215], v[48:51], v[152:155], v[212:215]
    ds_read_b64_tr_b16 v[44:45], v23 offset:128
    ds_read_b64_tr_b16 v[46:47], v23 offset:640
    s_add_u32 m0, s67, 27456
    v_mfma_f32_16x16x32_bf16 v[244:247], v[48:51], v[156:159], v[244:247]
    buffer_load_dwordx4 v18, s[4:7], s28 offen lds
    v_mfma_f32_16x16x32_bf16 v[184:187], v[52:55], v[148:151], v[184:187]
    ds_read_b64_tr_b16 v[48:49], v24 offset:128
    ds_read_b64_tr_b16 v[50:51], v24 offset:640
    s_add_u32 m0, s67, 28512
    v_mfma_f32_16x16x32_bf16 v[216:219], v[52:55], v[152:155], v[216:219]
    buffer_load_dwordx4 v19, s[4:7], s28 offen lds
    v_mfma_f32_16x16x32_bf16 v[248:251], v[52:55], v[156:159], v[248:251]
    v_mfma_f32_16x16x32_bf16 v[188:191], v[56:59], v[148:151], v[188:191]
    ds_read_b64_tr_b16 v[52:53], v23 offset:192
    ds_read_b64_tr_b16 v[54:55], v23 offset:704
    v_mfma_f32_16x16x32_bf16 v[220:223], v[56:59], v[152:155], v[220:223]
    s_add_u32 s28, s28, 65536
    v_mfma_f32_16x16x32_bf16 v[252:255], v[56:59], v[156:159], v[252:255]
    s_cmp_lg_u32 s29, 0
    s_cbranch_scc1 L_bfin
    s_add_u32 s27, s27, 0x8000
    s_mov_b32 s29, 1
    s_branch L_phase
L_bfin:
    s_waitcnt vmcnt(0) lgkmcnt(0)
    s_nop 7
    s_nop 1
    s_barrier
    s_mul_i32 s37, s24, 12288
    v_lshlrev_b32 v8, 4, v13
    v_add_u32 v7, s37, v8
    s_xor_b32 s38, s24, 2
    s_mul_i32 s38, s38, 12288
    v_add_u32 v8, s38, v8
    v_and_b32 v14, 15, v13
    v_lshlrev_b32 v14, 11, v14
    v_lshrrev_b32 v2, 4, v13
    v_lshl_add_u32 v14, v2, 4, v14
    s_mul_i32 s37, s44, 96
    s_mul_i32 s38, s33, 48
    s_add_u32 s37, s37, s38
    s_lshl_b32 s37, s37, 11
    s_lshl_b32 s38, s45, 8
    s_add_u32 s37, s37, s38
    s_cmp_lg_u32 s34, 0
    s_cbranch_scc1 L_bepi1
    ds_write_b128 v7, v[176:179] offset:0
    ds_write_b128 v7, v[180:183] offset:1024
    ds_write_b128 v7, v[184:187] offset:2048
    ds_write_b128 v7, v[188:191] offset:3072
    ds_write_b128 v7, v[208:211] offset:4096
    ds_write_b128 v7, v[212:215] offset:5120
    ds_write_b128 v7, v[216:219] offset:6144
    ds_write_b128 v7, v[220:223] offset:7168
    ds_write_b128 v7, v[240:243] offset:8192
    ds_write_b128 v7, v[244:247] offset:9216
    ds_write_b128 v7, v[248:251] offset:10240
    ds_write_b128 v7, v[252:255] offset:11264
    s_waitcnt lgkmcnt(0)
    s_barrier
    ds_read_b128 v[64:67], v8 offset:0
    ds_read_b128 v[68:71], v8 offset:1024
    ds_read_b128 v[72:75], v8 offset:2048
    ds_read_b128 v[76:79], v8 offset:3072
    ds_read_b128 v[80:83], v8 offset:4096
    ds_read_b128 v[84:87], v8 offset:5120
    ds_read_b128 v[88:91], v8 offset:6144
    ds_read_b128 v[92:95], v8 offset:7168
    ds_read_b128 v[96:99], v8 offset:8192
    ds_read_b128 v[100:103], v8 offset:9216
    ds_read_b128 v[104:107], v8 offset:10240
    ds_read_b128 v[108:111], v8 offset:11264
    s_waitcnt lgkmcnt(10)
    v_add_f32 v160, v160, v64
    v_add_f32 v161, v161, v65
    v_add_f32 v162, v162, v66
    v_add_f32 v163, v163, v67
    v_add_f32 v164, v164, v68
    v_add_f32 v165, v165, v69
    v_add_f32 v166, v166, v70
    v_add_f32 v167, v167, v71
    v_cvt_pk_bf16_f32 v112, v160, v161
    v_cvt_pk_bf16_f32 v113, v162, v163
    v_cvt_pk_bf16_f32 v114, v164, v165
    v_cvt_pk_bf16_f32 v115, v166, v167
    s_waitcnt lgkmcnt(8)
    v_add_f32 v168, v168, v72
    v_add_f32 v169, v169, v73
    v_add_f32 v170, v170, v74
    v_add_f32 v171, v171, v75
    v_add_f32 v172, v172, v76
    v_add_f32 v173, v173, v77
    v_add_f32 v174, v174, v78
    v_add_f32 v175, v175, v79
    v_cvt_pk_bf16_f32 v116, v168, v169
    v_cvt_pk_bf16_f32 v117, v170, v171
    v_cvt_pk_bf16_f32 v118, v172, v173
    v_cvt_pk_bf16_f32 v119, v174, v175
    s_waitcnt lgkmcnt(6)
    v_add_f32 v192, v192, v80
    v_add_f32 v193, v193, v81
    v_add_f32 v194, v194, v82
    v_add_f32 v195, v195, v83
    v_add_f32 v196, v196, v84
    v_add_f32 v197, v197, v85
    v_add_f32 v198, v198, v86
    v_add_f32 v199, v199, v87
    v_cvt_pk_bf16_f32 v120, v192, v193
    v_cvt_pk_bf16_f32 v121, v194, v195
    v_cvt_pk_bf16_f32 v122, v196, v197
    v_cvt_pk_bf16_f32 v123, v198, v199
    s_waitcnt lgkmcnt(4)
    v_add_f32 v200, v200, v88
    v_add_f32 v201, v201, v89
    v_add_f32 v202, v202, v90
    v_add_f32 v203, v203, v91
    v_add_f32 v204, v204, v92
    v_add_f32 v205, v205, v93
    v_add_f32 v206, v206, v94
    v_add_f32 v207, v207, v95
    v_cvt_pk_bf16_f32 v124, v200, v201
    v_cvt_pk_bf16_f32 v125, v202, v203
    v_cvt_pk_bf16_f32 v126, v204, v205
    v_cvt_pk_bf16_f32 v127, v206, v207
    s_waitcnt lgkmcnt(2)
    v_add_f32 v224, v224, v96
    v_add_f32 v225, v225, v97
    v_add_f32 v226, v226, v98
    v_add_f32 v227, v227, v99
    v_add_f32 v228, v228, v100
    v_add_f32 v229, v229, v101
    v_add_f32 v230, v230, v102
    v_add_f32 v231, v231, v103
    v_cvt_pk_bf16_f32 v128, v224, v225
    v_cvt_pk_bf16_f32 v129, v226, v227
    v_cvt_pk_bf16_f32 v130, v228, v229
    v_cvt_pk_bf16_f32 v131, v230, v231
    s_waitcnt lgkmcnt(0)
    v_add_f32 v232, v232, v104
    v_add_f32 v233, v233, v105
    v_add_f32 v234, v234, v106
    v_add_f32 v235, v235, v107
    v_add_f32 v236, v236, v108
    v_add_f32 v237, v237, v109
    v_add_f32 v238, v238, v110
    v_add_f32 v239, v239, v111
    v_cvt_pk_bf16_f32 v132, v232, v233
    v_cvt_pk_bf16_f32 v133, v234, v235
    v_cvt_pk_bf16_f32 v134, v236, v237
    v_cvt_pk_bf16_f32 v135, v238, v239
    s_mov_b32 exec_lo, 0
    s_nop 0
    v_swap_b32 v112, v114
    v_swap_b32 v113, v115
    v_swap_b32 v116, v118
    v_swap_b32 v117, v119
    v_swap_b32 v120, v122
    v_swap_b32 v121, v123
    v_swap_b32 v124, v126
    v_swap_b32 v125, v127
    v_swap_b32 v128, v130
    v_swap_b32 v129, v131
    v_swap_b32 v132, v134
    v_swap_b32 v133, v135
    s_mov_b32 exec_lo, -1
    s_nop 1
    buffer_store_dwordx4 v[112:115], v14, s[12:15], s37 offen
    buffer_store_dwordx4 v[116:119], v14, s[12:15], s37 offen offset:64
    s_add_u32 s37, s37, 0x8000
    buffer_store_dwordx4 v[120:123], v14, s[12:15], s37 offen
    buffer_store_dwordx4 v[124:127], v14, s[12:15], s37 offen offset:64
    s_add_u32 s37, s37, 0x8000
    buffer_store_dwordx4 v[128:131], v14, s[12:15], s37 offen
    buffer_store_dwordx4 v[132:135], v14, s[12:15], s37 offen offset:64
    s_endpgm
L_bepi1:
    ds_write_b128 v7, v[160:163] offset:0
    ds_write_b128 v7, v[164:167] offset:1024
    ds_write_b128 v7, v[168:171] offset:2048
    ds_write_b128 v7, v[172:175] offset:3072
    ds_write_b128 v7, v[192:195] offset:4096
    ds_write_b128 v7, v[196:199] offset:5120
    ds_write_b128 v7, v[200:203] offset:6144
    ds_write_b128 v7, v[204:207] offset:7168
    ds_write_b128 v7, v[224:227] offset:8192
    ds_write_b128 v7, v[228:231] offset:9216
    ds_write_b128 v7, v[232:235] offset:10240
    ds_write_b128 v7, v[236:239] offset:11264
    s_waitcnt lgkmcnt(0)
    s_barrier
    ds_read_b128 v[64:67], v8 offset:0
    ds_read_b128 v[68:71], v8 offset:1024
    ds_read_b128 v[72:75], v8 offset:2048
    ds_read_b128 v[76:79], v8 offset:3072
    ds_read_b128 v[80:83], v8 offset:4096
    ds_read_b128 v[84:87], v8 offset:5120
    ds_read_b128 v[88:91], v8 offset:6144
    ds_read_b128 v[92:95], v8 offset:7168
    ds_read_b128 v[96:99], v8 offset:8192
    ds_read_b128 v[100:103], v8 offset:9216
    ds_read_b128 v[104:107], v8 offset:10240
    ds_read_b128 v[108:111], v8 offset:11264
    s_waitcnt lgkmcnt(10)
    v_add_f32 v176, v176, v64
    v_add_f32 v177, v177, v65
    v_add_f32 v178, v178, v66
    v_add_f32 v179, v179, v67
    v_add_f32 v180, v180, v68
    v_add_f32 v181, v181, v69
    v_add_f32 v182, v182, v70
    v_add_f32 v183, v183, v71
    v_cvt_pk_bf16_f32 v112, v176, v177
    v_cvt_pk_bf16_f32 v113, v178, v179
    v_cvt_pk_bf16_f32 v114, v180, v181
    v_cvt_pk_bf16_f32 v115, v182, v183
    s_waitcnt lgkmcnt(8)
    v_add_f32 v184, v184, v72
    v_add_f32 v185, v185, v73
    v_add_f32 v186, v186, v74
    v_add_f32 v187, v187, v75
    v_add_f32 v188, v188, v76
    v_add_f32 v189, v189, v77
    v_add_f32 v190, v190, v78
    v_add_f32 v191, v191, v79
    v_cvt_pk_bf16_f32 v116, v184, v185
    v_cvt_pk_bf16_f32 v117, v186, v187
    v_cvt_pk_bf16_f32 v118, v188, v189
    v_cvt_pk_bf16_f32 v119, v190, v191
    s_waitcnt lgkmcnt(6)
    v_add_f32 v208, v208, v80
    v_add_f32 v209, v209, v81
    v_add_f32 v210, v210, v82
    v_add_f32 v211, v211, v83
    v_add_f32 v212, v212, v84
    v_add_f32 v213, v213, v85
    v_add_f32 v214, v214, v86
    v_add_f32 v215, v215, v87
    v_cvt_pk_bf16_f32 v120, v208, v209
    v_cvt_pk_bf16_f32 v121, v210, v211
    v_cvt_pk_bf16_f32 v122, v212, v213
    v_cvt_pk_bf16_f32 v123, v214, v215
    s_waitcnt lgkmcnt(4)
    v_add_f32 v216, v216, v88
    v_add_f32 v217, v217, v89
    v_add_f32 v218, v218, v90
    v_add_f32 v219, v219, v91
    v_add_f32 v220, v220, v92
    v_add_f32 v221, v221, v93
    v_add_f32 v222, v222, v94
    v_add_f32 v223, v223, v95
    v_cvt_pk_bf16_f32 v124, v216, v217
    v_cvt_pk_bf16_f32 v125, v218, v219
    v_cvt_pk_bf16_f32 v126, v220, v221
    v_cvt_pk_bf16_f32 v127, v222, v223
    s_waitcnt lgkmcnt(2)
    v_add_f32 v240, v240, v96
    v_add_f32 v241, v241, v97
    v_add_f32 v242, v242, v98
    v_add_f32 v243, v243, v99
    v_add_f32 v244, v244, v100
    v_add_f32 v245, v245, v101
    v_add_f32 v246, v246, v102
    v_add_f32 v247, v247, v103
    v_cvt_pk_bf16_f32 v128, v240, v241
    v_cvt_pk_bf16_f32 v129, v242, v243
    v_cvt_pk_bf16_f32 v130, v244, v245
    v_cvt_pk_bf16_f32 v131, v246, v247
    s_waitcnt lgkmcnt(0)
    v_add_f32 v248, v248, v104
    v_add_f32 v249, v249, v105
    v_add_f32 v250, v250, v106
    v_add_f32 v251, v251, v107
    v_add_f32 v252, v252, v108
    v_add_f32 v253, v253, v109
    v_add_f32 v254, v254, v110
    v_add_f32 v255, v255, v111
    v_cvt_pk_bf16_f32 v132, v248, v249
    v_cvt_pk_bf16_f32 v133, v250, v251
    v_cvt_pk_bf16_f32 v134, v252, v253
    v_cvt_pk_bf16_f32 v135, v254, v255
    s_mov_b32 exec_lo, 0
    s_nop 0
    v_swap_b32 v112, v114
    v_swap_b32 v113, v115
    v_swap_b32 v116, v118
    v_swap_b32 v117, v119
    v_swap_b32 v120, v122
    v_swap_b32 v121, v123
    v_swap_b32 v124, v126
    v_swap_b32 v125, v127
    v_swap_b32 v128, v130
    v_swap_b32 v129, v131
    v_swap_b32 v132, v134
    v_swap_b32 v133, v135
    s_mov_b32 exec_lo, -1
    s_nop 1
    buffer_store_dwordx4 v[112:115], v14, s[12:15], s37 offen offset:128
    buffer_store_dwordx4 v[116:119], v14, s[12:15], s37 offen offset:192
    s_add_u32 s37, s37, 0x8000
    buffer_store_dwordx4 v[120:123], v14, s[12:15], s37 offen offset:128
    buffer_store_dwordx4 v[124:127], v14, s[12:15], s37 offen offset:192
    s_add_u32 s37, s37, 0x8000
    buffer_store_dwordx4 v[128:131], v14, s[12:15], s37 offen offset:128
    buffer_store_dwordx4 v[132:135], v14, s[12:15], s37 offen offset:192
    s_endpgm
L_end:
    s_endpgm
L_slow0:
    s_sub_u32 s45, s39, 40960
    s_and_b32 s37, s45, 0xc0000
    s_add_u32 s44, s45, s70
    s_lshl_b32 s37, s37, 4
    s_and_b32 s44, s44, 0x3ffff
    s_or_b32 s44, s44, s37
    s_add_u32 s45, s44, 4096
    s_call_b64 s[40:41], L_rebase0
    ds_read_b64_tr_b16 v[28:29], v10 offset:43520
    ds_read_b64_tr_b16 v[30:31], v10 offset:44032
    ds_read_b64_tr_b16 v[32:33], v10 offset:43552
    ds_read_b64_tr_b16 v[34:35], v10 offset:44064
    ds_read_b64_tr_b16 v[36:37], v10 offset:43584
    ds_read_b64_tr_b16 v[38:39], v10 offset:44096
    ds_read_b64_tr_b16 v[40:41], v10 offset:43616
    ds_read_b64_tr_b16 v[42:43], v10 offset:44128
    ds_read_b64_tr_b16 v[44:45], v10 offset:43648
    ds_read_b64_tr_b16 v[46:47], v10 offset:44160
    ds_read_b64_tr_b16 v[48:49], v10 offset:43680
    ds_read_b64_tr_b16 v[50:51], v10 offset:44192
    s_waitcnt lgkmcnt(0)
    s_branch L_back0
L_slow1:
    s_sub_u32 s45, s39, 40960
    s_and_b32 s37, s45, 0xc0000
    s_add_u32 s44, s45, s70
    s_lshl_b32 s37, s37, 4
    s_and_b32 s44, s44, 0x3ffff
    s_or_b32 s44, s44, s37
    s_add_u32 s45, s44, 4096
    s_call_b64 s[40:41], L_rebase1
    ds_read_b64_tr_b16 v[28:29], v10 offset:60928
    ds_read_b64_tr_b16 v[30:31], v10 offset:61440
    ds_read_b64_tr_b16 v[32:33], v10 offset:60960
    ds_read_b64_tr_b16 v[34:35], v10 offset:61472
    ds_read_b64_tr_b16 v[36:37], v10 offset:60992
    ds_read_b64_tr_b16 v[38:39], v10 offset:61504
    ds_read_b64_tr_b16 v[40:41], v10 offset:61024
    ds_read_b64_tr_b16 v[42:43], v10 offset:61536
    ds_read_b64_tr_b16 v[44:45], v10 offset:61056
    ds_read_b64_tr_b16 v[46:47], v10 offset:61568
    ds_read_b64_tr_b16 v[48:49], v10 offset:61088
    ds_read_b64_tr_b16 v[50:51], v10 offset:61600
    s_waitcnt lgkmcnt(0)
    s_branch L_back1
L_slow2:
    s_sub_u32 s45, s39, 40960
    s_and_b32 s37, s45, 0xc0000
    s_add_u32 s44, s45, s70
    s_lshl_b32 s37, s37, 4
    s_and_b32 s44, s44, 0x3ffff
    s_or_b32 s44, s44, s37
    s_add_u32 s45, s44, 4096
    s_call_b64 s[40:41], L_rebase0
    ds_read_b64_tr_b16 v[28:29], v10 offset:0
    ds_read_b64_tr_b16 v[30:31], v10 offset:512
    ds_read_b64_tr_b16 v[32:33], v10 offset:32
    ds_read_b64_tr_b16 v[34:35], v10 offset:544
    ds_read_b64_tr_b16 v[36:37], v10 offset:64
    ds_read_b64_tr_b16 v[38:39], v10 offset:576
    ds_read_b64_tr_b16 v[40:41], v10 offset:96
    ds_read_b64_tr_b16 v[42:43], v10 offset:608
    ds_read_b64_tr_b16 v[44:45], v10 offset:128
    ds_read_b64_tr_b16 v[46:47], v10 offset:640
    ds_read_b64_tr_b16 v[48:49], v10 offset:160
    ds_read_b64_tr_b16 v[50:51], v10 offset:672
    s_waitcnt lgkmcnt(0)
    s_branch L_back2
L_slow3:
    s_sub_u32 s45, s39, 40960
    s_and_b32 s37, s45, 0xc0000
    s_add_u32 s44, s45, s70
    s_lshl_b32 s37, s37, 4
    s_and_b32 s44, s44, 0x3ffff
    s_or_b32 s44, s44, s37
    s_add_u32 s45, s44, 4096
    s_call_b64 s[40:41], L_rebase1
    ds_read_b64_tr_b16 v[28:29], v10 offset:17408
    ds_read_b64_tr_b16 v[30:31], v10 offset:17920
    ds_read_b64_tr_b16 v[32:33], v10 offset:17440
    ds_read_b64_tr_b16 v[34:35], v10 offset:17952
    ds_read_b64_tr_b16 v[36:37], v10 offset:17472
    ds_read_b64_tr_b16 v[38:39], v10 offset:17984
    ds_read_b64_tr_b16 v[40:41], v10 offset:17504
    ds_read_b64_tr_b16 v[42:43], v10 offset:18016
    ds_read_b64_tr_b16 v[44:45], v10 offset:17536
    ds_read_b64_tr_b16 v[46:47], v10 offset:18048
    ds_read_b64_tr_b16 v[48:49], v10 offset:17568
    ds_read_b64_tr_b16 v[50:51], v10 offset:18080
    s_waitcnt lgkmcnt(0)
    s_branch L_back3
L_slow4:
    s_sub_u32 s45, s39, 40960
    s_and_b32 s37, s45, 0xc0000
    s_add_u32 s44, s45, s70
    s_lshl_b32 s37, s37, 4
    s_and_b32 s44, s44, 0x3ffff
    s_or_b32 s44, s44, s37
    s_add_u32 s45, s44, 4096
    s_call_b64 s[40:41], L_rebase0
    ds_read_b64_tr_b16 v[28:29], v10 offset:43520
    ds_read_b64_tr_b16 v[30:31], v10 offset:44032
    ds_read_b64_tr_b16 v[32:33], v10 offset:43552
    ds_read_b64_tr_b16 v[34:35], v10 offset:44064
    ds_read_b64_tr_b16 v[36:37], v10 offset:43584
    ds_read_b64_tr_b16 v[38:39], v10 offset:44096
    ds_read_b64_tr_b16 v[40:41], v10 offset:43616
    ds_read_b64_tr_b16 v[42:43], v10 offset:44128
    ds_read_b64_tr_b16 v[44:45], v10 offset:43648
    ds_read_b64_tr_b16 v[46:47], v10 offset:44160
    ds_read_b64_tr_b16 v[48:49], v10 offset:43680
    ds_read_b64_tr_b16 v[50:51], v10 offset:44192
    s_waitcnt lgkmcnt(0)
    s_branch L_back4
L_slow5:
    s_sub_u32 s45, s39, 40960
    s_and_b32 s37, s45, 0xc0000
    s_add_u32 s44, s45, s70
    s_lshl_b32 s37, s37, 4
    s_and_b32 s44, s44, 0x3ffff
    s_or_b32 s44, s44, s37
    s_add_u32 s45, s44, 4096
    s_call_b64 s[40:41], L_rebase1
    ds_read_b64_tr_b16 v[28:29], v10 offset:60928
    ds_read_b64_tr_b16 v[30:31], v10 offset:61440
    ds_read_b64_tr_b16 v[32:33], v10 offset:60960
    ds_read_b64_tr_b16 v[34:35], v10 offset:61472
    ds_read_b64_tr_b16 v[36:37], v10 offset:60992
    ds_read_b64_tr_b16 v[38:39], v10 offset:61504
    ds_read_b64_tr_b16 v[40:41], v10 offset:61024
    ds_read_b64_tr_b16 v[42:43], v10 offset:61536
    ds_read_b64_tr_b16 v[44:45], v10 offset:61056
    ds_read_b64_tr_b16 v[46:47], v10 offset:61568
    ds_read_b64_tr_b16 v[48:49], v10 offset:61088
    ds_read_b64_tr_b16 v[50:51], v10 offset:61600
    s_waitcnt lgkmcnt(0)
    s_branch L_back5
L_slow6:
    s_sub_u32 s45, s39, 40960
    s_and_b32 s37, s45, 0xc0000
    s_add_u32 s44, s45, s70
    s_lshl_b32 s37, s37, 4
    s_and_b32 s44, s44, 0x3ffff
    s_or_b32 s44, s44, s37
    s_add_u32 s45, s44, 4096
    s_call_b64 s[40:41], L_rebase0
    ds_read_b64_tr_b16 v[28:29], v10 offset:0
    ds_read_b64_tr_b16 v[30:31], v10 offset:512
    ds_read_b64_tr_b16 v[32:33], v10 offset:32
    ds_read_b64_tr_b16 v[34:35], v10 offset:544
    ds_read_b64_tr_b16 v[36:37], v10 offset:64
    ds_read_b64_tr_b16 v[38:39], v10 offset:576
    ds_read_b64_tr_b16 v[40:41], v10 offset:96
    ds_read_b64_tr_b16 v[42:43], v10 offset:608
    ds_read_b64_tr_b16 v[44:45], v10 offset:128
    ds_read_b64_tr_b16 v[46:47], v10 offset:640
    ds_read_b64_tr_b16 v[48:49], v10 offset:160
    ds_read_b64_tr_b16 v[50:51], v10 offset:672
    s_waitcnt lgkmcnt(0)
    s_branch L_back6
L_slow7:
    s_sub_u32 s45, s39, 40960
    s_and_b32 s37, s45, 0xc0000
    s_add_u32 s44, s45, s70
    s_lshl_b32 s37, s37, 4
    s_and_b32 s44, s44, 0x3ffff
    s_or_b32 s44, s44, s37
    s_add_u32 s45, s44, 4096
    s_call_b64 s[40:41], L_rebase1
    ds_read_b64_tr_b16 v[28:29], v10 offset:17408
    ds_read_b64_tr_b16 v[30:31], v10 offset:17920
    ds_read_b64_tr_b16 v[32:33], v10 offset:17440
    ds_read_b64_tr_b16 v[34:35], v10 offset:17952
    ds_read_b64_tr_b16 v[36:37], v10 offset:17472
    ds_read_b64_tr_b16 v[38:39], v10 offset:17984
    ds_read_b64_tr_b16 v[40:41], v10 offset:17504
    ds_read_b64_tr_b16 v[42:43], v10 offset:18016
    ds_read_b64_tr_b16 v[44:45], v10 offset:17536
    ds_read_b64_tr_b16 v[46:47], v10 offset:18048
    ds_read_b64_tr_b16 v[48:49], v10 offset:17568
    ds_read_b64_tr_b16 v[50:51], v10 offset:18080
    s_waitcnt lgkmcnt(0)
    s_branch L_back7
L_rebase0:
    s_waitcnt lgkmcnt(0)
    s_nop 7
    s_nop 7
    v_and_b32 v7, 15, v13
    v_lshlrev_b32 v7, 8, v7
    v_lshrrev_b32 v8, 4, v13
    v_lshl_add_u32 v7, v8, 4, v7
    buffer_load_dwordx4 v[28:31], v7, s[12:15], s44 offen
    buffer_load_dwordx4 v[32:35], v7, s[12:15], s44 offen offset:64
    buffer_load_dwordx4 v[36:39], v7, s[12:15], s44 offen offset:128
    buffer_load_dwordx4 v[40:43], v7, s[12:15], s44 offen offset:192
    buffer_load_dwordx4 v[44:47], v7, s[12:15], s45 offen
    buffer_load_dwordx4 v[48:51], v7, s[12:15], s45 offen offset:64
    buffer_load_dwordx4 v[52:55], v7, s[12:15], s45 offen offset:128
    buffer_load_dwordx4 v[56:59], v7, s[12:15], s45 offen offset:192
    s_waitcnt vmcnt(0)
    v_mfma_f32_16x16x32_bf16 v[64:67], v[28:31], v[112:115], v[16:19]
    v_mfma_f32_16x16x32_bf16 v[72:75], v[28:31], v[128:131], v[20:23]
    v_mfma_f32_16x16x32_bf16 v[80:83], v[28:31], v[144:147], v[24:27]
    v_mfma_f32_16x16x32_bf16 v[64:67], v[32:35], v[116:119], v[64:67]
    v_mfma_f32_16x16x32_bf16 v[72:75], v[32:35], v[132:135], v[72:75]
    v_mfma_f32_16x16x32_bf16 v[80:83], v[32:35], v[148:151], v[80:83]
    v_mfma_f32_16x16x32_bf16 v[64:67], v[36:39], v[120:123], v[64:67]
    v_mfma_f32_16x16x32_bf16 v[72:75], v[36:39], v[136:139], v[72:75]
    v_mfma_f32_16x16x32_bf16 v[80:83], v[36:39], v[152:155], v[80:83]
    v_mfma_f32_16x16x32_bf16 v[64:67], v[40:43], v[124:127], v[64:67]
    v_mfma_f32_16x16x32_bf16 v[72:75], v[40:43], v[140:143], v[72:75]
    v_mfma_f32_16x16x32_bf16 v[80:83], v[40:43], v[156:159], v[80:83]
    v_mfma_f32_16x16x32_bf16 v[68:71], v[44:47], v[112:115], v[16:19]
    v_mfma_f32_16x16x32_bf16 v[76:79], v[44:47], v[128:131], v[20:23]
    v_mfma_f32_16x16x32_bf16 v[84:87], v[44:47], v[144:147], v[24:27]
    v_mfma_f32_16x16x32_bf16 v[68:71], v[48:51], v[116:119], v[68:71]
    v_mfma_f32_16x16x32_bf16 v[76:79], v[48:51], v[132:135], v[76:79]
    v_mfma_f32_16x16x32_bf16 v[84:87], v[48:51], v[148:151], v[84:87]
    v_mfma_f32_16x16x32_bf16 v[68:71], v[52:55], v[120:123], v[68:71]
    v_mfma_f32_16x16x32_bf16 v[76:79], v[52:55], v[136:139], v[76:79]
    v_mfma_f32_16x16x32_bf16 v[84:87], v[52:55], v[152:155], v[84:87]
    v_mfma_f32_16x16x32_bf16 v[68:71], v[56:59], v[124:127], v[68:71]
    v_mfma_f32_16x16x32_bf16 v[76:79], v[56:59], v[140:143], v[76:79]
    v_mfma_f32_16x16x32_bf16 v[84:87], v[56:59], v[156:159], v[84:87]
    s_nop 7
    s_nop 7
    v_max3_f32 v7, v64, v65, v66
    v_max3_f32 v7, v7, v67, v68
    v_max3_f32 v7, v7, v69, v70
    v_max_f32 v7, v7, v71
    v_mov_b32 v8, v7
    s_nop 1
    v_permlane16_swap_b32 v7, v8
    s_nop 1
    v_max_f32 v7, v7, v8
    v_mov_b32 v8, v7
    s_nop 1
    v_permlane32_swap_b32 v7, v8
    s_nop 1
    v_max_f32 v7, v7, v8
    v_max_f32 v7, 0, v7
    v_sub_f32 v8, 0, v7
    v_exp_f32 v8, v8
    v_sub_f32 v16, v16, v7
    v_sub_f32 v17, v17, v7
    v_sub_f32 v18, v18, v7
    v_sub_f32 v19, v19, v7
    v_sub_f32 v64, v64, v7
    v_sub_f32 v65, v65, v7
    v_sub_f32 v66, v66, v7
    v_sub_f32 v67, v67, v7
    v_sub_f32 v68, v68, v7
    v_sub_f32 v69, v69, v7
    v_sub_f32 v70, v70, v7
    v_sub_f32 v71, v71, v7
    v_sub_f32 v88, v88, v7
    v_sub_f32 v89, v89, v7
    v_sub_f32 v90, v90, v7
    v_sub_f32 v91, v91, v7
    v_sub_f32 v92, v92, v7
    v_sub_f32 v93, v93, v7
    v_sub_f32 v94, v94, v7
    v_sub_f32 v95, v95, v7
    v_mul_f32 v1, v1, v8
    v_mul_f32 v160, v160, v8
    v_mul_f32 v161, v161, v8
    v_mul_f32 v162, v162, v8
    v_mul_f32 v163, v163, v8
    v_mul_f32 v164, v164, v8
    v_mul_f32 v165, v165, v8
    v_mul_f32 v166, v166, v8
    v_mul_f32 v167, v167, v8
    v_mul_f32 v168, v168, v8
    v_mul_f32 v169, v169, v8
    v_mul_f32 v170, v170, v8
    v_mul_f32 v171, v171, v8
    v_mul_f32 v172, v172, v8
    v_mul_f32 v173, v173, v8
    v_mul_f32 v174, v174, v8
    v_mul_f32 v175, v175, v8
    v_mul_f32 v176, v176, v8
    v_mul_f32 v177, v177, v8
    v_mul_f32 v178, v178, v8
    v_mul_f32 v179, v179, v8
    v_mul_f32 v180, v180, v8
    v_mul_f32 v181, v181, v8
    v_mul_f32 v182, v182, v8
    v_mul_f32 v183, v183, v8
    v_mul_f32 v184, v184, v8
    v_mul_f32 v185, v185, v8
    v_mul_f32 v186, v186, v8
    v_mul_f32 v187, v187, v8
    v_mul_f32 v188, v188, v8
    v_mul_f32 v189, v189, v8
    v_mul_f32 v190, v190, v8
    v_mul_f32 v191, v191, v8
    v_exp_f32 v64, v64
    v_exp_f32 v65, v65
    v_exp_f32 v66, v66
    v_exp_f32 v67, v67
    v_exp_f32 v68, v68
    v_exp_f32 v69, v69
    v_exp_f32 v70, v70
    v_exp_f32 v71, v71
    s_nop 0
    v_add_f32 v4, v64, v65
    v_add_f32 v4, v4, v66
    v_add_f32 v4, v4, v67
    v_add_f32 v4, v4, v68
    v_add_f32 v4, v4, v69
    v_add_f32 v4, v4, v70
    v_add_f32 v4, v4, v71
    v_cvt_pk_bf16_f32 v64, v64, v65
    v_cvt_pk_bf16_f32 v65, v66, v67
    v_cvt_pk_bf16_f32 v66, v68, v69
    v_cvt_pk_bf16_f32 v67, v70, v71
    v_max3_f32 v7, v72, v73, v74
    v_max3_f32 v7, v7, v75, v76
    v_max3_f32 v7, v7, v77, v78
    v_max_f32 v7, v7, v79
    v_mov_b32 v8, v7
    s_nop 1
    v_permlane16_swap_b32 v7, v8
    s_nop 1
    v_max_f32 v7, v7, v8
    v_mov_b32 v8, v7
    s_nop 1
    v_permlane32_swap_b32 v7, v8
    s_nop 1
    v_max_f32 v7, v7, v8
    v_max_f32 v7, 0, v7
    v_sub_f32 v8, 0, v7
    v_exp_f32 v8, v8
    v_sub_f32 v20, v20, v7
    v_sub_f32 v21, v21, v7
    v_sub_f32 v22, v22, v7
    v_sub_f32 v23, v23, v7
    v_sub_f32 v72, v72, v7
    v_sub_f32 v73, v73, v7
    v_sub_f32 v74, v74, v7
    v_sub_f32 v75, v75, v7
    v_sub_f32 v76, v76, v7
    v_sub_f32 v77, v77, v7
    v_sub_f32 v78, v78, v7
    v_sub_f32 v79, v79, v7
    v_sub_f32 v96, v96, v7
    v_sub_f32 v97, v97, v7
    v_sub_f32 v98, v98, v7
    v_sub_f32 v99, v99, v7
    v_sub_f32 v100, v100, v7
    v_sub_f32 v101, v101, v7
    v_sub_f32 v102, v102, v7
    v_sub_f32 v103, v103, v7
    v_mul_f32 v2, v2, v8
    v_mul_f32 v192, v192, v8
    v_mul_f32 v193, v193, v8
    v_mul_f32 v194, v194, v8
    v_mul_f32 v195, v195, v8
    v_mul_f32 v196, v196, v8
    v_mul_f32 v197, v197, v8
    v_mul_f32 v198, v198, v8
    v_mul_f32 v199, v199, v8
    v_mul_f32 v200, v200, v8
    v_mul_f32 v201, v201, v8
    v_mul_f32 v202, v202, v8
    v_mul_f32 v203, v203, v8
    v_mul_f32 v204, v204, v8
    v_mul_f32 v205, v205, v8
    v_mul_f32 v206, v206, v8
    v_mul_f32 v207, v207, v8
    v_mul_f32 v208, v208, v8
    v_mul_f32 v209, v209, v8
    v_mul_f32 v210, v210, v8
    v_mul_f32 v211, v211, v8
    v_mul_f32 v212, v212, v8
    v_mul_f32 v213, v213, v8
    v_mul_f32 v214, v214, v8
    v_mul_f32 v215, v215, v8
    v_mul_f32 v216, v216, v8
    v_mul_f32 v217, v217, v8
    v_mul_f32 v218, v218, v8
    v_mul_f32 v219, v219, v8
    v_mul_f32 v220, v220, v8
    v_mul_f32 v221, v221, v8
    v_mul_f32 v222, v222, v8
    v_mul_f32 v223, v223, v8
    v_exp_f32 v72, v72
    v_exp_f32 v73, v73
    v_exp_f32 v74, v74
    v_exp_f32 v75, v75
    v_exp_f32 v76, v76
    v_exp_f32 v77, v77
    v_exp_f32 v78, v78
    v_exp_f32 v79, v79
    s_nop 0
    v_add_f32 v5, v72, v73
    v_add_f32 v5, v5, v74
    v_add_f32 v5, v5, v75
    v_add_f32 v5, v5, v76
    v_add_f32 v5, v5, v77
    v_add_f32 v5, v5, v78
    v_add_f32 v5, v5, v79
    v_cvt_pk_bf16_f32 v72, v72, v73
    v_cvt_pk_bf16_f32 v73, v74, v75
    v_cvt_pk_bf16_f32 v74, v76, v77
    v_cvt_pk_bf16_f32 v75, v78, v79
    v_max3_f32 v7, v80, v81, v82
    v_max3_f32 v7, v7, v83, v84
    v_max3_f32 v7, v7, v85, v86
    v_max_f32 v7, v7, v87
    v_mov_b32 v8, v7
    s_nop 1
    v_permlane16_swap_b32 v7, v8
    s_nop 1
    v_max_f32 v7, v7, v8
    v_mov_b32 v8, v7
    s_nop 1
    v_permlane32_swap_b32 v7, v8
    s_nop 1
    v_max_f32 v7, v7, v8
    v_max_f32 v7, 0, v7
    v_sub_f32 v8, 0, v7
    v_exp_f32 v8, v8
    v_sub_f32 v24, v24, v7
    v_sub_f32 v25, v25, v7
    v_sub_f32 v26, v26, v7
    v_sub_f32 v27, v27, v7
    v_sub_f32 v80, v80, v7
    v_sub_f32 v81, v81, v7
    v_sub_f32 v82, v82, v7
    v_sub_f32 v83, v83, v7
    v_sub_f32 v84, v84, v7
    v_sub_f32 v85, v85, v7
    v_sub_f32 v86, v86, v7
    v_sub_f32 v87, v87, v7
    v_sub_f32 v104, v104, v7
    v_sub_f32 v105, v105, v7
    v_sub_f32 v106, v106, v7
    v_sub_f32 v107, v107, v7
    v_sub_f32 v108, v108, v7
    v_sub_f32 v109, v109, v7
    v_sub_f32 v110, v110, v7
    v_sub_f32 v111, v111, v7
    v_mul_f32 v3, v3, v8
    v_mul_f32 v224, v224, v8
    v_mul_f32 v225, v225, v8
    v_mul_f32 v226, v226, v8
    v_mul_f32 v227, v227, v8
    v_mul_f32 v228, v228, v8
    v_mul_f32 v229, v229, v8
    v_mul_f32 v230, v230, v8
    v_mul_f32 v231, v231, v8
    v_mul_f32 v232, v232, v8
    v_mul_f32 v233, v233, v8
    v_mul_f32 v234, v234, v8
    v_mul_f32 v235, v235, v8
    v_mul_f32 v236, v236, v8
    v_mul_f32 v237, v237, v8
    v_mul_f32 v238, v238, v8
    v_mul_f32 v239, v239, v8
    v_mul_f32 v240, v240, v8
    v_mul_f32 v241, v241, v8
    v_mul_f32 v242, v242, v8
    v_mul_f32 v243, v243, v8
    v_mul_f32 v244, v244, v8
    v_mul_f32 v245, v245, v8
    v_mul_f32 v246, v246, v8
    v_mul_f32 v247, v247, v8
    v_mul_f32 v248, v248, v8
    v_mul_f32 v249, v249, v8
    v_mul_f32 v250, v250, v8
    v_mul_f32 v251, v251, v8
    v_mul_f32 v252, v252, v8
    v_mul_f32 v253, v253, v8
    v_mul_f32 v254, v254, v8
    v_mul_f32 v255, v255, v8
    v_exp_f32 v80, v80
    v_exp_f32 v81, v81
    v_exp_f32 v82, v82
    v_exp_f32 v83, v83
    v_exp_f32 v84, v84
    v_exp_f32 v85, v85
    v_exp_f32 v86, v86
    v_exp_f32 v87, v87
    s_nop 0
    v_add_f32 v6, v80, v81
    v_add_f32 v6, v6, v82
    v_add_f32 v6, v6, v83
    v_add_f32 v6, v6, v84
    v_add_f32 v6, v6, v85
    v_add_f32 v6, v6, v86
    v_add_f32 v6, v6, v87
    v_cvt_pk_bf16_f32 v80, v80, v81
    v_cvt_pk_bf16_f32 v81, v82, v83
    v_cvt_pk_bf16_f32 v82, v84, v85
    v_cvt_pk_bf16_f32 v83, v86, v87
    s_nop 3
    s_setpc_b64 s[40:41]
L_rebase1:
    s_waitcnt lgkmcnt(0)
    s_nop 7
    s_nop 7
    v_and_b32 v7, 15, v13
    v_lshlrev_b32 v7, 8, v7
    v_lshrrev_b32 v8, 4, v13
    v_lshl_add_u32 v7, v8, 4, v7
    buffer_load_dwordx4 v[28:31], v7, s[12:15], s44 offen
    buffer_load_dwordx4 v[32:35], v7, s[12:15], s44 offen offset:64
    buffer_load_dwordx4 v[36:39], v7, s[12:15], s44 offen offset:128
    buffer_load_dwordx4 v[40:43], v7, s[12:15], s44 offen offset:192
    buffer_load_dwordx4 v[44:47], v7, s[12:15], s45 offen
    buffer_load_dwordx4 v[48:51], v7, s[12:15], s45 offen offset:64
    buffer_load_dwordx4 v[52:55], v7, s[12:15], s45 offen offset:128
    buffer_load_dwordx4 v[56:59], v7, s[12:15], s45 offen offset:192
    s_waitcnt vmcnt(0)
    v_mfma_f32_16x16x32_bf16 v[88:91], v[28:31], v[112:115], v[16:19]
    v_mfma_f32_16x16x32_bf16 v[96:99], v[28:31], v[128:131], v[20:23]
    v_mfma_f32_16x16x32_bf16 v[104:107], v[28:31], v[144:147], v[24:27]
    v_mfma_f32_16x16x32_bf16 v[88:91], v[32:35], v[116:119], v[88:91]
    v_mfma_f32_16x16x32_bf16 v[96:99], v[32:35], v[132:135], v[96:99]
    v_mfma_f32_16x16x32_bf16 v[104:107], v[32:35], v[148:151], v[104:107]
    v_mfma_f32_16x16x32_bf16 v[88:91], v[36:39], v[120:123], v[88:91]
    v_mfma_f32_16x16x32_bf16 v[96:99], v[36:39], v[136:139], v[96:99]
    v_mfma_f32_16x16x32_bf16 v[104:107], v[36:39], v[152:155], v[104:107]
    v_mfma_f32_16x16x32_bf16 v[88:91], v[40:43], v[124:127], v[88:91]
    v_mfma_f32_16x16x32_bf16 v[96:99], v[40:43], v[140:143], v[96:99]
    v_mfma_f32_16x16x32_bf16 v[104:107], v[40:43], v[156:159], v[104:107]
    v_mfma_f32_16x16x32_bf16 v[92:95], v[44:47], v[112:115], v[16:19]
    v_mfma_f32_16x16x32_bf16 v[100:103], v[44:47], v[128:131], v[20:23]
    v_mfma_f32_16x16x32_bf16 v[108:111], v[44:47], v[144:147], v[24:27]
    v_mfma_f32_16x16x32_bf16 v[92:95], v[48:51], v[116:119], v[92:95]
    v_mfma_f32_16x16x32_bf16 v[100:103], v[48:51], v[132:135], v[100:103]
    v_mfma_f32_16x16x32_bf16 v[108:111], v[48:51], v[148:151], v[108:111]
    v_mfma_f32_16x16x32_bf16 v[92:95], v[52:55], v[120:123], v[92:95]
    v_mfma_f32_16x16x32_bf16 v[100:103], v[52:55], v[136:139], v[100:103]
    v_mfma_f32_16x16x32_bf16 v[108:111], v[52:55], v[152:155], v[108:111]
    v_mfma_f32_16x16x32_bf16 v[92:95], v[56:59], v[124:127], v[92:95]
    v_mfma_f32_16x16x32_bf16 v[100:103], v[56:59], v[140:143], v[100:103]
    v_mfma_f32_16x16x32_bf16 v[108:111], v[56:59], v[156:159], v[108:111]
    s_nop 7
    s_nop 7
    v_max3_f32 v7, v88, v89, v90
    v_max3_f32 v7, v7, v91, v92
    v_max3_f32 v7, v7, v93, v94
    v_max_f32 v7, v7, v95
    v_mov_b32 v8, v7
    s_nop 1
    v_permlane16_swap_b32 v7, v8
    s_nop 1
    v_max_f32 v7, v7, v8
    v_mov_b32 v8, v7
    s_nop 1
    v_permlane32_swap_b32 v7, v8
    s_nop 1
    v_max_f32 v7, v7, v8
    v_max_f32 v7, 0, v7
    v_sub_f32 v8, 0, v7
    v_exp_f32 v8, v8
    v_sub_f32 v16, v16, v7
    v_sub_f32 v17, v17, v7
    v_sub_f32 v18, v18, v7
    v_sub_f32 v19, v19, v7
    v_sub_f32 v64, v64, v7
    v_sub_f32 v65, v65, v7
    v_sub_f32 v66, v66, v7
    v_sub_f32 v67, v67, v7
    v_sub_f32 v68, v68, v7
    v_sub_f32 v69, v69, v7
    v_sub_f32 v70, v70, v7
    v_sub_f32 v71, v71, v7
    v_sub_f32 v88, v88, v7
    v_sub_f32 v89, v89, v7
    v_sub_f32 v90, v90, v7
    v_sub_f32 v91, v91, v7
    v_sub_f32 v92, v92, v7
    v_sub_f32 v93, v93, v7
    v_sub_f32 v94, v94, v7
    v_sub_f32 v95, v95, v7
    v_mul_f32 v1, v1, v8
    v_mul_f32 v160, v160, v8
    v_mul_f32 v161, v161, v8
    v_mul_f32 v162, v162, v8
    v_mul_f32 v163, v163, v8
    v_mul_f32 v164, v164, v8
    v_mul_f32 v165, v165, v8
    v_mul_f32 v166, v166, v8
    v_mul_f32 v167, v167, v8
    v_mul_f32 v168, v168, v8
    v_mul_f32 v169, v169, v8
    v_mul_f32 v170, v170, v8
    v_mul_f32 v171, v171, v8
    v_mul_f32 v172, v172, v8
    v_mul_f32 v173, v173, v8
    v_mul_f32 v174, v174, v8
    v_mul_f32 v175, v175, v8
    v_mul_f32 v176, v176, v8
    v_mul_f32 v177, v177, v8
    v_mul_f32 v178, v178, v8
    v_mul_f32 v179, v179, v8
    v_mul_f32 v180, v180, v8
    v_mul_f32 v181, v181, v8
    v_mul_f32 v182, v182, v8
    v_mul_f32 v183, v183, v8
    v_mul_f32 v184, v184, v8
    v_mul_f32 v185, v185, v8
    v_mul_f32 v186, v186, v8
    v_mul_f32 v187, v187, v8
    v_mul_f32 v188, v188, v8
    v_mul_f32 v189, v189, v8
    v_mul_f32 v190, v190, v8
    v_mul_f32 v191, v191, v8
    v_exp_f32 v88, v88
    v_exp_f32 v89, v89
    v_exp_f32 v90, v90
    v_exp_f32 v91, v91
    v_exp_f32 v92, v92
    v_exp_f32 v93, v93
    v_exp_f32 v94, v94
    v_exp_f32 v95, v95
    s_nop 0
    v_add_f32 v4, v88, v89
    v_add_f32 v4, v4, v90
    v_add_f32 v4, v4, v91
    v_add_f32 v4, v4, v92
    v_add_f32 v4, v4, v93
    v_add_f32 v4, v4, v94
    v_add_f32 v4, v4, v95
    v_cvt_pk_bf16_f32 v88, v88, v89
    v_cvt_pk_bf16_f32 v89, v90, v91
    v_cvt_pk_bf16_f32 v90, v92, v93
    v_cvt_pk_bf16_f32 v91, v94, v95
    v_max3_f32 v7, v96, v97, v98
    v_max3_f32 v7, v7, v99, v100
    v_max3_f32 v7, v7, v101, v102
    v_max_f32 v7, v7, v103
    v_mov_b32 v8, v7
    s_nop 1
    v_permlane16_swap_b32 v7, v8
    s_nop 1
    v_max_f32 v7, v7, v8
    v_mov_b32 v8, v7
    s_nop 1
    v_permlane32_swap_b32 v7, v8
    s_nop 1
    v_max_f32 v7, v7, v8
    v_max_f32 v7, 0, v7
    v_sub_f32 v8, 0, v7
    v_exp_f32 v8, v8
    v_sub_f32 v20, v20, v7
    v_sub_f32 v21, v21, v7
    v_sub_f32 v22, v22, v7
    v_sub_f32 v23, v23, v7
    v_sub_f32 v72, v72, v7
    v_sub_f32 v73, v73, v7
    v_sub_f32 v74, v74, v7
    v_sub_f32 v75, v75, v7
    v_sub_f32 v76, v76, v7
    v_sub_f32 v77, v77, v7
    v_sub_f32 v78, v78, v7
    v_sub_f32 v79, v79, v7
    v_sub_f32 v96, v96, v7
    v_sub_f32 v97, v97, v7
    v_sub_f32 v98, v98, v7
    v_sub_f32 v99, v99, v7
    v_sub_f32 v100, v100, v7
    v_sub_f32 v101, v101, v7
    v_sub_f32 v102, v102, v7
    v_sub_f32 v103, v103, v7
    v_mul_f32 v2, v2, v8
    v_mul_f32 v192, v192, v8
    v_mul_f32 v193, v193, v8
    v_mul_f32 v194, v194, v8
    v_mul_f32 v195, v195, v8
    v_mul_f32 v196, v196, v8
    v_mul_f32 v197, v197, v8
    v_mul_f32 v198, v198, v8
    v_mul_f32 v199, v199, v8
    v_mul_f32 v200, v200, v8
    v_mul_f32 v201, v201, v8
    v_mul_f32 v202, v202, v8
    v_mul_f32 v203, v203, v8
    v_mul_f32 v204, v204, v8
    v_mul_f32 v205, v205, v8
    v_mul_f32 v206, v206, v8
    v_mul_f32 v207, v207, v8
    v_mul_f32 v208, v208, v8
    v_mul_f32 v209, v209, v8
    v_mul_f32 v210, v210, v8
    v_mul_f32 v211, v211, v8
    v_mul_f32 v212, v212, v8
    v_mul_f32 v213, v213, v8
    v_mul_f32 v214, v214, v8
    v_mul_f32 v215, v215, v8
    v_mul_f32 v216, v216, v8
    v_mul_f32 v217, v217, v8
    v_mul_f32 v218, v218, v8
    v_mul_f32 v219, v219, v8
    v_mul_f32 v220, v220, v8
    v_mul_f32 v221, v221, v8
    v_mul_f32 v222, v222, v8
    v_mul_f32 v223, v223, v8
    v_exp_f32 v96, v96
    v_exp_f32 v97, v97
    v_exp_f32 v98, v98
    v_exp_f32 v99, v99
    v_exp_f32 v100, v100
    v_exp_f32 v101, v101
    v_exp_f32 v102, v102
    v_exp_f32 v103, v103
    s_nop 0
    v_add_f32 v5, v96, v97
    v_add_f32 v5, v5, v98
    v_add_f32 v5, v5, v99
    v_add_f32 v5, v5, v100
    v_add_f32 v5, v5, v101
    v_add_f32 v5, v5, v102
    v_add_f32 v5, v5, v103
    v_cvt_pk_bf16_f32 v96, v96, v97
    v_cvt_pk_bf16_f32 v97, v98, v99
    v_cvt_pk_bf16_f32 v98, v100, v101
    v_cvt_pk_bf16_f32 v99, v102, v103
    v_max3_f32 v7, v104, v105, v106
    v_max3_f32 v7, v7, v107, v108
    v_max3_f32 v7, v7, v109, v110
    v_max_f32 v7, v7, v111
    v_mov_b32 v8, v7
    s_nop 1
    v_permlane16_swap_b32 v7, v8
    s_nop 1
    v_max_f32 v7, v7, v8
    v_mov_b32 v8, v7
    s_nop 1
    v_permlane32_swap_b32 v7, v8
    s_nop 1
    v_max_f32 v7, v7, v8
    v_max_f32 v7, 0, v7
    v_sub_f32 v8, 0, v7
    v_exp_f32 v8, v8
    v_sub_f32 v24, v24, v7
    v_sub_f32 v25, v25, v7
    v_sub_f32 v26, v26, v7
    v_sub_f32 v27, v27, v7
    v_sub_f32 v80, v80, v7
    v_sub_f32 v81, v81, v7
    v_sub_f32 v82, v82, v7
    v_sub_f32 v83, v83, v7
    v_sub_f32 v84, v84, v7
    v_sub_f32 v85, v85, v7
    v_sub_f32 v86, v86, v7
    v_sub_f32 v87, v87, v7
    v_sub_f32 v104, v104, v7
    v_sub_f32 v105, v105, v7
    v_sub_f32 v106, v106, v7
    v_sub_f32 v107, v107, v7
    v_sub_f32 v108, v108, v7
    v_sub_f32 v109, v109, v7
    v_sub_f32 v110, v110, v7
    v_sub_f32 v111, v111, v7
    v_mul_f32 v3, v3, v8
    v_mul_f32 v224, v224, v8
    v_mul_f32 v225, v225, v8
    v_mul_f32 v226, v226, v8
    v_mul_f32 v227, v227, v8
    v_mul_f32 v228, v228, v8
    v_mul_f32 v229, v229, v8
    v_mul_f32 v230, v230, v8
    v_mul_f32 v231, v231, v8
    v_mul_f32 v232, v232, v8
    v_mul_f32 v233, v233, v8
    v_mul_f32 v234, v234, v8
    v_mul_f32 v235, v235, v8
    v_mul_f32 v236, v236, v8
    v_mul_f32 v237, v237, v8
    v_mul_f32 v238, v238, v8
    v_mul_f32 v239, v239, v8
    v_mul_f32 v240, v240, v8
    v_mul_f32 v241, v241, v8
    v_mul_f32 v242, v242, v8
    v_mul_f32 v243, v243, v8
    v_mul_f32 v244, v244, v8
    v_mul_f32 v245, v245, v8
    v_mul_f32 v246, v246, v8
    v_mul_f32 v247, v247, v8
    v_mul_f32 v248, v248, v8
    v_mul_f32 v249, v249, v8
    v_mul_f32 v250, v250, v8
    v_mul_f32 v251, v251, v8
    v_mul_f32 v252, v252, v8
    v_mul_f32 v253, v253, v8
    v_mul_f32 v254, v254, v8
    v_mul_f32 v255, v255, v8
    v_exp_f32 v104, v104
    v_exp_f32 v105, v105
    v_exp_f32 v106, v106
    v_exp_f32 v107, v107
    v_exp_f32 v108, v108
    v_exp_f32 v109, v109
    v_exp_f32 v110, v110
    v_exp_f32 v111, v111
    s_nop 0
    v_add_f32 v6, v104, v105
    v_add_f32 v6, v6, v106
    v_add_f32 v6, v6, v107
    v_add_f32 v6, v6, v108
    v_add_f32 v6, v6, v109
    v_add_f32 v6, v6, v110
    v_add_f32 v6, v6, v111
    v_cvt_pk_bf16_f32 v104, v104, v105
    v_cvt_pk_bf16_f32 v105, v106, v107
    v_cvt_pk_bf16_f32 v106, v108, v109
    v_cvt_pk_bf16_f32 v107, v110, v111
    s_nop 3
    s_setpc_b64 s[40:41]
.section .rodata,"a"
.p2align 6
.amdhsa_kernel standalone__mha_block_cached__near_ridge_kernel
  .amdhsa_next_free_vgpr 256
  .amdhsa_next_free_sgpr 102
  .amdhsa_accum_offset 256
  .amdhsa_group_segment_fixed_size 0
  .amdhsa_kernarg_size 64
  .amdhsa_user_sgpr_count 2
  .amdhsa_user_sgpr_kernarg_segment_ptr 1
  .amdhsa_system_sgpr_workgroup_id_x 1
.end_amdhsa_kernel
```
